```python
import torch

def _softmax(x, axis=-1):
    return torch.softmax(x, dim=axis)

def _gelu(x):
    return torch.nn.functional.gelu(x, approximate='tanh')

def _silu(x):
    return torch.nn.functional.silu(x)

def _sigmoid(x):
    return torch.sigmoid(x)

def _layernorm(x, axis=-1, eps=1e-05):
    m = x.mean(dim=axis, keepdim=True)
    v = x.var(dim=axis, keepdim=True, unbiased=False)
    return (x - m) / torch.sqrt(v + eps)

def _scatter_add(tgt, idx, src, axis=0):
    return tgt.clone().index_add_(axis, idx, src)

def _segment_sum(src, seg, n):
    out = torch.zeros((n,) + src.shape[1:], dtype=src.dtype)
    return out.index_add_(0, seg, src)

def _pad(x, pw):
    flat = tuple((v for pair in reversed(pw) for v in pair))
    return torch.nn.functional.pad(x, flat)
kernel_name = 'adaLN_cond__softmax_full_mha__glu_gated_geglu__prompt'

def setup_inputs():

    _w = lambda a: (lambda t: t.to(torch.bfloat16) if t.is_floating_point() else t)(torch.as_tensor(a))

    def _A_setup():
        B, S, D = (1, 2048, 512)
        return {'x': _w((lambda *s: torch.randn(*s, dtype=torch.bfloat16) * 0.05)(B, S, D)), 'wqkv': _w((lambda *s: torch.randn(*s, dtype=torch.bfloat16) * 0.05)(D, 3 * D)), 'wo': _w((lambda *s: torch.randn(*s, dtype=torch.bfloat16) * 0.05)(D, D))}
    _A_in = _A_setup()

    def _B_setup():
        B, S, Dm, Df = (1, 2048, 512, 1792)
        return {'x': _w((lambda *s: torch.randn(*s, dtype=torch.bfloat16) * 0.05)(B, S, Dm)), 'w_gate': _w((lambda *s: torch.randn(*s, dtype=torch.bfloat16) * 0.8)(Dm, Df) * Dm ** (-0.5)), 'w_up': _w((lambda *s: torch.randn(*s, dtype=torch.bfloat16) * 0.8)(Dm, Df) * Dm ** (-0.5)), 'w_down': _w((lambda *s: torch.randn(*s, dtype=torch.bfloat16) * 0.8)(Df, Dm) * Df ** (-0.5))}
    _B_in = _B_setup()
    return {'A_x': _A_in['x'], 'A_wqkv': _A_in['wqkv'], 'A_wo': _A_in['wo'], 'B_x': _B_in['x'], 'B_w_gate': _B_in['w_gate'], 'B_w_up': _B_in['w_up'], 'B_w_down': _B_in['w_down'], 'c': _w((lambda *s: torch.randn(*s, dtype=torch.bfloat16) * 0.1)(1, 512) * 8.0), 'w_mod': _w((lambda *s: torch.randn(*s, dtype=torch.bfloat16) * 0.1)(512, 6 * 512) * 512 ** (-0.5) * 8.0)}

def reference(A_x, A_wqkv, A_wo, B_x, B_w_gate, B_w_up, B_w_down, c, w_mod):

    def _A_ref(x, wqkv, wo):
        B, S, D = x.shape
        H = 32
        Dh = D // H
        qkv = (lambda x, *d: x.permute(*d))((x @ wqkv).reshape(B, S, 3, H, Dh), 2, 0, 3, 1, 4)
        q, k, v = (qkv[0], qkv[1], qkv[2])
        scale = Dh ** (-0.5)
        scores = torch.einsum('bhqd,bhkd->bhqk', q, k) * scale
        p = _softmax(scores, axis=-1)
        o = torch.einsum('bhqk,bhkd->bhqd', p, v)
        return (lambda x, *d: x.permute(*d))(o, 0, 2, 1, 3).reshape(B, S, D) @ wo

    def _B_ref(x, w_gate, w_up, w_down):
        g = torch.einsum('bsd,df->bsf', x, w_gate)
        u = torch.einsum('bsd,df->bsf', x, w_up)
        h = _gelu(g) * u
        return torch.einsum('bsf,fd->bsd', h, w_down)
    x = A_x
    mod = (_silu(c) @ w_mod).reshape(c.shape[0], 6, 1, -1)
    sa, ca, ga, sb, cb, gb = (mod[:, 0].clone(), mod[:, 1].clone(), mod[:, 2].clone(), mod[:, 3].clone(), mod[:, 4].clone(), mod[:, 5].clone())
    h = _layernorm(x, axis=-1) * (1 + ca) + sa
    x = x + ga * _A_ref(h, A_wqkv, A_wo)
    h = _layernorm(x, axis=-1) * (1 + cb) + sb
    x = x + gb * _B_ref(h, B_w_gate, B_w_up, B_w_down)
    return x
```

```asm
; @launch grid=(256,1,1) block=(256,1,1) lds=163840
.amdgcn_target "amdgcn-amd-amdhsa--gfx950"
.text
.globl adaLN_cond__softmax_full_mha__glu_gated_geglu__prompt_kernel
.p2align 8
.type adaLN_cond__softmax_full_mha__glu_gated_geglu__prompt_kernel,@function
adaLN_cond__softmax_full_mha__glu_gated_geglu__prompt_kernel:
    s_cmp_ge_u32 s2, 256
    s_cbranch_scc1 L_end
    s_load_dwordx16 s[52:67], s[0:1], 0
    s_load_dwordx8 s[68:75], s[0:1], 64
    s_getpc_b64 s[4:5]
L_pc0:
    v_lshlrev_b32 v7, 7, v0
    v_min_u32 v7, L_phaseB-L_pc0, v7
    global_load_dword v250, v7, s[4:5]
    v_lshrrev_b32 v6, 6, v0
    v_and_b32 v1, 63, v0
    v_readfirstlane_b32 s46, v6
    v_lshlrev_b32 v2, 4, v1
    s_and_b32 s44, s2, 7
    s_lshr_b32 s45, s2, 3
    s_lshl_b32 s51, s46, 8
    v_lshrrev_b32 v120, 2, v1
    v_lshlrev_b32 v120, 4, v120
    v_add_u32 v120, s51, v120
    s_mul_i32 s51, s46, 786432
    s_lshl_b32 s3, s45, 6
    s_add_u32 s51, s51, s3
    v_lshrrev_b32 v121, 2, v1
    v_mul_u32_u24 v121, 49152, v121
    v_and_b32 v6, 3, v1
    v_lshl_add_u32 v121, v6, 4, v121
    v_add_u32 v121, s51, v121
    s_mul_i32 s51, s45, 98304
    s_mul_i32 s3, s46, 24576
    s_add_u32 s51, s51, s3
    s_add_u32 s51, s51, 384
    v_and_b32 v117, 1, v1
    v_lshlrev_b32 v117, 10, v117
    v_bfe_u32 v6, v1, 1, 2
    v_mul_u32_u24 v6, 6144, v6
    v_add_u32 v117, v117, v6
    v_add_u32 v117, s51, v117
    s_getreg_b32 s49, hwreg(HW_REG_XCC_ID)
    s_and_b32 s49, s49, 15
    s_add_u32 s49, s49, 33
    s_and_b32 s24, s46, 1
    s_lshr_b32 s25, s46, 1
    s_and_b32 s26, s45, 15
    s_and_b32 s27, s45, 7
    s_waitcnt lgkmcnt(0)
    s_load_dword s47, s[74:75], 0
    s_mov_b32 s32, s66
    s_mov_b32 s33, s67
    s_mov_b32 s34, 0x400
    s_mov_b32 s35, 0x00020000
    s_mov_b32 s36, s68
    s_mov_b32 s37, s69
    s_mov_b32 s38, 0x300000
    s_mov_b32 s39, 0x00020000
    buffer_load_dwordx4 v[48:51], v120, s[32:35], 0 offen
    buffer_load_dword v251, v117, s[36:39], 0 offen
    buffer_load_dwordx4 v[16:19], v121, s[36:39], 0 offen
    s_mov_b32 s3, 6144
    buffer_load_dwordx4 v[20:23], v121, s[36:39], s3 offen
    s_mov_b32 s3, 12288
    buffer_load_dwordx4 v[24:27], v121, s[36:39], s3 offen
    s_mov_b32 s3, 18432
    buffer_load_dwordx4 v[28:31], v121, s[36:39], s3 offen
    s_mov_b32 s4, s74
    s_mov_b32 s5, s75
    s_mov_b32 s6, 0x1500000
    s_mov_b32 s7, 0x00020000
    s_mov_b32 s8, s52
    s_mov_b32 s9, s53
    s_mov_b32 s10, 0x200000
    s_mov_b32 s11, 0x00020000
    s_mov_b32 s12, s54
    s_mov_b32 s13, s55
    s_mov_b32 s14, 0x180000
    s_mov_b32 s15, 0x00020000
    s_mov_b32 s16, s56
    s_mov_b32 s17, s57
    s_mov_b32 s18, 0x80000
    s_mov_b32 s19, 0x00020000
    s_mov_b32 s28, s64
    s_mov_b32 s29, s65
    s_mov_b32 s30, 0x1c0000
    s_mov_b32 s31, 0x00020000
    s_mov_b32 s40, s70
    s_mov_b32 s41, s71
    s_mov_b32 s42, 0x200000
    s_mov_b32 s43, 0x00020000
    s_cmp_eq_u32 s24, 1
    s_cselect_b32 s20, s62, s60
    s_cselect_b32 s21, s63, s61
    s_mov_b32 s22, 0x1c0000
    s_mov_b32 s23, 0x00020000
    s_lshr_b32 s55, s45, 2
    s_and_b32 s56, s45, 1
    s_lshl_b32 s55, s55, 1
    s_add_u32 s55, s55, s56
    s_bitcmp1_b32 s45, 1
    s_cselect_b32 s50, 0x7f000000, 0
    s_cselect_b32 s48, 0, 0x7f000000
    s_mul_i32 s65, s55, 12288
    s_mul_i32 s3, s46, 3072
    s_add_u32 s65, s65, s3
    s_add_u32 s65, s65, s48
    s_lshl_b32 s62, s44, 8
    s_lshl_b32 s3, s55, 4
    s_add_u32 s62, s62, s3
    s_lshl_b32 s3, s46, 2
    s_add_u32 s62, s62, s3
    s_lshr_b32 s63, s62, 5
    s_lshl_b32 s52, s63, 7
    s_add_u32 s52, s52, 16384
    s_lshl_b32 s53, s44, 12
    s_lshl_b32 s3, s45, 7
    s_add_u32 s53, s53, s3
    s_add_u32 s53, s53, 131072
    v_mov_b32 v7, s52
    v_mov_b32 v8, s53
    v_cmp_eq_u32 vcc, 0, v1
    s_lshl_b32 s54, s62, 10
    s_add_u32 s54, s54, s50
    v_cndmask_b32 v7, v7, v8, vcc
    s_lshl_b32 s57, s26, 10
    s_lshl_b32 s3, s44, 7
    s_add_u32 s57, s57, s3
    s_add_u32 s57, s57, 81920
    v_cmp_eq_u32 vcc, 1, v1
    v_mov_b32 v8, s57
    s_nop 0
    v_cndmask_b32 v7, v7, v8, vcc
    buffer_load_dword v254, v7, s[4:7], 0 offen
    v_lshrrev_b32 v15, 5, v1
    v_lshlrev_b32 v15, 3, v15
    v_bfe_u32 v6, v1, 2, 2
    v_lshl_add_u32 v15, v6, 0, v15
    v_and_b32 v14, 1, v1
    v_lshlrev_b32 v14, 4, v14
    v_bfe_u32 v6, v1, 1, 1
    v_lshl_add_u32 v14, v6, 3, v14
    v_lshrrev_b32 v4, 5, v1
    v_lshlrev_b32 v4, 9, v4
    v_bfe_u32 v6, v1, 2, 2
    v_lshl_add_u32 v4, v6, 6, v4
    v_bfe_u32 v6, v1, 4, 1
    v_lshl_add_u32 v4, v6, 5, v4
    v_add_u32 v4, v4, v14
    v_and_b32 v10, 31, v1
    v_lshlrev_b32 v10, 2, v10
    v_and_b32 v11, 15, v1
    v_lshlrev_b32 v11, 2, v11
    v_lshlrev_b32 v13, 2, v1
    s_lshl_b32 s51, s26, 6
    v_lshrrev_b32 v255, 2, v1
    v_mul_u32_u24 v255, 3072, v255
    v_and_b32 v6, 3, v1
    v_lshl_add_u32 v255, v6, 4, v255
    v_add_u32 v255, s51, v255
    s_mul_i32 s66, s46, 98304
    s_mul_i32 s67, s46, 6144
    s_lshr_b32 s51, s45, 4
    s_lshl_b32 s64, s44, 3
    s_lshl_b32 s3, s51, 2
    s_add_u32 s64, s64, s3
    s_add_u32 s64, s64, s46
    s_lshl_b32 s51, s46, 7
    s_add_u32 s51, s51, 153600
    v_and_b32 v116, 3, v1
    v_lshlrev_b32 v116, 5, v116
    v_lshrrev_b32 v6, 5, v1
    v_lshl_add_u32 v116, v6, 3, v116
    v_bfe_u32 v6, v1, 4, 1
    v_lshl_add_u32 v116, v6, 4, v116
    v_add_u32 v116, s51, v116
    v_and_b32 v122, 3, v1
    v_lshlrev_b32 v122, 3, v122
    s_lshl_b32 s51, s46, 5
    s_add_u32 s51, s51, 153600
    v_add_u32 v123, s51, v122
    v_lshlrev_b32 v125, 5, v1
    v_lshlrev_b32 v124, 9, v1
    s_and_b32 s55, s45, 1
    s_lshl_b32 s56, s63, 15
    s_mul_i32 s3, s44, 655360
    s_add_u32 s56, s56, s3
    s_lshl_b32 s3, s55, 8
    s_add_u32 s56, s56, s3
    s_lshl_b32 s3, s25, 7
    s_add_u32 s56, s56, s3
    s_lshl_b32 s3, s24, 14
    s_add_u32 s56, s56, s3
    s_add_u32 s56, s56, s48
    s_add_u32 s56, s56, 13631488
    v_and_b32 v127, 31, v1
    v_lshlrev_b32 v127, 9, v127
    v_add_u32 v127, s56, v127
    s_mov_b32 s58, s50
    v_min_u32 v118, 23, v1
    v_lshlrev_b32 v118, 7, v118
    s_lshr_b32 s55, s45, 2
    s_and_b32 s56, s45, 1
    s_lshl_b32 s55, s55, 1
    s_add_u32 s55, s55, s56
    s_lshl_b32 s3, s44, 4
    s_add_u32 s55, s55, s3
    s_lshr_b32 s56, s55, 5
    s_and_b32 s55, s55, 31
    s_lshl_b32 s51, s56, 8
    s_lshl_b32 s3, s46, 6
    s_add_u32 s51, s51, s3
    s_add_u32 s51, s51, s58
    v_lshrrev_b32 v128, 3, v1
    v_lshlrev_b32 v128, 3, v128
    v_add_u32 v128, s51, v128
    s_mul_i32 s51, s56, 786432
    s_mul_i32 s3, s46, 196608
    s_add_u32 s51, s51, s3
    s_lshl_b32 s3, s55, 7
    s_add_u32 s51, s51, s3
    s_add_u32 s51, s51, s58
    s_add_u32 s51, s51, 2048
    v_lshrrev_b32 v129, 3, v1
    v_mul_u32_u24 v129, 24576, v129
    v_and_b32 v6, 7, v1
    v_lshl_add_u32 v129, v6, 4, v129
    v_add_u32 v129, s51, v129
    s_lshl_b32 s75, s55, 9
    s_lshl_b32 s3, s56, 14
    s_add_u32 s75, s75, s3
    s_lshl_b32 s3, s46, 7
    s_add_u32 s75, s75, s3
    s_add_u32 s75, s75, s58
    s_add_u32 s75, s75, 262144
    s_mov_b32 s3, 24576
    buffer_load_dwordx4 v[32:35], v121, s[36:39], s3 offen
    s_mov_b32 s3, 30720
    buffer_load_dwordx4 v[36:39], v121, s[36:39], s3 offen
    s_mov_b32 s3, 36864
    buffer_load_dwordx4 v[40:43], v121, s[36:39], s3 offen
    s_mov_b32 s3, 43008
    buffer_load_dwordx4 v[44:47], v121, s[36:39], s3 offen
    s_mov_b32 s74, s58
    buffer_load_dwordx4 v[160:163], v2, s[8:11], s54 offen offset:0
    buffer_load_dwordx4 v[164:167], v2, s[8:11], s54 offen offset:1024
    buffer_load_dwordx4 v[168:171], v2, s[8:11], s54 offen offset:2048
    buffer_load_dwordx4 v[172:175], v2, s[8:11], s54 offen offset:3072
    s_waitcnt lgkmcnt(0)
    s_add_u32 s49, s49, s47
    s_add_u32 s47, s47, 32
    v_mov_b32 v126, s49
    v_mov_b32 v5, s47
    s_mov_b32 s54, s53
    s_lshl_b32 s3, s46, 5
    s_add_u32 s54, s54, s3
    s_lshl_b32 s53, s44, 12
    s_add_u32 s53, s53, 131072
    s_waitcnt vmcnt(14)
    v_lshlrev_b32 v80, 16, v48
    v_and_b32 v81, 0xffff0000, v48
    v_lshlrev_b32 v82, 16, v49
    v_and_b32 v83, 0xffff0000, v49
    v_lshlrev_b32 v84, 16, v50
    v_and_b32 v85, 0xffff0000, v50
    v_lshlrev_b32 v86, 16, v51
    v_and_b32 v87, 0xffff0000, v51
    v_mul_f32 v72, 0xbfb8aa3b, v80
    v_mul_f32 v73, 0xbfb8aa3b, v81
    v_mul_f32 v74, 0xbfb8aa3b, v82
    v_mul_f32 v75, 0xbfb8aa3b, v83
    v_mul_f32 v76, 0xbfb8aa3b, v84
    v_mul_f32 v77, 0xbfb8aa3b, v85
    v_mul_f32 v78, 0xbfb8aa3b, v86
    v_mul_f32 v79, 0xbfb8aa3b, v87
    v_exp_f32 v72, v72
    v_exp_f32 v73, v73
    v_exp_f32 v74, v74
    v_exp_f32 v75, v75
    v_exp_f32 v76, v76
    v_exp_f32 v77, v77
    v_exp_f32 v78, v78
    v_exp_f32 v79, v79
    s_nop 0
    v_add_f32 v72, 1.0, v72
    v_add_f32 v73, 1.0, v73
    v_add_f32 v74, 1.0, v74
    v_add_f32 v75, 1.0, v75
    v_add_f32 v76, 1.0, v76
    v_add_f32 v77, 1.0, v77
    v_add_f32 v78, 1.0, v78
    v_add_f32 v79, 1.0, v79
    v_rcp_f32 v72, v72
    v_rcp_f32 v73, v73
    v_rcp_f32 v74, v74
    v_rcp_f32 v75, v75
    v_rcp_f32 v76, v76
    v_rcp_f32 v77, v77
    v_rcp_f32 v78, v78
    v_rcp_f32 v79, v79
    s_nop 0
    v_mul_f32 v80, v80, v72
    v_mul_f32 v81, v81, v73
    v_mul_f32 v82, v82, v74
    v_mul_f32 v83, v83, v75
    v_mul_f32 v84, v84, v76
    v_mul_f32 v85, v85, v77
    v_mul_f32 v86, v86, v78
    v_mul_f32 v87, v87, v79
    v_cvt_pk_bf16_f32 v72, v80, v81
    v_cvt_pk_bf16_f32 v74, v82, v83
    v_cvt_pk_bf16_f32 v76, v84, v85
    v_cvt_pk_bf16_f32 v78, v86, v87
    v_lshlrev_b32 v80, 16, v72
    v_and_b32 v81, 0xffff0000, v72
    v_lshlrev_b32 v82, 16, v74
    v_and_b32 v83, 0xffff0000, v74
    v_lshlrev_b32 v84, 16, v76
    v_and_b32 v85, 0xffff0000, v76
    v_lshlrev_b32 v86, 16, v78
    v_and_b32 v87, 0xffff0000, v78
    s_waitcnt vmcnt(12)
    v_lshlrev_b32 v96, 16, v16
    v_and_b32 v97, 0xffff0000, v16
    v_lshlrev_b32 v98, 16, v17
    v_and_b32 v99, 0xffff0000, v17
    v_lshlrev_b32 v100, 16, v18
    v_and_b32 v101, 0xffff0000, v18
    v_lshlrev_b32 v102, 16, v19
    v_and_b32 v103, 0xffff0000, v19
    v_pk_mul_f32 v[104:105], v[96:97], v[80:81] op_sel:[0,0] op_sel_hi:[1,0]
    v_pk_mul_f32 v[106:107], v[98:99], v[80:81] op_sel:[0,0] op_sel_hi:[1,0]
    v_pk_mul_f32 v[108:109], v[100:101], v[80:81] op_sel:[0,0] op_sel_hi:[1,0]
    v_pk_mul_f32 v[110:111], v[102:103], v[80:81] op_sel:[0,0] op_sel_hi:[1,0]
    s_waitcnt vmcnt(11)
    v_lshlrev_b32 v96, 16, v20
    v_and_b32 v97, 0xffff0000, v20
    v_lshlrev_b32 v98, 16, v21
    v_and_b32 v99, 0xffff0000, v21
    v_lshlrev_b32 v100, 16, v22
    v_and_b32 v101, 0xffff0000, v22
    v_lshlrev_b32 v102, 16, v23
    v_and_b32 v103, 0xffff0000, v23
    v_pk_fma_f32 v[104:105], v[96:97], v[80:81], v[104:105] op_sel:[0,1,0] op_sel_hi:[1,1,1]
    v_pk_fma_f32 v[106:107], v[98:99], v[80:81], v[106:107] op_sel:[0,1,0] op_sel_hi:[1,1,1]
    v_pk_fma_f32 v[108:109], v[100:101], v[80:81], v[108:109] op_sel:[0,1,0] op_sel_hi:[1,1,1]
    v_pk_fma_f32 v[110:111], v[102:103], v[80:81], v[110:111] op_sel:[0,1,0] op_sel_hi:[1,1,1]
    s_waitcnt vmcnt(10)
    v_lshlrev_b32 v96, 16, v24
    v_and_b32 v97, 0xffff0000, v24
    v_lshlrev_b32 v98, 16, v25
    v_and_b32 v99, 0xffff0000, v25
    v_lshlrev_b32 v100, 16, v26
    v_and_b32 v101, 0xffff0000, v26
    v_lshlrev_b32 v102, 16, v27
    v_and_b32 v103, 0xffff0000, v27
    v_pk_fma_f32 v[104:105], v[96:97], v[82:83], v[104:105] op_sel:[0,0,0] op_sel_hi:[1,0,1]
    v_pk_fma_f32 v[106:107], v[98:99], v[82:83], v[106:107] op_sel:[0,0,0] op_sel_hi:[1,0,1]
    v_pk_fma_f32 v[108:109], v[100:101], v[82:83], v[108:109] op_sel:[0,0,0] op_sel_hi:[1,0,1]
    v_pk_fma_f32 v[110:111], v[102:103], v[82:83], v[110:111] op_sel:[0,0,0] op_sel_hi:[1,0,1]
    s_waitcnt vmcnt(9)
    v_lshlrev_b32 v96, 16, v28
    v_and_b32 v97, 0xffff0000, v28
    v_lshlrev_b32 v98, 16, v29
    v_and_b32 v99, 0xffff0000, v29
    v_lshlrev_b32 v100, 16, v30
    v_and_b32 v101, 0xffff0000, v30
    v_lshlrev_b32 v102, 16, v31
    v_and_b32 v103, 0xffff0000, v31
    v_pk_fma_f32 v[104:105], v[96:97], v[82:83], v[104:105] op_sel:[0,1,0] op_sel_hi:[1,1,1]
    v_pk_fma_f32 v[106:107], v[98:99], v[82:83], v[106:107] op_sel:[0,1,0] op_sel_hi:[1,1,1]
    v_pk_fma_f32 v[108:109], v[100:101], v[82:83], v[108:109] op_sel:[0,1,0] op_sel_hi:[1,1,1]
    v_pk_fma_f32 v[110:111], v[102:103], v[82:83], v[110:111] op_sel:[0,1,0] op_sel_hi:[1,1,1]
    s_waitcnt vmcnt(7)
    v_lshlrev_b32 v96, 16, v32
    v_and_b32 v97, 0xffff0000, v32
    v_lshlrev_b32 v98, 16, v33
    v_and_b32 v99, 0xffff0000, v33
    v_lshlrev_b32 v100, 16, v34
    v_and_b32 v101, 0xffff0000, v34
    v_lshlrev_b32 v102, 16, v35
    v_and_b32 v103, 0xffff0000, v35
    v_pk_fma_f32 v[104:105], v[96:97], v[84:85], v[104:105] op_sel:[0,0,0] op_sel_hi:[1,0,1]
    v_pk_fma_f32 v[106:107], v[98:99], v[84:85], v[106:107] op_sel:[0,0,0] op_sel_hi:[1,0,1]
    v_pk_fma_f32 v[108:109], v[100:101], v[84:85], v[108:109] op_sel:[0,0,0] op_sel_hi:[1,0,1]
    v_pk_fma_f32 v[110:111], v[102:103], v[84:85], v[110:111] op_sel:[0,0,0] op_sel_hi:[1,0,1]
    s_waitcnt vmcnt(6)
    v_lshlrev_b32 v96, 16, v36
    v_and_b32 v97, 0xffff0000, v36
    v_lshlrev_b32 v98, 16, v37
    v_and_b32 v99, 0xffff0000, v37
    v_lshlrev_b32 v100, 16, v38
    v_and_b32 v101, 0xffff0000, v38
    v_lshlrev_b32 v102, 16, v39
    v_and_b32 v103, 0xffff0000, v39
    v_pk_fma_f32 v[104:105], v[96:97], v[84:85], v[104:105] op_sel:[0,1,0] op_sel_hi:[1,1,1]
    v_pk_fma_f32 v[106:107], v[98:99], v[84:85], v[106:107] op_sel:[0,1,0] op_sel_hi:[1,1,1]
    v_pk_fma_f32 v[108:109], v[100:101], v[84:85], v[108:109] op_sel:[0,1,0] op_sel_hi:[1,1,1]
    v_pk_fma_f32 v[110:111], v[102:103], v[84:85], v[110:111] op_sel:[0,1,0] op_sel_hi:[1,1,1]
    s_waitcnt vmcnt(5)
    v_lshlrev_b32 v96, 16, v40
    v_and_b32 v97, 0xffff0000, v40
    v_lshlrev_b32 v98, 16, v41
    v_and_b32 v99, 0xffff0000, v41
    v_lshlrev_b32 v100, 16, v42
    v_and_b32 v101, 0xffff0000, v42
    v_lshlrev_b32 v102, 16, v43
    v_and_b32 v103, 0xffff0000, v43
    v_pk_fma_f32 v[104:105], v[96:97], v[86:87], v[104:105] op_sel:[0,0,0] op_sel_hi:[1,0,1]
    v_pk_fma_f32 v[106:107], v[98:99], v[86:87], v[106:107] op_sel:[0,0,0] op_sel_hi:[1,0,1]
    v_pk_fma_f32 v[108:109], v[100:101], v[86:87], v[108:109] op_sel:[0,0,0] op_sel_hi:[1,0,1]
    v_pk_fma_f32 v[110:111], v[102:103], v[86:87], v[110:111] op_sel:[0,0,0] op_sel_hi:[1,0,1]
    s_waitcnt vmcnt(4)
    buffer_load_dword v252, v127, s[4:7], 0 offen
    v_lshlrev_b32 v96, 16, v44
    v_and_b32 v97, 0xffff0000, v44
    v_lshlrev_b32 v98, 16, v45
    v_and_b32 v99, 0xffff0000, v45
    v_lshlrev_b32 v100, 16, v46
    v_and_b32 v101, 0xffff0000, v46
    v_lshlrev_b32 v102, 16, v47
    v_and_b32 v103, 0xffff0000, v47
    v_pk_fma_f32 v[104:105], v[96:97], v[86:87], v[104:105] op_sel:[0,1,0] op_sel_hi:[1,1,1]
    v_pk_fma_f32 v[106:107], v[98:99], v[86:87], v[106:107] op_sel:[0,1,0] op_sel_hi:[1,1,1]
    v_pk_fma_f32 v[108:109], v[100:101], v[86:87], v[108:109] op_sel:[0,1,0] op_sel_hi:[1,1,1]
    v_pk_fma_f32 v[110:111], v[102:103], v[86:87], v[110:111] op_sel:[0,1,0] op_sel_hi:[1,1,1]
    s_nop 0
    v_add_f32_dpp v104, v104, v104 row_ror:8 row_mask:0xf bank_mask:0xf
    v_add_f32_dpp v105, v105, v105 row_ror:8 row_mask:0xf bank_mask:0xf
    v_add_f32_dpp v106, v106, v106 row_ror:8 row_mask:0xf bank_mask:0xf
    v_add_f32_dpp v107, v107, v107 row_ror:8 row_mask:0xf bank_mask:0xf
    v_add_f32_dpp v108, v108, v108 row_ror:8 row_mask:0xf bank_mask:0xf
    v_add_f32_dpp v109, v109, v109 row_ror:8 row_mask:0xf bank_mask:0xf
    v_add_f32_dpp v110, v110, v110 row_ror:8 row_mask:0xf bank_mask:0xf
    v_add_f32_dpp v111, v111, v111 row_ror:8 row_mask:0xf bank_mask:0xf
    v_add_f32_dpp v104, v104, v104 row_ror:4 row_mask:0xf bank_mask:0xf
    v_add_f32_dpp v105, v105, v105 row_ror:4 row_mask:0xf bank_mask:0xf
    v_add_f32_dpp v106, v106, v106 row_ror:4 row_mask:0xf bank_mask:0xf
    v_add_f32_dpp v107, v107, v107 row_ror:4 row_mask:0xf bank_mask:0xf
    v_add_f32_dpp v108, v108, v108 row_ror:4 row_mask:0xf bank_mask:0xf
    v_add_f32_dpp v109, v109, v109 row_ror:4 row_mask:0xf bank_mask:0xf
    v_add_f32_dpp v110, v110, v110 row_ror:4 row_mask:0xf bank_mask:0xf
    v_add_f32_dpp v111, v111, v111 row_ror:4 row_mask:0xf bank_mask:0xf
    s_nop 0
    v_permlane16_swap_b32 v104, v108
    v_permlane16_swap_b32 v105, v109
    v_permlane16_swap_b32 v106, v110
    v_permlane16_swap_b32 v107, v111
    v_add_f32 v104, v104, v108
    v_add_f32 v105, v105, v109
    v_add_f32 v106, v106, v110
    v_add_f32 v107, v107, v111
    s_nop 0
    v_permlane32_swap_b32 v104, v106
    v_permlane32_swap_b32 v105, v107
    v_add_f32 v104, v104, v106
    v_add_f32 v105, v105, v107
    ds_write_b64 v116, v[104:105]
    s_cmp_ge_u32 s45, 16
    s_cselect_b32 s55, 1.0, 0
    s_waitcnt lgkmcnt(0)
    s_barrier
    ds_read_b64 v[104:105], v123 offset:0
    ds_read_b64 v[106:107], v123 offset:128
    ds_read_b64 v[108:109], v123 offset:256
    ds_read_b64 v[110:111], v123 offset:384
    v_mov_b32 v113, v126
    s_waitcnt lgkmcnt(0)
    v_pk_add_f32 v[104:105], v[104:105], v[106:107]
    v_pk_add_f32 v[108:109], v[108:109], v[110:111]
    v_pk_add_f32 v[104:105], v[104:105], v[108:109]
    v_cvt_pk_bf16_f32 v106, v104, v105
    v_lshlrev_b32 v104, 16, v106
    v_and_b32 v105, 0xffff0000, v106
    v_add_f32 v104, s55, v104
    v_add_f32 v105, s55, v105
    v_cvt_pk_bf16_f32 v112, v104, v105
    buffer_store_dwordx2 v[112:113], v122, s[4:7], s54 offen
    s_add_u32 s54, s54, 32768
    v_add_u32 v123, s54, v122
    v_mov_b32 v113, v5
    s_cmp_eq_u32 s74, 0
    s_cbranch_scc1 L_rows_1
    s_add_u32 s3, s65, 0
    buffer_load_dword v253, v118, s[12:15], s3 offen
    s_add_u32 s3, s65, 196608
    buffer_load_dword v253, v118, s[12:15], s3 offen
    s_add_u32 s3, s65, 393216
    buffer_load_dword v253, v118, s[12:15], s3 offen
    s_add_u32 s3, s65, 589824
    buffer_load_dword v253, v118, s[12:15], s3 offen
    s_getpc_b64 s[68:69]
L_pc_4:
    s_lshl_b32 s70, s45, 2
    s_add_u32 s70, s70, s46
    s_lshl_b32 s70, s70, 8
    v_and_b32 v7, 1, v1
    v_lshlrev_b32 v7, 7, v7
    v_add_u32 v7, s70, v7
    v_min_u32 v7, L_u64-L_phaseB-4, v7
    v_add_u32 v7, L_phaseB-L_pc_4, v7
    global_load_dword v250, v7, s[68:69]
    s_add_u32 s3, s65, 786432
    buffer_load_dword v253, v118, s[12:15], s3 offen
    s_add_u32 s3, s65, 983040
    buffer_load_dword v253, v118, s[12:15], s3 offen
    s_add_u32 s3, s65, 1179648
    buffer_load_dword v253, v118, s[12:15], s3 offen
    s_add_u32 s3, s65, 1376256
    buffer_load_dword v253, v118, s[12:15], s3 offen
    s_lshr_b32 s55, s45, 2
    s_and_b32 s56, s45, 1
    s_lshl_b32 s55, s55, 13
    s_lshl_b32 s3, s56, 12
    s_add_u32 s55, s55, s3
    s_lshl_b32 s3, s44, 16
    s_add_u32 s55, s55, s3
    s_lshl_b32 s3, s46, 10
    s_add_u32 s55, s55, s3
    v_min_u32 v7, 896, v118
    buffer_load_dword v251, v7, s[16:19], s55 offen
    s_add_u32 m0, s67, 0
    s_add_u32 s51, s66, 0
    buffer_load_dwordx4 v255, s[12:15], s51 offen offset:0 lds
    buffer_load_dwordx4 v255, s[12:15], s51 offen offset:1024 lds
    buffer_load_dwordx4 v255, s[12:15], s51 offen offset:2048 lds
    s_add_u32 m0, s67, 3072
    s_add_u32 s51, s66, 49152
    buffer_load_dwordx4 v255, s[12:15], s51 offen offset:0 lds
    buffer_load_dwordx4 v255, s[12:15], s51 offen offset:1024 lds
    buffer_load_dwordx4 v255, s[12:15], s51 offen offset:2048 lds
    v_mov_b32 v61, v5
    s_branch L_noh1_3
L_rows_1:
    s_waitcnt vmcnt(2)
    buffer_load_dwordx2 v[176:177], v128, s[32:35], 0 offen
    buffer_load_dwordx4 v[180:183], v129, s[36:39], 0 offen
    s_mov_b32 s3, 6144
    buffer_load_dwordx4 v[184:187], v129, s[36:39], s3 offen
    s_mov_b32 s3, 12288
    buffer_load_dwordx4 v[188:191], v129, s[36:39], s3 offen
    s_mov_b32 s3, 18432
    buffer_load_dwordx4 v[192:195], v129, s[36:39], s3 offen
    v_lshlrev_b32 v16, 16, v160
    v_and_b32 v17, 0xffff0000, v160
    v_lshlrev_b32 v18, 16, v161
    v_and_b32 v19, 0xffff0000, v161
    v_lshlrev_b32 v20, 16, v162
    v_and_b32 v21, 0xffff0000, v162
    v_lshlrev_b32 v22, 16, v163
    v_and_b32 v23, 0xffff0000, v163
    v_lshlrev_b32 v24, 16, v164
    v_and_b32 v25, 0xffff0000, v164
    v_lshlrev_b32 v26, 16, v165
    v_and_b32 v27, 0xffff0000, v165
    v_lshlrev_b32 v28, 16, v166
    v_and_b32 v29, 0xffff0000, v166
    v_lshlrev_b32 v30, 16, v167
    v_and_b32 v31, 0xffff0000, v167
    v_lshlrev_b32 v32, 16, v168
    v_and_b32 v33, 0xffff0000, v168
    v_lshlrev_b32 v34, 16, v169
    v_and_b32 v35, 0xffff0000, v169
    v_lshlrev_b32 v36, 16, v170
    v_and_b32 v37, 0xffff0000, v170
    v_lshlrev_b32 v38, 16, v171
    v_and_b32 v39, 0xffff0000, v171
    v_lshlrev_b32 v40, 16, v172
    v_and_b32 v41, 0xffff0000, v172
    v_lshlrev_b32 v42, 16, v173
    v_and_b32 v43, 0xffff0000, v173
    v_lshlrev_b32 v44, 16, v174
    v_and_b32 v45, 0xffff0000, v174
    v_lshlrev_b32 v46, 16, v175
    v_and_b32 v47, 0xffff0000, v175
    v_pk_add_f32 v[48:49], v[16:17], v[18:19]
    v_pk_add_f32 v[50:51], v[20:21], v[22:23]
    v_pk_add_f32 v[48:49], v[48:49], v[50:51]
    v_add_f32 v64, v48, v49
    v_pk_add_f32 v[52:53], v[24:25], v[26:27]
    v_pk_add_f32 v[54:55], v[28:29], v[30:31]
    v_pk_add_f32 v[52:53], v[52:53], v[54:55]
    v_add_f32 v66, v52, v53
    v_pk_add_f32 v[56:57], v[32:33], v[34:35]
    v_pk_add_f32 v[58:59], v[36:37], v[38:39]
    v_pk_add_f32 v[56:57], v[56:57], v[58:59]
    v_add_f32 v68, v56, v57
    v_pk_add_f32 v[60:61], v[40:41], v[42:43]
    v_pk_add_f32 v[62:63], v[44:45], v[46:47]
    v_pk_add_f32 v[60:61], v[60:61], v[62:63]
    v_add_f32 v70, v60, v61
    v_add_f32_dpp v64, v64, v64 row_ror:8 row_mask:0xf bank_mask:0xf
    v_add_f32_dpp v66, v66, v66 row_ror:8 row_mask:0xf bank_mask:0xf
    v_add_f32_dpp v68, v68, v68 row_ror:8 row_mask:0xf bank_mask:0xf
    v_add_f32_dpp v70, v70, v70 row_ror:8 row_mask:0xf bank_mask:0xf
    v_add_f32_dpp v64, v64, v64 row_ror:4 row_mask:0xf bank_mask:0xf
    v_add_f32_dpp v66, v66, v66 row_ror:4 row_mask:0xf bank_mask:0xf
    v_add_f32_dpp v68, v68, v68 row_ror:4 row_mask:0xf bank_mask:0xf
    v_add_f32_dpp v70, v70, v70 row_ror:4 row_mask:0xf bank_mask:0xf
    v_add_f32_dpp v64, v64, v64 row_ror:2 row_mask:0xf bank_mask:0xf
    v_add_f32_dpp v66, v66, v66 row_ror:2 row_mask:0xf bank_mask:0xf
    v_add_f32_dpp v68, v68, v68 row_ror:2 row_mask:0xf bank_mask:0xf
    v_add_f32_dpp v70, v70, v70 row_ror:2 row_mask:0xf bank_mask:0xf
    v_add_f32_dpp v64, v64, v64 row_ror:1 row_mask:0xf bank_mask:0xf
    v_add_f32_dpp v66, v66, v66 row_ror:1 row_mask:0xf bank_mask:0xf
    v_add_f32_dpp v68, v68, v68 row_ror:1 row_mask:0xf bank_mask:0xf
    v_add_f32_dpp v70, v70, v70 row_ror:1 row_mask:0xf bank_mask:0xf
    v_mov_b32 v48, v64
    v_mov_b32 v49, v66
    v_mov_b32 v50, v68
    v_mov_b32 v51, v70
    v_permlane16_swap_b32 v64, v48
    v_permlane16_swap_b32 v66, v49
    v_permlane16_swap_b32 v68, v50
    v_permlane16_swap_b32 v70, v51
    v_add_f32 v64, v64, v48
    v_add_f32 v66, v66, v49
    v_add_f32 v68, v68, v50
    v_add_f32 v70, v70, v51
    v_mov_b32 v48, v64
    v_mov_b32 v49, v66
    v_mov_b32 v50, v68
    v_mov_b32 v51, v70
    v_permlane32_swap_b32 v64, v48
    v_permlane32_swap_b32 v66, v49
    v_permlane32_swap_b32 v68, v50
    v_permlane32_swap_b32 v70, v51
    v_add_f32 v64, v64, v48
    v_add_f32 v66, v66, v49
    v_add_f32 v68, v68, v50
    v_add_f32 v70, v70, v51
    v_mul_f32 v64, 0x3b000000, v64
    v_mul_f32 v66, 0x3b000000, v66
    v_mul_f32 v68, 0x3b000000, v68
    v_mul_f32 v70, 0x3b000000, v70
    v_pk_add_f32 v[48:49], v[16:17], v[64:65] op_sel_hi:[1,0] neg_lo:[0,1] neg_hi:[0,1]
    v_pk_add_f32 v[50:51], v[18:19], v[64:65] op_sel_hi:[1,0] neg_lo:[0,1] neg_hi:[0,1]
    v_pk_add_f32 v[52:53], v[20:21], v[64:65] op_sel_hi:[1,0] neg_lo:[0,1] neg_hi:[0,1]
    v_pk_add_f32 v[54:55], v[22:23], v[64:65] op_sel_hi:[1,0] neg_lo:[0,1] neg_hi:[0,1]
    v_pk_mul_f32 v[56:57], v[48:49], v[48:49]
    v_pk_fma_f32 v[56:57], v[50:51], v[50:51], v[56:57]
    v_pk_fma_f32 v[56:57], v[52:53], v[52:53], v[56:57]
    v_pk_fma_f32 v[56:57], v[54:55], v[54:55], v[56:57]
    v_add_f32 v72, v56, v57
    v_pk_add_f32 v[48:49], v[24:25], v[66:67] op_sel_hi:[1,0] neg_lo:[0,1] neg_hi:[0,1]
    v_pk_add_f32 v[50:51], v[26:27], v[66:67] op_sel_hi:[1,0] neg_lo:[0,1] neg_hi:[0,1]
    v_pk_add_f32 v[52:53], v[28:29], v[66:67] op_sel_hi:[1,0] neg_lo:[0,1] neg_hi:[0,1]
    v_pk_add_f32 v[54:55], v[30:31], v[66:67] op_sel_hi:[1,0] neg_lo:[0,1] neg_hi:[0,1]
    v_pk_mul_f32 v[56:57], v[48:49], v[48:49]
    v_pk_fma_f32 v[56:57], v[50:51], v[50:51], v[56:57]
    v_pk_fma_f32 v[56:57], v[52:53], v[52:53], v[56:57]
    v_pk_fma_f32 v[56:57], v[54:55], v[54:55], v[56:57]
    v_add_f32 v74, v56, v57
    v_pk_add_f32 v[48:49], v[32:33], v[68:69] op_sel_hi:[1,0] neg_lo:[0,1] neg_hi:[0,1]
    v_pk_add_f32 v[50:51], v[34:35], v[68:69] op_sel_hi:[1,0] neg_lo:[0,1] neg_hi:[0,1]
    v_pk_add_f32 v[52:53], v[36:37], v[68:69] op_sel_hi:[1,0] neg_lo:[0,1] neg_hi:[0,1]
    v_pk_add_f32 v[54:55], v[38:39], v[68:69] op_sel_hi:[1,0] neg_lo:[0,1] neg_hi:[0,1]
    v_pk_mul_f32 v[56:57], v[48:49], v[48:49]
    v_pk_fma_f32 v[56:57], v[50:51], v[50:51], v[56:57]
    v_pk_fma_f32 v[56:57], v[52:53], v[52:53], v[56:57]
    v_pk_fma_f32 v[56:57], v[54:55], v[54:55], v[56:57]
    v_add_f32 v76, v56, v57
    v_pk_add_f32 v[48:49], v[40:41], v[70:71] op_sel_hi:[1,0] neg_lo:[0,1] neg_hi:[0,1]
    v_pk_add_f32 v[50:51], v[42:43], v[70:71] op_sel_hi:[1,0] neg_lo:[0,1] neg_hi:[0,1]
    v_pk_add_f32 v[52:53], v[44:45], v[70:71] op_sel_hi:[1,0] neg_lo:[0,1] neg_hi:[0,1]
    v_pk_add_f32 v[54:55], v[46:47], v[70:71] op_sel_hi:[1,0] neg_lo:[0,1] neg_hi:[0,1]
    v_pk_mul_f32 v[56:57], v[48:49], v[48:49]
    v_pk_fma_f32 v[56:57], v[50:51], v[50:51], v[56:57]
    v_pk_fma_f32 v[56:57], v[52:53], v[52:53], v[56:57]
    v_pk_fma_f32 v[56:57], v[54:55], v[54:55], v[56:57]
    v_add_f32 v78, v56, v57
    v_add_f32_dpp v72, v72, v72 row_ror:8 row_mask:0xf bank_mask:0xf
    v_add_f32_dpp v74, v74, v74 row_ror:8 row_mask:0xf bank_mask:0xf
    v_add_f32_dpp v76, v76, v76 row_ror:8 row_mask:0xf bank_mask:0xf
    v_add_f32_dpp v78, v78, v78 row_ror:8 row_mask:0xf bank_mask:0xf
    v_add_f32_dpp v72, v72, v72 row_ror:4 row_mask:0xf bank_mask:0xf
    v_add_f32_dpp v74, v74, v74 row_ror:4 row_mask:0xf bank_mask:0xf
    v_add_f32_dpp v76, v76, v76 row_ror:4 row_mask:0xf bank_mask:0xf
    v_add_f32_dpp v78, v78, v78 row_ror:4 row_mask:0xf bank_mask:0xf
    v_add_f32_dpp v72, v72, v72 row_ror:2 row_mask:0xf bank_mask:0xf
    v_add_f32_dpp v74, v74, v74 row_ror:2 row_mask:0xf bank_mask:0xf
    v_add_f32_dpp v76, v76, v76 row_ror:2 row_mask:0xf bank_mask:0xf
    v_add_f32_dpp v78, v78, v78 row_ror:2 row_mask:0xf bank_mask:0xf
    v_add_f32_dpp v72, v72, v72 row_ror:1 row_mask:0xf bank_mask:0xf
    v_add_f32_dpp v74, v74, v74 row_ror:1 row_mask:0xf bank_mask:0xf
    v_add_f32_dpp v76, v76, v76 row_ror:1 row_mask:0xf bank_mask:0xf
    v_add_f32_dpp v78, v78, v78 row_ror:1 row_mask:0xf bank_mask:0xf
    v_mov_b32 v48, v72
    v_mov_b32 v49, v74
    v_mov_b32 v50, v76
    v_mov_b32 v51, v78
    v_permlane16_swap_b32 v72, v48
    v_permlane16_swap_b32 v74, v49
    v_permlane16_swap_b32 v76, v50
    v_permlane16_swap_b32 v78, v51
    v_add_f32 v72, v72, v48
    v_add_f32 v74, v74, v49
    v_add_f32 v76, v76, v50
    v_add_f32 v78, v78, v51
    v_mov_b32 v48, v72
    v_mov_b32 v49, v74
    v_mov_b32 v50, v76
    v_mov_b32 v51, v78
    v_permlane32_swap_b32 v72, v48
    v_permlane32_swap_b32 v74, v49
    v_permlane32_swap_b32 v76, v50
    v_permlane32_swap_b32 v78, v51
    v_add_f32 v72, v72, v48
    v_add_f32 v74, v74, v49
    v_add_f32 v76, v76, v50
    v_add_f32 v78, v78, v51
    v_mul_f32 v72, 0x3b000000, v72
    v_mul_f32 v74, 0x3b000000, v74
    v_mul_f32 v76, 0x3b000000, v76
    v_mul_f32 v78, 0x3b000000, v78
    v_cvt_pk_bf16_f32 v64, v64, v64
    v_and_b32 v64, 0xffff0000, v64
    v_cvt_pk_bf16_f32 v66, v66, v66
    v_and_b32 v66, 0xffff0000, v66
    v_cvt_pk_bf16_f32 v68, v68, v68
    v_and_b32 v68, 0xffff0000, v68
    v_cvt_pk_bf16_f32 v70, v70, v70
    v_and_b32 v70, 0xffff0000, v70
    v_cvt_pk_bf16_f32 v72, v72, v72
    v_and_b32 v72, 0xffff0000, v72
    v_cvt_pk_bf16_f32 v74, v74, v74
    v_and_b32 v74, 0xffff0000, v74
    v_cvt_pk_bf16_f32 v76, v76, v76
    v_and_b32 v76, 0xffff0000, v76
    v_cvt_pk_bf16_f32 v78, v78, v78
    v_and_b32 v78, 0xffff0000, v78
    v_add_f32 v72, 0x3727c5ac, v72
    v_add_f32 v74, 0x3727c5ac, v74
    v_add_f32 v76, 0x3727c5ac, v76
    v_add_f32 v78, 0x3727c5ac, v78
    v_cvt_pk_bf16_f32 v72, v72, v72
    v_and_b32 v72, 0xffff0000, v72
    v_cvt_pk_bf16_f32 v74, v74, v74
    v_and_b32 v74, 0xffff0000, v74
    v_cvt_pk_bf16_f32 v76, v76, v76
    v_and_b32 v76, 0xffff0000, v76
    v_cvt_pk_bf16_f32 v78, v78, v78
    v_and_b32 v78, 0xffff0000, v78
    v_sqrt_f32 v72, v72
    v_sqrt_f32 v74, v74
    v_sqrt_f32 v76, v76
    v_sqrt_f32 v78, v78
    v_cvt_pk_bf16_f32 v72, v72, v72
    v_and_b32 v72, 0xffff0000, v72
    v_cvt_pk_bf16_f32 v74, v74, v74
    v_and_b32 v74, 0xffff0000, v74
    v_cvt_pk_bf16_f32 v76, v76, v76
    v_and_b32 v76, 0xffff0000, v76
    v_cvt_pk_bf16_f32 v78, v78, v78
    v_and_b32 v78, 0xffff0000, v78
    v_rcp_f32 v72, v72
    v_rcp_f32 v74, v74
    v_rcp_f32 v76, v76
    v_rcp_f32 v78, v78
    s_nop 0
    v_pk_add_f32 v[16:17], v[16:17], v[64:65] op_sel_hi:[1,0] neg_lo:[0,1] neg_hi:[0,1]
    v_pk_add_f32 v[18:19], v[18:19], v[64:65] op_sel_hi:[1,0] neg_lo:[0,1] neg_hi:[0,1]
    v_pk_add_f32 v[20:21], v[20:21], v[64:65] op_sel_hi:[1,0] neg_lo:[0,1] neg_hi:[0,1]
    v_pk_add_f32 v[22:23], v[22:23], v[64:65] op_sel_hi:[1,0] neg_lo:[0,1] neg_hi:[0,1]
    v_pk_mul_f32 v[16:17], v[16:17], v[72:73] op_sel_hi:[1,0]
    v_pk_mul_f32 v[18:19], v[18:19], v[72:73] op_sel_hi:[1,0]
    v_pk_mul_f32 v[20:21], v[20:21], v[72:73] op_sel_hi:[1,0]
    v_pk_mul_f32 v[22:23], v[22:23], v[72:73] op_sel_hi:[1,0]
    v_pk_add_f32 v[24:25], v[24:25], v[66:67] op_sel_hi:[1,0] neg_lo:[0,1] neg_hi:[0,1]
    v_pk_add_f32 v[26:27], v[26:27], v[66:67] op_sel_hi:[1,0] neg_lo:[0,1] neg_hi:[0,1]
    v_pk_add_f32 v[28:29], v[28:29], v[66:67] op_sel_hi:[1,0] neg_lo:[0,1] neg_hi:[0,1]
    v_pk_add_f32 v[30:31], v[30:31], v[66:67] op_sel_hi:[1,0] neg_lo:[0,1] neg_hi:[0,1]
    v_pk_mul_f32 v[24:25], v[24:25], v[74:75] op_sel_hi:[1,0]
    v_pk_mul_f32 v[26:27], v[26:27], v[74:75] op_sel_hi:[1,0]
    v_pk_mul_f32 v[28:29], v[28:29], v[74:75] op_sel_hi:[1,0]
    v_pk_mul_f32 v[30:31], v[30:31], v[74:75] op_sel_hi:[1,0]
    v_pk_add_f32 v[32:33], v[32:33], v[68:69] op_sel_hi:[1,0] neg_lo:[0,1] neg_hi:[0,1]
    v_pk_add_f32 v[34:35], v[34:35], v[68:69] op_sel_hi:[1,0] neg_lo:[0,1] neg_hi:[0,1]
    v_pk_add_f32 v[36:37], v[36:37], v[68:69] op_sel_hi:[1,0] neg_lo:[0,1] neg_hi:[0,1]
    v_pk_add_f32 v[38:39], v[38:39], v[68:69] op_sel_hi:[1,0] neg_lo:[0,1] neg_hi:[0,1]
    v_pk_mul_f32 v[32:33], v[32:33], v[76:77] op_sel_hi:[1,0]
    v_pk_mul_f32 v[34:35], v[34:35], v[76:77] op_sel_hi:[1,0]
    v_pk_mul_f32 v[36:37], v[36:37], v[76:77] op_sel_hi:[1,0]
    v_pk_mul_f32 v[38:39], v[38:39], v[76:77] op_sel_hi:[1,0]
    v_pk_add_f32 v[40:41], v[40:41], v[70:71] op_sel_hi:[1,0] neg_lo:[0,1] neg_hi:[0,1]
    v_pk_add_f32 v[42:43], v[42:43], v[70:71] op_sel_hi:[1,0] neg_lo:[0,1] neg_hi:[0,1]
    v_pk_add_f32 v[44:45], v[44:45], v[70:71] op_sel_hi:[1,0] neg_lo:[0,1] neg_hi:[0,1]
    v_pk_add_f32 v[46:47], v[46:47], v[70:71] op_sel_hi:[1,0] neg_lo:[0,1] neg_hi:[0,1]
    v_pk_mul_f32 v[40:41], v[40:41], v[78:79] op_sel_hi:[1,0]
    v_pk_mul_f32 v[42:43], v[42:43], v[78:79] op_sel_hi:[1,0]
    v_pk_mul_f32 v[44:45], v[44:45], v[78:79] op_sel_hi:[1,0]
    v_pk_mul_f32 v[46:47], v[46:47], v[78:79] op_sel_hi:[1,0]
    s_and_b32 s56, s62, 31
    s_lshl_b32 s54, s63, 15
    s_mul_i32 s3, s44, 655360
    s_add_u32 s54, s54, s3
    s_lshl_b32 s3, s56, 4
    s_add_u32 s54, s54, s3
    s_add_u32 s54, s54, 13631488
    s_lshl_b32 s55, s63, 7
    s_add_u32 s55, s55, s56
    s_add_u32 s55, s55, 16384
    s_mul_i32 s51, s46, 4160
    s_add_u32 s51, s51, 102400
    v_add_u32 v114, s51, v2
    v_and_b32 v115, 3, v1
    v_mul_u32_u24 v115, 1040, v115
    v_lshrrev_b32 v6, 2, v1
    v_lshl_add_u32 v115, v6, 6, v115
    v_add_u32 v115, s51, v115
    v_and_b32 v124, 3, v1
    v_lshlrev_b32 v124, 4, v124
    v_lshrrev_b32 v6, 2, v1
    v_lshl_add_u32 v124, v6, 11, v124
    v_mov_b64 v[60:61], 0
    s_mov_b32 s50, 48
    s_mov_b32 s48, 1
L_ma_5:
    buffer_load_dwordx4 v[64:67], v125, s[4:7], s53 offen offset:0 sc1
    buffer_load_dwordx4 v[68:71], v125, s[4:7], s53 offen offset:16 sc1
    buffer_load_dwordx4 v[72:75], v125, s[4:7], s53 offen offset:2048 sc1
    buffer_load_dwordx4 v[76:79], v125, s[4:7], s53 offen offset:2064 sc1
    s_sub_u32 s50, s50, 1
    s_waitcnt vmcnt(0)
    v_xor_b32 v65, v126, v65
    v_xor_b32 v67, v126, v67
    v_xor_b32 v69, v126, v69
    v_xor_b32 v71, v126, v71
    v_xor_b32 v73, v126, v73
    v_xor_b32 v75, v126, v75
    v_xor_b32 v77, v126, v77
    v_xor_b32 v79, v126, v79
    v_or3_b32 v6, v65, v67, v69
    v_or3_b32 v7, v71, v73, v75
    v_or3_b32 v6, v6, v77, v79
    v_or_b32 v6, v6, v7
    v_cmp_ne_u32 vcc, 0, v6
    s_cbranch_scc1 L_maretry_6
    s_cbranch_vccnz L_ma_5
L_madone_8:
    v_lshlrev_b32 v96, 16, v64
    v_and_b32 v97, 0xffff0000, v64
    v_lshlrev_b32 v98, 16, v66
    v_and_b32 v99, 0xffff0000, v66
    v_lshlrev_b32 v100, 16, v68
    v_and_b32 v101, 0xffff0000, v68
    v_lshlrev_b32 v102, 16, v70
    v_and_b32 v103, 0xffff0000, v70
    v_lshlrev_b32 v104, 16, v72
    v_and_b32 v105, 0xffff0000, v72
    v_lshlrev_b32 v106, 16, v74
    v_and_b32 v107, 0xffff0000, v74
    v_lshlrev_b32 v108, 16, v76
    v_and_b32 v109, 0xffff0000, v76
    v_lshlrev_b32 v110, 16, v78
    v_and_b32 v111, 0xffff0000, v78
    v_pk_fma_f32 v[16:17], v[16:17], v[104:105], v[96:97]
    v_pk_fma_f32 v[18:19], v[18:19], v[106:107], v[98:99]
    v_pk_fma_f32 v[20:21], v[20:21], v[108:109], v[100:101]
    v_pk_fma_f32 v[22:23], v[22:23], v[110:111], v[102:103]
    v_cvt_pk_bf16_f32 v48, v16, v17
    v_cvt_pk_bf16_f32 v49, v18, v19
    v_cvt_pk_bf16_f32 v50, v20, v21
    v_cvt_pk_bf16_f32 v51, v22, v23
    ds_write_b128 v114, v[48:51] offset:0
    v_pk_fma_f32 v[24:25], v[24:25], v[104:105], v[96:97]
    v_pk_fma_f32 v[26:27], v[26:27], v[106:107], v[98:99]
    v_pk_fma_f32 v[28:29], v[28:29], v[108:109], v[100:101]
    v_pk_fma_f32 v[30:31], v[30:31], v[110:111], v[102:103]
    v_cvt_pk_bf16_f32 v52, v24, v25
    v_cvt_pk_bf16_f32 v53, v26, v27
    v_cvt_pk_bf16_f32 v54, v28, v29
    v_cvt_pk_bf16_f32 v55, v30, v31
    ds_write_b128 v114, v[52:55] offset:1040
    v_pk_fma_f32 v[32:33], v[32:33], v[104:105], v[96:97]
    v_pk_fma_f32 v[34:35], v[34:35], v[106:107], v[98:99]
    v_pk_fma_f32 v[36:37], v[36:37], v[108:109], v[100:101]
    v_pk_fma_f32 v[38:39], v[38:39], v[110:111], v[102:103]
    v_cvt_pk_bf16_f32 v56, v32, v33
    v_cvt_pk_bf16_f32 v57, v34, v35
    v_cvt_pk_bf16_f32 v58, v36, v37
    v_cvt_pk_bf16_f32 v59, v38, v39
    ds_write_b128 v114, v[56:59] offset:2080
    v_pk_fma_f32 v[40:41], v[40:41], v[104:105], v[96:97]
    v_pk_fma_f32 v[42:43], v[42:43], v[106:107], v[98:99]
    v_pk_fma_f32 v[44:45], v[44:45], v[108:109], v[100:101]
    v_pk_fma_f32 v[46:47], v[46:47], v[110:111], v[102:103]
    v_cvt_pk_bf16_f32 v60, v40, v41
    v_cvt_pk_bf16_f32 v61, v42, v43
    v_cvt_pk_bf16_f32 v62, v44, v45
    v_cvt_pk_bf16_f32 v63, v46, v47
    ds_write_b128 v114, v[60:63] offset:3120
    s_waitcnt lgkmcnt(0)
    ds_read_b128 v[16:19], v115 offset:0
    ds_read_b128 v[20:23], v115 offset:16
    ds_read_b128 v[24:27], v115 offset:32
    ds_read_b128 v[28:31], v115 offset:48
    s_cmp_eq_u32 s48, 0
    s_cbranch_scc1 L_slow_9
    s_waitcnt lgkmcnt(3)
    buffer_store_dwordx4 v[16:19], v124, s[4:7], s54 offen offset:0
    s_waitcnt lgkmcnt(2)
    buffer_store_dwordx4 v[20:23], v124, s[4:7], s54 offen offset:512
    s_waitcnt lgkmcnt(1)
    buffer_store_dwordx4 v[24:27], v124, s[4:7], s54 offen offset:1024
    s_waitcnt lgkmcnt(0)
    buffer_store_dwordx4 v[28:31], v124, s[4:7], s54 offen offset:1536
    s_waitcnt vmcnt(0)
    buffer_store_dword v5, off, s[4:7], s55
L_st_10:
    s_add_u32 m0, s67, 0
    s_add_u32 s51, s66, 0
    buffer_load_dwordx4 v255, s[12:15], s51 offen offset:0 lds
    buffer_load_dwordx4 v255, s[12:15], s51 offen offset:1024 lds
    buffer_load_dwordx4 v255, s[12:15], s51 offen offset:2048 lds
    s_add_u32 m0, s67, 3072
    s_add_u32 s51, s66, 49152
    buffer_load_dwordx4 v255, s[12:15], s51 offen offset:0 lds
    buffer_load_dwordx4 v255, s[12:15], s51 offen offset:1024 lds
    buffer_load_dwordx4 v255, s[12:15], s51 offen offset:2048 lds
    v_lshlrev_b32 v80, 16, v176
    v_and_b32 v81, 0xffff0000, v176
    v_lshlrev_b32 v82, 16, v177
    v_and_b32 v83, 0xffff0000, v177
    v_mul_f32 v72, 0xbfb8aa3b, v80
    v_mul_f32 v73, 0xbfb8aa3b, v81
    v_mul_f32 v74, 0xbfb8aa3b, v82
    v_mul_f32 v75, 0xbfb8aa3b, v83
    v_exp_f32 v72, v72
    v_exp_f32 v73, v73
    v_exp_f32 v74, v74
    v_exp_f32 v75, v75
    s_nop 0
    v_add_f32 v72, 1.0, v72
    v_add_f32 v73, 1.0, v73
    v_add_f32 v74, 1.0, v74
    v_add_f32 v75, 1.0, v75
    v_rcp_f32 v72, v72
    v_rcp_f32 v73, v73
    v_rcp_f32 v74, v74
    v_rcp_f32 v75, v75
    s_nop 0
    v_mul_f32 v80, v80, v72
    v_mul_f32 v81, v81, v73
    v_mul_f32 v82, v82, v74
    v_mul_f32 v83, v83, v75
    v_cvt_pk_bf16_f32 v72, v80, v81
    v_cvt_pk_bf16_f32 v74, v82, v83
    v_lshlrev_b32 v80, 16, v72
    v_and_b32 v81, 0xffff0000, v72
    v_lshlrev_b32 v82, 16, v74
    v_and_b32 v83, 0xffff0000, v74
    v_lshlrev_b32 v96, 16, v180
    v_and_b32 v97, 0xffff0000, v180
    v_lshlrev_b32 v98, 16, v181
    v_and_b32 v99, 0xffff0000, v181
    v_lshlrev_b32 v100, 16, v182
    v_and_b32 v101, 0xffff0000, v182
    v_lshlrev_b32 v102, 16, v183
    v_and_b32 v103, 0xffff0000, v183
    v_pk_mul_f32 v[104:105], v[96:97], v[80:81] op_sel:[0,0] op_sel_hi:[1,0]
    v_pk_mul_f32 v[106:107], v[98:99], v[80:81] op_sel:[0,0] op_sel_hi:[1,0]
    v_pk_mul_f32 v[108:109], v[100:101], v[80:81] op_sel:[0,0] op_sel_hi:[1,0]
    v_pk_mul_f32 v[110:111], v[102:103], v[80:81] op_sel:[0,0] op_sel_hi:[1,0]
    v_lshlrev_b32 v96, 16, v184
    v_and_b32 v97, 0xffff0000, v184
    v_lshlrev_b32 v98, 16, v185
    v_and_b32 v99, 0xffff0000, v185
    v_lshlrev_b32 v100, 16, v186
    v_and_b32 v101, 0xffff0000, v186
    v_lshlrev_b32 v102, 16, v187
    v_and_b32 v103, 0xffff0000, v187
    v_pk_fma_f32 v[104:105], v[96:97], v[80:81], v[104:105] op_sel:[0,1,0] op_sel_hi:[1,1,1]
    v_pk_fma_f32 v[106:107], v[98:99], v[80:81], v[106:107] op_sel:[0,1,0] op_sel_hi:[1,1,1]
    v_pk_fma_f32 v[108:109], v[100:101], v[80:81], v[108:109] op_sel:[0,1,0] op_sel_hi:[1,1,1]
    v_pk_fma_f32 v[110:111], v[102:103], v[80:81], v[110:111] op_sel:[0,1,0] op_sel_hi:[1,1,1]
    v_lshlrev_b32 v96, 16, v188
    v_and_b32 v97, 0xffff0000, v188
    v_lshlrev_b32 v98, 16, v189
    v_and_b32 v99, 0xffff0000, v189
    v_lshlrev_b32 v100, 16, v190
    v_and_b32 v101, 0xffff0000, v190
    v_lshlrev_b32 v102, 16, v191
    v_and_b32 v103, 0xffff0000, v191
    v_pk_fma_f32 v[104:105], v[96:97], v[82:83], v[104:105] op_sel:[0,0,0] op_sel_hi:[1,0,1]
    v_pk_fma_f32 v[106:107], v[98:99], v[82:83], v[106:107] op_sel:[0,0,0] op_sel_hi:[1,0,1]
    v_pk_fma_f32 v[108:109], v[100:101], v[82:83], v[108:109] op_sel:[0,0,0] op_sel_hi:[1,0,1]
    v_pk_fma_f32 v[110:111], v[102:103], v[82:83], v[110:111] op_sel:[0,0,0] op_sel_hi:[1,0,1]
    v_lshlrev_b32 v96, 16, v192
    v_and_b32 v97, 0xffff0000, v192
    v_lshlrev_b32 v98, 16, v193
    v_and_b32 v99, 0xffff0000, v193
    v_lshlrev_b32 v100, 16, v194
    v_and_b32 v101, 0xffff0000, v194
    v_lshlrev_b32 v102, 16, v195
    v_and_b32 v103, 0xffff0000, v195
    v_pk_fma_f32 v[104:105], v[96:97], v[82:83], v[104:105] op_sel:[0,1,0] op_sel_hi:[1,1,1]
    v_pk_fma_f32 v[106:107], v[98:99], v[82:83], v[106:107] op_sel:[0,1,0] op_sel_hi:[1,1,1]
    v_pk_fma_f32 v[108:109], v[100:101], v[82:83], v[108:109] op_sel:[0,1,0] op_sel_hi:[1,1,1]
    v_pk_fma_f32 v[110:111], v[102:103], v[82:83], v[110:111] op_sel:[0,1,0] op_sel_hi:[1,1,1]
    s_nop 0
    v_add_f32_dpp v104, v104, v104 row_ror:8 row_mask:0xf bank_mask:0xf
    v_add_f32_dpp v105, v105, v105 row_ror:8 row_mask:0xf bank_mask:0xf
    v_add_f32_dpp v106, v106, v106 row_ror:8 row_mask:0xf bank_mask:0xf
    v_add_f32_dpp v107, v107, v107 row_ror:8 row_mask:0xf bank_mask:0xf
    v_add_f32_dpp v108, v108, v108 row_ror:8 row_mask:0xf bank_mask:0xf
    v_add_f32_dpp v109, v109, v109 row_ror:8 row_mask:0xf bank_mask:0xf
    v_add_f32_dpp v110, v110, v110 row_ror:8 row_mask:0xf bank_mask:0xf
    v_add_f32_dpp v111, v111, v111 row_ror:8 row_mask:0xf bank_mask:0xf
    s_nop 0
    v_permlane16_swap_b32 v104, v108
    v_permlane16_swap_b32 v105, v109
    v_permlane16_swap_b32 v106, v110
    v_permlane16_swap_b32 v107, v111
    v_add_f32 v104, v104, v108
    v_add_f32 v105, v105, v109
    v_add_f32 v106, v106, v110
    v_add_f32 v107, v107, v111
    s_nop 0
    v_permlane32_swap_b32 v104, v106
    v_permlane32_swap_b32 v105, v107
    v_add_f32 v104, v104, v106
    v_add_f32 v105, v105, v107
    s_lshl_b32 s51, s46, 8
    s_add_u32 s51, s51, 154112
    v_and_b32 v7, 7, v1
    v_lshlrev_b32 v7, 5, v7
    v_lshrrev_b32 v6, 5, v1
    v_lshl_add_u32 v7, v6, 3, v7
    v_bfe_u32 v6, v1, 4, 1
    v_lshl_add_u32 v7, v6, 4, v7
    v_add_u32 v7, s51, v7
    ds_write_b64 v7, v[104:105]
    s_lshl_b32 s51, s46, 6
    s_add_u32 s51, s51, 154112
    v_add_u32 v7, s51, v11
    s_waitcnt lgkmcnt(0)
    s_barrier
    ds_read_b32 v40, v7 offset:0
    ds_read_b32 v41, v7 offset:256
    ds_read_b32 v42, v7 offset:512
    ds_read_b32 v43, v7 offset:768
    s_waitcnt lgkmcnt(0)
    v_add_f32 v40, v40, v41
    v_add_f32 v42, v42, v43
    v_add_f32 v60, v40, v42
    v_mov_b32 v61, v5
L_noh1_3:
L_phaseB:
    s_lshl_b32 s52, s64, 7
    s_add_u32 s52, s52, 16384
    s_lshl_b32 s53, s64, 15
    s_mul_i32 s3, s44, 655360
    s_add_u32 s53, s53, s3
    s_add_u32 s53, s53, 13631488
    v_add_u32 v12, 49152, v4
    v_and_b32 v7, 7, v1
    v_lshlrev_b32 v7, 2, v7
    s_mov_b32 s50, 64
L_h1_11:
    buffer_load_dword v6, v7, s[4:7], s52 offen sc1
    s_sub_u32 s50, s50, 1
    s_waitcnt vmcnt(0)
    v_cmp_ne_u32 vcc, s47, v6
    s_cbranch_scc1 L_h1late_12
    s_cbranch_vccnz L_h1_11
L_h1got_13:
    s_lshl_b32 s54, s44, 12
    s_add_u32 s54, s54, 131072
    v_lshlrev_b32 v125, 6, v1
    buffer_load_dwordx4 a[0:3], v2, s[4:7], s53 offen offset:0 sc1
    buffer_load_dwordx4 a[4:7], v2, s[4:7], s53 offen offset:1024 sc1
    buffer_load_dwordx4 a[8:11], v2, s[4:7], s53 offen offset:2048 sc1
    buffer_load_dwordx4 a[12:15], v2, s[4:7], s53 offen offset:3072 sc1
    s_add_u32 s53, s53, 4096
    buffer_load_dwordx4 a[16:19], v2, s[4:7], s53 offen offset:0 sc1
    buffer_load_dwordx4 a[20:23], v2, s[4:7], s53 offen offset:1024 sc1
    buffer_load_dwordx4 a[24:27], v2, s[4:7], s53 offen offset:2048 sc1
    buffer_load_dwordx4 a[28:31], v2, s[4:7], s53 offen offset:3072 sc1
    s_barrier
    ds_read_b64_tr_b16 v[16:17], v4 offset:0
    ds_read_b64_tr_b16 v[18:19], v4 offset:256
    ds_read_b64_tr_b16 v[20:21], v4 offset:1024
    ds_read_b64_tr_b16 v[22:23], v4 offset:1280
    ds_read_b64_tr_b16 v[24:25], v4 offset:2048
    ds_read_b64_tr_b16 v[26:27], v4 offset:2304
    ds_read_b64_tr_b16 v[28:29], v4 offset:3072
    ds_read_b64_tr_b16 v[30:31], v4 offset:3328
    ds_read_b64_tr_b16 v[32:33], v4 offset:4096
    ds_read_b64_tr_b16 v[34:35], v4 offset:4352
    ds_read_b64_tr_b16 v[36:37], v4 offset:5120
    ds_read_b64_tr_b16 v[38:39], v4 offset:5376
    s_waitcnt vmcnt(7) lgkmcnt(6)
    v_mfma_f32_32x32x16_bf16 v[64:79], v[16:19], a[0:3], 0
    ds_read_b64_tr_b16 v[40:41], v4 offset:6144
    ds_read_b64_tr_b16 v[42:43], v4 offset:6400
    s_add_u32 s53, s53, 4096
    buffer_load_dwordx4 a[32:35], v2, s[4:7], s53 offen offset:0 sc1
    v_mfma_f32_32x32x16_bf16 v[80:95], v[20:23], a[0:3], 0
    ds_read_b64_tr_b16 v[44:45], v4 offset:7168
    ds_read_b64_tr_b16 v[46:47], v4 offset:7424
    s_add_u32 m0, s67, 24576
    s_add_u32 s51, s66, 393216
    v_mfma_f32_32x32x16_bf16 v[96:111], a[0:3], v[24:27], 0
    ds_read_b64_tr_b16 v[48:49], v4 offset:8192
    ds_read_b64_tr_b16 v[50:51], v4 offset:8448
    buffer_load_dwordx4 v255, s[12:15], s51 offen offset:0 lds
    s_waitcnt vmcnt(8) lgkmcnt(6)
    v_mfma_f32_32x32x16_bf16 v[64:79], v[28:31], a[4:7], v[64:79]
    ds_read_b64_tr_b16 v[16:17], v4 offset:9216
    ds_read_b64_tr_b16 v[18:19], v4 offset:9472
    buffer_load_dwordx4 a[36:39], v2, s[4:7], s53 offen offset:1024 sc1
    v_mfma_f32_32x32x16_bf16 v[80:95], v[32:35], a[4:7], v[80:95]
    ds_read_b64_tr_b16 v[20:21], v4 offset:10240
    ds_read_b64_tr_b16 v[22:23], v4 offset:10496
    buffer_load_dwordx4 v255, s[12:15], s51 offen offset:1024 lds
    v_mfma_f32_32x32x16_bf16 v[96:111], a[4:7], v[36:39], v[96:111]
    ds_read_b64_tr_b16 v[24:25], v4 offset:11264
    ds_read_b64_tr_b16 v[26:27], v4 offset:11520
    buffer_load_dwordx4 v255, s[12:15], s51 offen offset:2048 lds
    s_waitcnt vmcnt(10) lgkmcnt(6)
    v_mfma_f32_32x32x16_bf16 v[64:79], v[40:43], a[8:11], v[64:79]
    ds_read_b64_tr_b16 v[28:29], v4 offset:12288
    ds_read_b64_tr_b16 v[30:31], v4 offset:12544
    buffer_load_dwordx4 a[40:43], v2, s[4:7], s53 offen offset:2048 sc1
    s_lshr_b32 s69, s45, 4
    v_and_b32 v6, 27, v1
    v_cmp_eq_u32 vcc, 16, v6
    v_mov_b32 v7, 0x3f803f80
    v_mov_b32 v3, 0xdddddddd
    v_mfma_f32_32x32x16_bf16 v[80:95], v[44:47], a[8:11], v[80:95]
    ds_read_b64_tr_b16 v[32:33], v4 offset:13312
    ds_read_b64_tr_b16 v[34:35], v4 offset:13568
    s_add_u32 m0, s67, 27648
    s_add_u32 s51, s66, 442368
    v_cndmask_b32 v236, 0, v7, vcc
    v_mov_b32 v237, v236
    v_mov_b64 v[132:133], v[236:237]
    v_mov_b64 v[134:135], v[236:237]
    v_mov_b64 v[136:137], v[236:237]
    v_mfma_f32_32x32x16_bf16 v[96:111], a[8:11], v[48:51], v[96:111]
    ds_read_b64_tr_b16 v[36:37], v4 offset:14336
    ds_read_b64_tr_b16 v[38:39], v4 offset:14592
    buffer_load_dwordx4 v255, s[12:15], s51 offen offset:0 lds
    v_mov_b64 v[138:139], v[236:237]
    v_mov_b64 v[144:145], v[236:237]
    v_mov_b64 v[146:147], v[236:237]
    v_mov_b64 v[148:149], v[236:237]
    v_mov_b64 v[150:151], v[236:237]
    s_waitcnt vmcnt(11) lgkmcnt(6)
    v_mfma_f32_32x32x16_bf16 v[64:79], v[16:19], a[12:15], v[64:79]
    ds_read_b64_tr_b16 v[40:41], v4 offset:15360
    ds_read_b64_tr_b16 v[42:43], v4 offset:15616
    buffer_load_dwordx4 a[44:47], v2, s[4:7], s53 offen offset:3072 sc1
    v_mov_b64 v[228:229], v[236:237]
    v_mov_b64 v[230:231], v[236:237]
    v_mov_b64 v[232:233], v[236:237]
    v_mov_b64 v[234:235], v[236:237]
    v_mov_b64 v[160:161], 0
    v_mfma_f32_32x32x16_bf16 v[80:95], v[20:23], a[12:15], v[80:95]
    ds_read_b64_tr_b16 v[44:45], v4 offset:16384
    ds_read_b64_tr_b16 v[46:47], v4 offset:16640
    buffer_load_dwordx4 v255, s[12:15], s51 offen offset:1024 lds
    v_mov_b64 v[162:163], 0
    v_mov_b64 v[164:165], 0
    v_mov_b64 v[166:167], 0
    v_mov_b64 v[168:169], 0
    v_mov_b64 v[176:177], 0
    v_mfma_f32_32x32x16_bf16 v[96:111], a[12:15], v[24:27], v[96:111]
    ds_read_b64_tr_b16 v[48:49], v4 offset:17408
    ds_read_b64_tr_b16 v[50:51], v4 offset:17664
    buffer_load_dwordx4 v255, s[12:15], s51 offen offset:2048 lds
    v_mov_b64 v[178:179], 0
    v_mov_b64 v[180:181], 0
    v_mov_b64 v[182:183], 0
    v_mov_b64 v[184:185], 0
    v_mov_b64 v[192:193], 0
    s_waitcnt vmcnt(13) lgkmcnt(6)
    v_mfma_f32_32x32x16_bf16 v[64:79], v[28:31], a[16:19], v[64:79]
    ds_read_b64_tr_b16 v[16:17], v4 offset:18432
    ds_read_b64_tr_b16 v[18:19], v4 offset:18688
    s_add_u32 s53, s53, 4096
    buffer_load_dwordx4 a[48:51], v2, s[4:7], s53 offen offset:0 sc1
    v_mov_b64 v[194:195], 0
    v_mov_b64 v[196:197], 0
    v_mov_b64 v[198:199], 0
    v_mov_b64 v[200:201], 0
    v_mov_b64 v[208:209], 0
    v_mfma_f32_32x32x16_bf16 v[80:95], v[32:35], a[16:19], v[80:95]
    ds_read_b64_tr_b16 v[20:21], v4 offset:19456
    ds_read_b64_tr_b16 v[22:23], v4 offset:19712
    s_add_u32 m0, s67, 49152
    s_add_u32 s51, s66, 786432
    v_mov_b64 v[210:211], 0
    v_mov_b64 v[212:213], 0
    v_mov_b64 v[214:215], 0
    v_mov_b64 v[216:217], 0
    s_mov_b32 s60, 0x0000ffff
    v_mfma_f32_32x32x16_bf16 v[96:111], a[16:19], v[36:39], v[96:111]
    ds_read_b64_tr_b16 v[24:25], v4 offset:20480
    ds_read_b64_tr_b16 v[26:27], v4 offset:20736
    buffer_load_dwordx4 v255, s[12:15], s51 offen offset:0 lds
    s_mov_b32 s61, 0x0000ffff
    s_mul_i32 s68, s26, 224
    v_add_u32 v6, 0, v1
    v_mul_u32_u24 v7, 4682, v6
    v_lshrrev_b32 v7, 16, v7
    s_waitcnt vmcnt(14) lgkmcnt(6)
    v_mfma_f32_32x32x16_bf16 v[64:79], v[40:43], a[20:23], v[64:79]
    ds_read_b64_tr_b16 v[28:29], v4 offset:21504
    ds_read_b64_tr_b16 v[30:31], v4 offset:21760
    buffer_load_dwordx4 a[52:55], v2, s[4:7], s53 offen offset:1024 sc1
    v_mul_u32_u24 v7, 3360, v7
    v_add3_u32 v240, v2, v7, s68
    v_add_u32 v6, 64, v1
    v_mul_u32_u24 v7, 4682, v6
    v_lshrrev_b32 v7, 16, v7
    v_mfma_f32_32x32x16_bf16 v[80:95], v[44:47], a[20:23], v[80:95]
    ds_read_b64_tr_b16 v[32:33], v4 offset:22528
    ds_read_b64_tr_b16 v[34:35], v4 offset:22784
    buffer_load_dwordx4 v255, s[12:15], s51 offen offset:1024 lds
    v_mul_u32_u24 v7, 3360, v7
    v_add3_u32 v241, v2, v7, s68
    v_add_u32 v6, 128, v1
    v_mul_u32_u24 v7, 4682, v6
    v_lshrrev_b32 v7, 16, v7
    v_mfma_f32_32x32x16_bf16 v[96:111], a[20:23], v[48:51], v[96:111]
    ds_read_b64_tr_b16 v[36:37], v4 offset:23552
    ds_read_b64_tr_b16 v[38:39], v4 offset:23808
    buffer_load_dwordx4 v255, s[12:15], s51 offen offset:2048 lds
    v_mul_u32_u24 v7, 3360, v7
    v_add3_u32 v242, v2, v7, s68
    v_add_u32 v6, 192, v1
    v_mul_u32_u24 v7, 4682, v6
    v_lshrrev_b32 v7, 16, v7
    s_waitcnt vmcnt(5)
    s_barrier
    s_waitcnt lgkmcnt(6)
    v_mfma_f32_32x32x16_bf16 v[64:79], v[16:19], a[24:27], v[64:79]
    ds_read_b64_tr_b16 v[40:41], v4 offset:24576
    ds_read_b64_tr_b16 v[42:43], v4 offset:24832
    buffer_load_dwordx4 a[56:59], v2, s[4:7], s53 offen offset:2048 sc1
    v_mul_u32_u24 v7, 3360, v7
    v_add3_u32 v243, v2, v7, s68
    v_add_u32 v6, 256, v1
    v_mul_u32_u24 v7, 4682, v6
    v_lshrrev_b32 v7, 16, v7
    v_mfma_f32_32x32x16_bf16 v[80:95], v[20:23], a[24:27], v[80:95]
    ds_read_b64_tr_b16 v[44:45], v4 offset:25600
    ds_read_b64_tr_b16 v[46:47], v4 offset:25856
    s_add_u32 m0, s67, 52224
    s_add_u32 s51, s66, 835584
    v_mul_u32_u24 v7, 3360, v7
    v_add3_u32 v244, v2, v7, s68
    v_add_u32 v244, 4096, v244
    v_add_u32 v6, 320, v1
    v_mul_u32_u24 v7, 4682, v6
    v_mfma_f32_32x32x16_bf16 v[96:111], a[24:27], v[24:27], v[96:111]
    ds_read_b64_tr_b16 v[48:49], v4 offset:26624
    ds_read_b64_tr_b16 v[50:51], v4 offset:26880
    buffer_load_dwordx4 v255, s[12:15], s51 offen offset:0 lds
    v_lshrrev_b32 v7, 16, v7
    v_mul_u32_u24 v7, 3360, v7
    v_add3_u32 v245, v2, v7, s68
    v_add_u32 v245, 4096, v245
    v_add_u32 v6, 384, v1
    s_waitcnt lgkmcnt(6)
    v_mfma_f32_32x32x16_bf16 v[64:79], v[28:31], a[28:31], v[64:79]
    ds_read_b64_tr_b16 v[16:17], v4 offset:27648
    ds_read_b64_tr_b16 v[18:19], v4 offset:27904
    buffer_load_dwordx4 a[60:63], v2, s[4:7], s53 offen offset:3072 sc1
    v_mul_u32_u24 v7, 4682, v6
    v_lshrrev_b32 v7, 16, v7
    v_mul_u32_u24 v7, 3360, v7
    v_add3_u32 v246, v2, v7, s68
    v_add_u32 v246, 4096, v246
    v_mfma_f32_32x32x16_bf16 v[80:95], v[32:35], a[28:31], v[80:95]
    ds_read_b64_tr_b16 v[20:21], v4 offset:28672
    ds_read_b64_tr_b16 v[22:23], v4 offset:28928
    buffer_load_dwordx4 v255, s[12:15], s51 offen offset:1024 lds
    s_lshl_b32 s68, s27, 7
    v_lshrrev_b32 v9, 3, v1
    v_lshlrev_b32 v9, 10, v9
    v_add_u32 v9, s68, v9
    v_and_b32 v7, 7, v1
    v_mfma_f32_32x32x16_bf16 v[96:111], a[28:31], v[36:39], v[96:111]
    ds_read_b64_tr_b16 v[24:25], v4 offset:29696
    ds_read_b64_tr_b16 v[26:27], v4 offset:29952
    buffer_load_dwordx4 v255, s[12:15], s51 offen offset:2048 lds
    v_lshlrev_b32 v7, 4, v7
    v_lshrrev_b32 v8, 4, v1
    v_lshlrev_b32 v8, 5, v8
    v_xor_b32 v8, v7, v8
    v_add_u32 v8, v8, v9
    s_waitcnt lgkmcnt(6)
    v_mfma_f32_32x32x16_bf16 v[64:79], v[40:43], a[32:35], v[64:79]
    ds_read_b64_tr_b16 v[28:29], v4 offset:30720
    ds_read_b64_tr_b16 v[30:31], v4 offset:30976
    s_add_u32 s53, s53, 4096
    buffer_load_dwordx4 a[64:67], v2, s[4:7], s53 offen offset:0 sc1
    v_accvgpr_write_b32 a184, v8
    v_bfe_u32 v8, v1, 4, 1
    v_lshlrev_b32 v8, 5, v8
    v_xor_b32 v7, v7, v8
    v_add_u32 v247, v7, v9
    v_mfma_f32_32x32x16_bf16 v[80:95], v[44:47], a[32:35], v[80:95]
    ds_read_b64_tr_b16 v[32:33], v4 offset:31744
    ds_read_b64_tr_b16 v[34:35], v4 offset:32000
    v_xor_b32 v7, 64, v7
    v_add_u32 v7, v7, v9
    v_add_u32 v248, 7168, v7
    v_bfe_u32 v7, v1, 2, 2
    v_lshlrev_b32 v7, 7, v7
    v_mfma_f32_32x32x16_bf16 v[96:111], a[32:35], v[48:51], v[96:111]
    ds_read_b64_tr_b16 v[36:37], v4 offset:32768
    ds_read_b64_tr_b16 v[38:39], v4 offset:33024
    v_bfe_u32 v6, v1, 3, 2
    v_lshl_add_u32 v7, v6, 5, v7
    v_and_b32 v6, 3, v1
    v_lshl_add_u32 v7, v6, 3, v7
    v_lshrrev_b32 v8, 4, v1
    s_waitcnt lgkmcnt(6)
    v_mfma_f32_32x32x16_bf16 v[64:79], v[16:19], a[36:39], v[64:79]
    ds_read_b64_tr_b16 v[40:41], v4 offset:33792
    ds_read_b64_tr_b16 v[42:43], v4 offset:34048
    buffer_load_dwordx4 a[68:71], v2, s[4:7], s53 offen offset:1024 sc1
    v_lshl_add_u32 v9, v8, 9, v7
    v_accvgpr_write_b32 a186, v9
    s_lshl_b32 s68, s25, 15
    s_add_u32 s68, s68, 87552
    v_lshl_add_u32 v9, v8, 10, v7
    v_mfma_f32_32x32x16_bf16 v[80:95], v[20:23], a[36:39], v[80:95]
    ds_read_b64_tr_b16 v[44:45], v4 offset:34816
    ds_read_b64_tr_b16 v[46:47], v4 offset:35072
    v_add_u32 v249, s68, v9
    v_lshlrev_b32 v8, 7, v1
    s_mul_i32 s68, s2, 2816
    s_mul_i32 s3, s25, 1408
    s_add_u32 s68, s68, s3
    v_mfma_f32_32x32x16_bf16 v[96:111], a[36:39], v[24:27], v[96:111]
    ds_read_b64_tr_b16 v[48:49], v4 offset:35840
    ds_read_b64_tr_b16 v[50:51], v4 offset:36096
    s_add_u32 s68, s68, 1146880
    v_min_u32 v7, 1280, v8
    v_add_u32 v7, s68, v7
    v_accvgpr_write_b32 a160, v7
    s_mul_i32 s68, s2, 2816
    s_waitcnt lgkmcnt(6)
    v_mfma_f32_32x32x16_bf16 v[64:79], v[28:31], a[40:43], v[64:79]
    ds_read_b64_tr_b16 v[16:17], v4 offset:36864
    ds_read_b64_tr_b16 v[18:19], v4 offset:37120
    buffer_load_dwordx4 a[72:75], v2, s[4:7], s53 offen offset:2048 sc1
    s_mul_i32 s3, s25, 1408
    s_add_u32 s68, s68, s3
    v_min_u32 v7, 1280, v8
    v_add_u32 v7, s68, v7
    v_accvgpr_write_b32 a191, v7
    v_mfma_f32_32x32x16_bf16 v[80:95], v[32:35], a[40:43], v[80:95]
    ds_read_b64_tr_b16 v[20:21], v4 offset:37888
    ds_read_b64_tr_b16 v[22:23], v4 offset:38144
    s_add_u32 m0, s67, 73728
    s_add_u32 s51, s66, 1179648
    s_mul_i32 s68, s2, 7168
    s_mul_i32 s3, s46, 1792
    s_add_u32 s68, s68, s3
    v_min_u32 v7, 1664, v8
    v_add_u32 v7, s68, v7
    v_mfma_f32_32x32x16_bf16 v[96:111], a[40:43], v[36:39], v[96:111]
    ds_read_b64_tr_b16 v[24:25], v4 offset:38912
    ds_read_b64_tr_b16 v[26:27], v4 offset:39168
    buffer_load_dwordx4 v255, s[12:15], s51 offen offset:0 lds
    v_accvgpr_write_b32 a161, v7
    s_mul_i32 s68, s45, 14336
    s_mul_i32 s3, s25, 7168
    s_add_u32 s68, s68, s3
    s_add_u32 s68, s68, 688128
    s_waitcnt lgkmcnt(6)
    v_mfma_f32_32x32x16_bf16 v[64:79], v[40:43], a[44:47], v[64:79]
    ds_read_b64_tr_b16 v[28:29], v4 offset:39936
    ds_read_b64_tr_b16 v[30:31], v4 offset:40192
    buffer_load_dwordx4 a[76:79], v2, s[4:7], s53 offen offset:3072 sc1
    v_min_u32 v7, 3456, v8
    v_add_u32 v7, s68, v7
    v_accvgpr_write_b32 a162, v7
    s_lshr_b32 s72, s45, 3
    s_lshl_b32 s68, s72, 16
    v_mfma_f32_32x32x16_bf16 v[80:95], v[44:47], a[44:47], v[80:95]
    ds_read_b64_tr_b16 v[32:33], v4 offset:40960
    ds_read_b64_tr_b16 v[34:35], v4 offset:41216
    buffer_load_dwordx4 v255, s[12:15], s51 offen offset:1024 lds
    s_lshl_b32 s3, s44, 18
    s_add_u32 s68, s68, s3
    s_lshl_b32 s3, s24, 15
    s_add_u32 s68, s68, s3
    s_lshl_b32 s3, s27, 7
    v_mfma_f32_32x32x16_bf16 v[96:111], a[44:47], v[48:51], v[96:111]
    ds_read_b64_tr_b16 v[36:37], v4 offset:41984
    ds_read_b64_tr_b16 v[38:39], v4 offset:42240
    buffer_load_dwordx4 v255, s[12:15], s51 offen offset:2048 lds
    s_add_u32 s68, s68, s3
    s_lshl_b32 s3, s25, 14
    s_add_u32 s68, s68, s3
    v_and_b32 v7, 15, v1
    v_lshlrev_b32 v7, 10, v7
    s_waitcnt vmcnt(16) lgkmcnt(6)
    v_mfma_f32_32x32x16_bf16 v[64:79], v[16:19], a[48:51], v[64:79]
    ds_read_b64_tr_b16 v[40:41], v4 offset:43008
    ds_read_b64_tr_b16 v[42:43], v4 offset:43264
    s_add_u32 s53, s53, 4096
    buffer_load_dwordx4 a[80:83], v2, s[4:7], s53 offen offset:0 sc1
    v_lshrrev_b32 v6, 4, v1
    v_lshl_add_u32 v7, v6, 3, v7
    v_add_u32 v7, s68, v7
    v_accvgpr_write_b32 a190, v7
    s_mul_i32 s68, s64, 114688
    v_mfma_f32_32x32x16_bf16 v[80:95], v[20:23], a[48:51], v[80:95]
    ds_read_b64_tr_b16 v[44:45], v4 offset:44032
    ds_read_b64_tr_b16 v[46:47], v4 offset:44288
    s_add_u32 m0, s67, 76800
    s_add_u32 s51, s66, 1228800
    s_mul_i32 s3, s26, 3584
    s_add_u32 s68, s68, s3
    s_add_u32 s68, s68, 13631488
    v_bfe_u32 v7, v1, 4, 1
    v_mul_u32_u24 v7, 57344, v7
    v_mfma_f32_32x32x16_bf16 v[96:111], a[48:51], v[24:27], v[96:111]
    ds_read_b64_tr_b16 v[48:49], v4 offset:45056
    ds_read_b64_tr_b16 v[50:51], v4 offset:45312
    buffer_load_dwordx4 v255, s[12:15], s51 offen offset:0 lds
    v_add_u32 v7, s68, v7
    v_and_b32 v9, 15, v1
    v_min_u32 v9, 13, v9
    v_lshl_add_u32 v7, v9, 7, v7
    v_accvgpr_write_b32 a163, v7
    s_waitcnt vmcnt(16) lgkmcnt(6)
    v_mfma_f32_32x32x16_bf16 v[64:79], v[28:31], a[52:55], v[64:79]
    ds_read_b64_tr_b16 v[16:17], v4 offset:46080
    ds_read_b64_tr_b16 v[18:19], v4 offset:46336
    buffer_load_dwordx4 a[84:87], v2, s[4:7], s53 offen offset:1024 sc1
    s_lshl_b32 s72, s44, 2
    s_lshl_b32 s3, s69, 1
    s_add_u32 s72, s72, s3
    s_add_u32 s72, s72, s25
    s_lshl_b32 s94, s72, 16
    v_mfma_f32_32x32x16_bf16 v[80:95], v[32:35], a[52:55], v[80:95]
    ds_read_b64_tr_b16 v[20:21], v4 offset:47104
    ds_read_b64_tr_b16 v[22:23], v4 offset:47360
    buffer_load_dwordx4 v255, s[12:15], s51 offen offset:1024 lds
    s_lshl_b32 s3, s26, 10
    s_add_u32 s94, s94, s3
    s_lshl_b32 s3, s24, 9
    s_add_u32 s94, s94, s3
    s_add_u32 s94, s94, 9437184
    v_mfma_f32_32x32x16_bf16 v[96:111], a[52:55], v[36:39], v[96:111]
    ds_read_b64_tr_b16 v[24:25], v4 offset:48128
    ds_read_b64_tr_b16 v[26:27], v4 offset:48384
    buffer_load_dwordx4 v255, s[12:15], s51 offen offset:2048 lds
    s_lshl_b32 s95, s72, 7
    s_lshl_b32 s3, s26, 3
    s_add_u32 s95, s95, s3
    s_lshl_b32 s3, s24, 2
    s_add_u32 s95, s95, s3
    s_waitcnt vmcnt(12)
    s_barrier
    s_waitcnt lgkmcnt(6)
    v_mfma_f32_32x32x16_bf16 v[64:79], v[40:43], a[56:59], v[64:79]
    ds_read_b64_tr_b16 v[28:29], v12 offset:0
    ds_read_b64_tr_b16 v[30:31], v12 offset:256
    buffer_load_dwordx4 a[88:91], v2, s[4:7], s53 offen offset:2048 sc1
    s_add_u32 s95, s95, 32768
    v_and_b32 v9, 3, v1
    v_lshlrev_b32 v9, 7, v9
    v_bfe_u32 v6, v1, 2, 1
    v_lshl_add_u32 v9, v6, 14, v9
    v_mfma_f32_32x32x16_bf16 v[80:95], v[44:47], a[56:59], v[80:95]
    ds_read_b64_tr_b16 v[32:33], v12 offset:1024
    ds_read_b64_tr_b16 v[34:35], v12 offset:1280
    v_bfe_u32 v6, v1, 3, 1
    v_lshl_add_u32 v9, v6, 15, v9
    v_add_u32 v9, s94, v9
    s_lshl_b32 s68, s44, 15
    s_lshl_b32 s3, s45, 10
    v_mfma_f32_32x32x16_bf16 v[96:111], a[56:59], v[48:51], v[96:111]
    ds_read_b64_tr_b16 v[36:37], v12 offset:2048
    ds_read_b64_tr_b16 v[38:39], v12 offset:2304
    s_add_u32 s68, s68, s3
    s_lshl_b32 s3, s46, 8
    s_add_u32 s68, s68, s3
    s_add_u32 s68, s68, 522240
    v_add_u32 v7, s68, v8
    s_waitcnt lgkmcnt(6)
    v_mfma_f32_32x32x16_bf16 v[64:79], v[16:19], a[60:63], v[64:79]
    ds_read_b64_tr_b16 v[40:41], v12 offset:3072
    ds_read_b64_tr_b16 v[42:43], v12 offset:3328
    buffer_load_dwordx4 a[92:95], v2, s[4:7], s53 offen offset:3072 sc1
    v_cmp_gt_u32 vcc, 16, v1
    s_lshl_b32 s72, s72, 7
    s_add_u32 s72, s72, 32768
    v_cndmask_b32 v9, v7, v9, vcc
    s_lshl_b32 s73, s64, 7
    v_mfma_f32_32x32x16_bf16 v[80:95], v[20:23], a[60:63], v[80:95]
    ds_read_b64_tr_b16 v[44:45], v12 offset:4096
    ds_read_b64_tr_b16 v[46:47], v12 offset:4352
    s_add_u32 s73, s73, 49152
    s_add_u32 s68, s73, 8192
    v_cmp_gt_u32 vcc, 18, v1
    v_mov_b32 v7, s72
    s_nop 0
    v_mfma_f32_32x32x16_bf16 v[96:111], a[60:63], v[24:27], v[96:111]
    ds_read_b64_tr_b16 v[48:49], v12 offset:5120
    ds_read_b64_tr_b16 v[50:51], v12 offset:5376
    v_cndmask_b32 v9, v7, v9, vcc
    v_cmp_gt_u32 vcc, 19, v1
    v_mov_b32 v7, s73
    s_nop 0
    v_cndmask_b32 v9, v7, v9, vcc
    s_waitcnt vmcnt(13) lgkmcnt(6)
    v_mfma_f32_32x32x16_bf16 v[64:79], v[28:31], a[64:67], v[64:79]
    ds_read_b64_tr_b16 v[16:17], v12 offset:6144
    ds_read_b64_tr_b16 v[18:19], v12 offset:6400
    s_add_u32 s53, s53, 4096
    buffer_load_dwordx4 a[96:99], v2, s[4:7], s53 offen offset:0 sc1
    v_cmp_gt_u32 vcc, 20, v1
    v_mov_b32 v7, s68
    s_nop 0
    v_cndmask_b32 v9, v7, v9, vcc
    v_accvgpr_write_b32 a164, v9
    v_mfma_f32_32x32x16_bf16 v[80:95], v[32:35], a[64:67], v[80:95]
    ds_read_b64_tr_b16 v[20:21], v12 offset:7168
    ds_read_b64_tr_b16 v[22:23], v12 offset:7424
    s_lshl_b32 s56, s26, 18
    s_lshl_b32 s3, s64, 11
    s_add_u32 s56, s56, s3
    s_add_u32 s56, s56, 5242880
    s_add_u32 s57, s56, 131072
    v_mfma_f32_32x32x16_bf16 v[96:111], a[64:67], v[36:39], v[96:111]
    ds_read_b64_tr_b16 v[24:25], v12 offset:8192
    ds_read_b64_tr_b16 v[26:27], v12 offset:8448
    v_and_b32 v117, 3, v1
    v_lshlrev_b32 v117, 4, v117
    v_bfe_u32 v6, v1, 2, 1
    v_lshl_add_u32 v117, v6, 7, v117
    v_bfe_u32 v6, v1, 3, 1
    s_waitcnt vmcnt(13) lgkmcnt(6)
    v_mfma_f32_32x32x16_bf16 v[64:79], v[40:43], a[68:71], v[64:79]
    ds_read_b64_tr_b16 v[28:29], v12 offset:9216
    ds_read_b64_tr_b16 v[30:31], v12 offset:9472
    buffer_load_dwordx4 a[100:103], v2, s[4:7], s53 offen offset:1024 sc1
    v_lshl_add_u32 v117, v6, 6, v117
    v_lshrrev_b32 v6, 4, v1
    v_lshl_add_u32 v117, v6, 8, v117
    v_lshrrev_b32 v116, 5, v1
    v_lshlrev_b32 v116, 8, v116
    v_mfma_f32_32x32x16_bf16 v[80:95], v[44:47], a[68:71], v[80:95]
    ds_read_b64_tr_b16 v[32:33], v12 offset:10240
    ds_read_b64_tr_b16 v[34:35], v12 offset:10496
    v_and_b32 v6, 15, v1
    v_lshl_add_u32 v116, v6, 4, v116
    v_bfe_u32 v119, v1, 4, 1
    v_lshlrev_b32 v119, 17, v119
    v_add_u32 v119, v119, v116
    v_mfma_f32_32x32x16_bf16 v[96:111], a[68:71], v[48:51], v[96:111]
    ds_read_b64_tr_b16 v[36:37], v12 offset:11264
    ds_read_b64_tr_b16 v[38:39], v12 offset:11520
    v_mov_b32 v62, 0x3eb8aa3b
    s_mul_i32 s52, s46, 6144
    s_add_u32 s52, s52, 98304
    v_add_u32 v52, s52, v2
    v_add_u32 v53, s52, v117
    s_waitcnt vmcnt(13) lgkmcnt(6)
    v_mfma_f32_32x32x16_bf16 v[64:79], v[16:19], a[72:75], v[64:79]
    ds_read_b64_tr_b16 v[40:41], v12 offset:12288
    ds_read_b64_tr_b16 v[42:43], v12 offset:12544
    buffer_load_dwordx4 a[104:107], v2, s[4:7], s53 offen offset:2048 sc1
    v_bfe_u32 v54, v1, 4, 1
    v_lshlrev_b32 v54, 11, v54
    v_add_u32 v54, s52, v54
    v_add_u32 v54, v54, v116
    v_xor_b32 v250, 32, v249
    v_mfma_f32_32x32x16_bf16 v[80:95], v[20:23], a[72:75], v[80:95]
    ds_read_b64_tr_b16 v[44:45], v12 offset:13312
    ds_read_b64_tr_b16 v[46:47], v12 offset:13568
    v_xor_b32 v251, 64, v249
    v_xor_b32 v252, 96, v249
    s_lshr_b32 s69, s45, 4
    s_lshl_b32 s62, s26, 1
    s_add_u32 s62, s62, s24
    v_mfma_f32_32x32x16_bf16 v[96:111], a[72:75], v[24:27], v[96:111]
    ds_read_b64_tr_b16 v[48:49], v12 offset:14336
    ds_read_b64_tr_b16 v[50:51], v12 offset:14592
    s_lshl_b32 s84, s26, 10
    s_add_u32 s84, s84, 65536
    s_mov_b32 s85, s84
    s_lshl_b32 s3, s44, 7
    s_add_u32 s85, s85, s3
    s_waitcnt vmcnt(12) lgkmcnt(6)
    v_mfma_f32_32x32x16_bf16 v[64:79], v[28:31], a[76:79], v[64:79]
    ds_read_b64_tr_b16 v[16:17], v12 offset:15360
    ds_read_b64_tr_b16 v[18:19], v12 offset:15616
    buffer_load_dwordx4 a[108:111], v2, s[4:7], s53 offen offset:3072 sc1
    s_add_u32 s85, s85, 16384
    s_and_b32 s68, s64, 7
    s_mov_b32 s92, s85
    s_lshl_b32 s3, s68, 2
    s_add_u32 s92, s92, s3
    v_mfma_f32_32x32x16_bf16 v[80:95], v[32:35], a[76:79], v[80:95]
    ds_read_b64_tr_b16 v[20:21], v12 offset:16384
    ds_read_b64_tr_b16 v[22:23], v12 offset:16640
    s_add_u32 s91, s92, 4294950912
    v_and_b32 v254, 7, v1
    v_lshlrev_b32 v254, 2, v254
    v_lshrrev_b32 v6, 3, v1
    v_lshl_add_u32 v254, v6, 7, v254
    v_mfma_f32_32x32x16_bf16 v[96:111], a[76:79], v[36:39], v[96:111]
    ds_read_b64_tr_b16 v[24:25], v12 offset:17408
    ds_read_b64_tr_b16 v[26:27], v12 offset:17664
    s_add_u32 s68, s44, 1
    s_and_b32 s68, s68, 7
    s_lshl_b32 s90, s68, 14
    s_lshl_b32 s68, s68, 7
    v_and_b32 v253, 7, v1
    s_waitcnt vmcnt(10) lgkmcnt(6)
    v_mfma_f32_32x32x16_bf16 v[64:79], v[40:43], a[80:83], v[64:79]
    ds_read_b64_tr_b16 v[28:29], v12 offset:18432
    ds_read_b64_tr_b16 v[30:31], v12 offset:18688
    s_add_u32 s53, s53, 4096
    buffer_load_dwordx4 a[112:115], v2, s[4:7], s53 offen offset:0 sc1
    v_lshlrev_b32 v253, 2, v253
    v_add_u32 v253, s68, v253
    s_xor_b32 s68, s69, 1
    s_lshl_b32 s89, s44, 14
    s_lshl_b32 s3, s68, 13
    v_mfma_f32_32x32x16_bf16 v[80:95], v[44:47], a[80:83], v[80:95]
    ds_read_b64_tr_b16 v[32:33], v12 offset:19456
    ds_read_b64_tr_b16 v[34:35], v12 offset:19712
    s_add_u32 s89, s89, s3
    s_lshl_b32 s65, s62, 17
    s_add_u32 s65, s65, 5242880
    s_mov_b32 s63, s65
    s_lshl_b32 s3, s25, 11
    v_mfma_f32_32x32x16_bf16 v[96:111], a[80:83], v[48:51], v[96:111]
    ds_read_b64_tr_b16 v[36:37], v12 offset:20480
    ds_read_b64_tr_b16 v[38:39], v12 offset:20736
    s_add_u32 s63, s63, s3
    s_lshl_b32 s86, s46, 14
    s_add_u32 s86, s86, 87552
    s_lshl_b32 s87, s46, 17
    s_lshl_b32 s74, s46, 12
    s_waitcnt vmcnt(9) lgkmcnt(6)
    v_mfma_f32_32x32x16_bf16 v[64:79], v[16:19], a[84:87], v[64:79]
    ds_read_b64_tr_b16 v[40:41], v12 offset:21504
    ds_read_b64_tr_b16 v[42:43], v12 offset:21760
    buffer_load_dwordx4 a[116:119], v2, s[4:7], s53 offen offset:1024 sc1
    s_lshl_b32 s3, s27, 9
    s_add_u32 s74, s74, s3
    s_add_u32 s74, s74, 262144
    s_xor_b32 s68, s25, 1
    s_mul_i32 s68, s68, 12288
    v_mfma_f32_32x32x16_bf16 v[80:95], v[20:23], a[84:87], v[80:95]
    ds_read_b64_tr_b16 v[44:45], v12 offset:22528
    ds_read_b64_tr_b16 v[46:47], v12 offset:22784
    s_lshl_b32 s3, s24, 10
    s_add_u32 s68, s68, s3
    s_add_u32 s68, s68, 98304
    v_add_u32 v55, s68, v2
    s_mul_i32 s68, s25, 12288
    v_mfma_f32_32x32x16_bf16 v[96:111], a[84:87], v[24:27], v[96:111]
    ds_read_b64_tr_b16 v[48:49], v12 offset:23552
    ds_read_b64_tr_b16 v[50:51], v12 offset:23808
    s_lshl_b32 s3, s24, 10
    s_add_u32 s68, s68, s3
    s_add_u32 s68, s68, 98304
    v_add_u32 v56, s68, v2
    s_mul_i32 s68, s25, 6144
    s_waitcnt vmcnt(8)
    s_barrier
    s_waitcnt vmcnt(7) lgkmcnt(6)
    v_mfma_f32_32x32x16_bf16 v[64:79], v[28:31], a[88:91], v[64:79]
    ds_read_b64_tr_b16 v[16:17], v12 offset:26624
    ds_read_b64_tr_b16 v[18:19], v12 offset:26880
    buffer_load_dwordx4 a[120:123], v2, s[4:7], s53 offen offset:2048 sc1
    s_lshl_b32 s3, s24, 11
    s_add_u32 s68, s68, s3
    s_add_u32 s68, s68, 100352
    v_add_u32 v57, s68, v2
    v_add_u32 v58, s68, v116
    v_mfma_f32_32x32x16_bf16 v[80:95], v[32:35], a[88:91], v[80:95]
    ds_read_b64_tr_b16 v[20:21], v12 offset:29696
    ds_read_b64_tr_b16 v[22:23], v12 offset:29952
    v_and_b32 v238, 7, v1
    v_lshlrev_b32 v238, 2, v238
    s_mul_i32 s66, s25, 14592
    s_mul_i32 s3, s24, 7296
    s_add_u32 s66, s66, s3
    v_mfma_f32_32x32x16_bf16 v[96:111], a[88:91], v[36:39], v[96:111]
    ds_read_b64_tr_b16 v[24:25], v12 offset:32768
    ds_read_b64_tr_b16 v[26:27], v12 offset:33024
    s_mul_i32 s67, s25, 114688
    s_waitcnt vmcnt(7) lgkmcnt(6)
    v_mfma_f32_32x32x16_bf16 v[64:79], v[40:43], a[92:95], v[64:79]
    ds_read_b64_tr_b16 v[28:29], v12 offset:35840
    ds_read_b64_tr_b16 v[30:31], v12 offset:36096
    buffer_load_dwordx4 a[124:127], v2, s[4:7], s53 offen offset:3072 sc1
    v_mfma_f32_32x32x16_bf16 v[80:95], v[44:47], a[92:95], v[80:95]
    ds_read_b64_tr_b16 v[32:33], v12 offset:38912
    ds_read_b64_tr_b16 v[34:35], v12 offset:39168
    buffer_load_dword v114, v125, s[4:7], s54 offen offset:4 sc1
    v_mfma_f32_32x32x16_bf16 v[96:111], a[92:95], v[48:51], v[96:111]
    ds_read_b64_tr_b16 v[36:37], v12 offset:41984
    ds_read_b64_tr_b16 v[38:39], v12 offset:42240
    buffer_load_dword v115, v125, s[4:7], s54 offen offset:36 sc1
    s_waitcnt vmcnt(9) lgkmcnt(6)
    v_mfma_f32_32x32x16_bf16 v[96:111], a[96:99], v[16:19], v[96:111]
    ds_read_b64_tr_b16 v[40:41], v12 offset:45056
    ds_read_b64_tr_b16 v[42:43], v12 offset:45312
    s_waitcnt vmcnt(8)
    v_mfma_f32_32x32x16_bf16 v[96:111], a[100:103], v[20:23], v[96:111]
    ds_read_b64_tr_b16 v[44:45], v12 offset:48128
    ds_read_b64_tr_b16 v[46:47], v12 offset:48384
    s_waitcnt vmcnt(7)
    v_mfma_f32_32x32x16_bf16 v[96:111], a[104:107], v[24:27], v[96:111]
    ds_read_b64_tr_b16 v[48:49], v12 offset:25600
    ds_read_b64_tr_b16 v[50:51], v12 offset:25856
    s_waitcnt vmcnt(6) lgkmcnt(6)
    v_mfma_f32_32x32x16_bf16 v[96:111], a[108:111], v[28:31], v[96:111]
    ds_read_b64_tr_b16 v[16:17], v12 offset:28672
    ds_read_b64_tr_b16 v[18:19], v12 offset:28928
    s_waitcnt vmcnt(5)
    v_mfma_f32_32x32x16_bf16 v[96:111], a[112:115], v[32:35], v[96:111]
    ds_read_b64_tr_b16 v[20:21], v12 offset:31744
    ds_read_b64_tr_b16 v[22:23], v12 offset:32000
    s_waitcnt vmcnt(4)
    v_mfma_f32_32x32x16_bf16 v[96:111], a[116:119], v[36:39], v[96:111]
    ds_read_b64_tr_b16 v[24:25], v12 offset:34816
    ds_read_b64_tr_b16 v[26:27], v12 offset:35072
    s_waitcnt vmcnt(3) lgkmcnt(6)
    v_mfma_f32_32x32x16_bf16 v[96:111], a[120:123], v[40:43], v[96:111]
    ds_read_b64_tr_b16 v[28:29], v12 offset:37888
    ds_read_b64_tr_b16 v[30:31], v12 offset:38144
    s_waitcnt vmcnt(2)
    v_mfma_f32_32x32x16_bf16 v[96:111], a[124:127], v[44:47], v[96:111]
    ds_read_b64_tr_b16 v[32:33], v12 offset:40960
    ds_read_b64_tr_b16 v[34:35], v12 offset:41216
    v_mfma_f32_32x32x16_bf16 v[80:95], v[48:51], a[96:99], v[80:95]
    ds_read_b64_tr_b16 v[36:37], v12 offset:44032
    ds_read_b64_tr_b16 v[38:39], v12 offset:44288
    s_waitcnt lgkmcnt(6)
    v_mfma_f32_32x32x16_bf16 v[80:95], v[16:19], a[100:103], v[80:95]
    ds_read_b64_tr_b16 v[40:41], v12 offset:47104
    ds_read_b64_tr_b16 v[42:43], v12 offset:47360
    v_mfma_f32_32x32x16_bf16 v[80:95], v[20:23], a[104:107], v[80:95]
    ds_read_b64_tr_b16 v[44:45], v12 offset:24576
    ds_read_b64_tr_b16 v[46:47], v12 offset:24832
    v_mfma_f32_32x32x16_bf16 v[80:95], v[24:27], a[108:111], v[80:95]
    ds_read_b64_tr_b16 v[48:49], v12 offset:27648
    ds_read_b64_tr_b16 v[50:51], v12 offset:27904
    v_cvt_pk_bf16_f32 v96, v96, v97
    v_cvt_pk_bf16_f32 v97, v98, v99
    v_cvt_pk_bf16_f32 v98, v100, v101
    s_waitcnt lgkmcnt(6)
    v_mfma_f32_32x32x16_bf16 v[80:95], v[28:31], a[112:115], v[80:95]
    ds_read_b64_tr_b16 v[16:17], v12 offset:30720
    ds_read_b64_tr_b16 v[18:19], v12 offset:30976
    v_cvt_pk_bf16_f32 v99, v102, v103
    v_cvt_pk_bf16_f32 v100, v104, v105
    v_cvt_pk_bf16_f32 v101, v106, v107
    v_mfma_f32_32x32x16_bf16 v[80:95], v[32:35], a[116:119], v[80:95]
    ds_read_b64_tr_b16 v[20:21], v12 offset:33792
    ds_read_b64_tr_b16 v[22:23], v12 offset:34048
    v_cvt_pk_bf16_f32 v102, v108, v109
    v_cvt_pk_bf16_f32 v103, v110, v111
    buffer_store_dwordx4 v[96:99], v119, s[4:7], s56 offen offset:1024 sc1
    v_mfma_f32_32x32x16_bf16 v[80:95], v[36:39], a[120:123], v[80:95]
    ds_read_b64_tr_b16 v[24:25], v12 offset:36864
    ds_read_b64_tr_b16 v[26:27], v12 offset:37120
    buffer_store_dwordx4 v[100:103], v119, s[4:7], s56 offen offset:1536 sc1
    ds_write_b128 v54, v[96:99] offset:3072
    ds_write_b128 v54, v[100:103] offset:3584
    s_waitcnt lgkmcnt(8)
    v_mfma_f32_32x32x16_bf16 v[80:95], v[40:43], a[124:127], v[80:95]
    ds_read_b64_tr_b16 v[28:29], v12 offset:39936
    ds_read_b64_tr_b16 v[30:31], v12 offset:40192
    v_mfma_f32_32x32x16_bf16 v[64:79], v[44:47], a[96:99], v[64:79]
    ds_read_b64_tr_b16 v[32:33], v12 offset:43008
    ds_read_b64_tr_b16 v[34:35], v12 offset:43264
    v_mfma_f32_32x32x16_bf16 v[64:79], v[48:51], a[100:103], v[64:79]
    ds_read_b64_tr_b16 v[36:37], v12 offset:46080
    ds_read_b64_tr_b16 v[38:39], v12 offset:46336
    s_waitcnt lgkmcnt(8)
    v_mfma_f32_32x32x16_bf16 v[64:79], v[16:19], a[104:107], v[64:79]
    v_mfma_f32_32x32x16_bf16 v[64:79], v[20:23], a[108:111], v[64:79]
    v_mfma_f32_32x32x16_bf16 v[64:79], v[24:27], a[112:115], v[64:79]
    v_cvt_pk_bf16_f32 v80, v80, v81
    v_cvt_pk_bf16_f32 v81, v82, v83
    v_cvt_pk_bf16_f32 v82, v84, v85
    s_waitcnt lgkmcnt(0)
    v_mfma_f32_32x32x16_bf16 v[64:79], v[28:31], a[116:119], v[64:79]
    v_cvt_pk_bf16_f32 v83, v86, v87
    v_cvt_pk_bf16_f32 v84, v88, v89
    v_cvt_pk_bf16_f32 v85, v90, v91
    v_mfma_f32_32x32x16_bf16 v[64:79], v[32:35], a[120:123], v[64:79]
    v_cvt_pk_bf16_f32 v86, v92, v93
    v_cvt_pk_bf16_f32 v87, v94, v95
    buffer_store_dwordx4 v[80:83], v117, s[4:7], s56 offen sc1
    v_mfma_f32_32x32x16_bf16 v[64:79], v[36:39], a[124:127], v[64:79]
    buffer_store_dwordx4 v[84:87], v117, s[4:7], s57 offen sc1
    ds_write_b128 v53, v[80:83] offset:2048
    ds_write_b128 v53, v[84:87] offset:4096
    v_mov_b32 v12, v116
    s_nop 10
    v_pk_mul_f32 v[64:65], v[64:65], v[62:63] op_sel_hi:[1,0]
    v_pk_mul_f32 v[66:67], v[66:67], v[62:63] op_sel_hi:[1,0]
    v_pk_mul_f32 v[68:69], v[68:69], v[62:63] op_sel_hi:[1,0]
    v_pk_mul_f32 v[70:71], v[70:71], v[62:63] op_sel_hi:[1,0]
    v_pk_mul_f32 v[72:73], v[72:73], v[62:63] op_sel_hi:[1,0]
    v_pk_mul_f32 v[74:75], v[74:75], v[62:63] op_sel_hi:[1,0]
    v_pk_mul_f32 v[76:77], v[76:77], v[62:63] op_sel_hi:[1,0]
    v_pk_mul_f32 v[78:79], v[78:79], v[62:63] op_sel_hi:[1,0]
    v_cvt_pk_bf16_f32 v64, v64, v65
    v_cvt_pk_bf16_f32 v65, v66, v67
    v_cvt_pk_bf16_f32 v66, v68, v69
    v_cvt_pk_bf16_f32 v67, v70, v71
    v_cvt_pk_bf16_f32 v68, v72, v73
    v_cvt_pk_bf16_f32 v69, v74, v75
    v_cvt_pk_bf16_f32 v70, v76, v77
    v_cvt_pk_bf16_f32 v71, v78, v79
    ds_write_b128 v52, v[64:67] offset:0
    ds_write_b128 v52, v[68:71] offset:1024
    v_lshlrev_b32 v8, 1, v11
    buffer_store_dwordx2 v[60:61], v8, s[4:7], s75 offen sc1
    s_waitcnt vmcnt(5)
    v_cmp_ne_u32 vcc, s49, v114
    v_cmp_ne_u32 s[68:69], s49, v115
    s_mov_b32 s48, 1
    s_or_b64 vcc, vcc, s[68:69]
    s_cbranch_vccnz L_notone_16
L_one_17:
    v_accvgpr_read_b32 v4, a186
    s_waitcnt lgkmcnt(0)
    s_barrier
    ds_read_b128 a[128:131], v55
    ds_read_b128 v[128:131], v57
    ds_read_b128 a[132:135], v55 offset:6144
    s_mov_b64 exec, s[60:61]
    ds_read_b128 v[132:135], v58 offset:1024
    ds_read_b128 v[136:139], v58 offset:1536
    ds_read_b128 v[144:147], v58 offset:13312
    ds_read_b128 v[148:151], v58 offset:13824
    s_mov_b64 exec, -1
    ds_read_b128 a[136:139], v56
    ds_read_b128 a[140:143], v56 offset:6144
    ds_read_b128 v[140:143], v57 offset:12288
    s_waitcnt lgkmcnt(8)
    v_mfma_f32_32x32x16_bf16 v[16:31], v[128:131], a[128:131], 0
    s_nop 9
    .p2align 3
    s_waitcnt lgkmcnt(0)
    v_mfma_f32_32x32x16_bf16 v[32:47], v[128:131], a[132:135], 0
    v_exp_f32 v16, v16
    v_exp_f32 v17, v17
    v_exp_f32 v18, v18
    v_exp_f32 v19, v19
    v_exp_f32 v20, v20
    v_exp_f32 v21, v21
    v_exp_f32 v22, v22
    v_exp_f32 v23, v23
    v_exp_f32 v24, v24
    v_exp_f32 v25, v25
    v_smfmac_f32_32x32x32_bf16 v[160:175], v[132:135], v[16:23], v3
    v_mov_b64 v[68:69], v[236:237]
    v_mov_b64 v[70:71], v[236:237]
    v_mov_b64 v[72:73], v[236:237]
    v_mov_b64 v[74:75], v[236:237]
    v_exp_f32 v26, v26
    v_exp_f32 v27, v27
    v_exp_f32 v28, v28
    v_exp_f32 v29, v29
    v_exp_f32 v30, v30
    v_exp_f32 v31, v31
    v_mfma_f32_32x32x16_bf16 v[48:63], v[128:131], a[136:139], 0
    v_mov_b64 v[80:81], v[236:237]
    v_mov_b64 v[82:83], v[236:237]
    v_mov_b64 v[84:85], v[236:237]
    v_mov_b64 v[86:87], v[236:237]
    v_exp_f32 v32, v32
    v_exp_f32 v33, v33
    v_exp_f32 v34, v34
    v_exp_f32 v35, v35
    v_smfmac_f32_32x32x32_bf16 v[160:175], v[136:139], v[24:31], v3
    s_waitcnt vmcnt(0)
    s_cmp_eq_u32 s48, 0
    s_cbranch_scc1 L_slow_18
    buffer_store_dword v5, off, s[4:7], s92
L_st_19:
    v_exp_f32 v36, v36
    v_exp_f32 v37, v37
    v_exp_f32 v38, v38
    v_exp_f32 v39, v39
    v_exp_f32 v40, v40
    v_exp_f32 v41, v41
    v_smfmac_f32_32x32x32_bf16 v[176:191], v[132:135], v[32:39], v3
    v_exp_f32 v42, v42
    v_exp_f32 v43, v43
    v_exp_f32 v44, v44
    v_exp_f32 v45, v45
    v_exp_f32 v46, v46
    v_exp_f32 v47, v47
    v_mfma_f32_32x32x16_bf16 v[16:31], v[128:131], a[140:143], 0
    v_mov_b64 v[92:93], v[236:237]
    v_mov_b64 v[94:95], v[236:237]
    v_mov_b64 v[96:97], v[236:237]
    v_mov_b64 v[98:99], v[236:237]
    v_exp_f32 v48, v48
    v_exp_f32 v49, v49
    v_exp_f32 v50, v50
    v_exp_f32 v51, v51
    v_smfmac_f32_32x32x32_bf16 v[176:191], v[136:139], v[40:47], v3
    buffer_load_dword v9, v238, s[4:7], s85 offen sc1
    v_exp_f32 v52, v52
    v_exp_f32 v53, v53
    v_exp_f32 v54, v54
    v_exp_f32 v55, v55
    v_exp_f32 v56, v56
    v_exp_f32 v57, v57
    v_smfmac_f32_32x32x32_bf16 v[192:207], v[132:135], v[48:55], v3
    v_exp_f32 v58, v58
    v_exp_f32 v59, v59
    v_exp_f32 v60, v60
    v_exp_f32 v61, v61
    v_exp_f32 v62, v62
    v_exp_f32 v63, v63
    v_mfma_f32_32x32x16_bf16 v[32:47], v[140:143], a[128:131], 0
    v_mov_b64 v[104:105], v[236:237]
    v_mov_b64 v[106:107], v[236:237]
    v_mov_b64 v[108:109], v[236:237]
    v_mov_b64 v[110:111], v[236:237]
    v_exp_f32 v16, v16
    v_exp_f32 v17, v17
    v_exp_f32 v18, v18
    v_exp_f32 v19, v19
    v_smfmac_f32_32x32x32_bf16 v[192:207], v[136:139], v[56:63], v3
    s_mov_b32 s50, 0x80000
    s_waitcnt vmcnt(0)
    v_cmp_ne_u32 vcc, s47, v9
    s_cbranch_vccnz L_retry_20
L_got_21:
    s_mov_b32 s88, s89
    s_add_u32 s93, s88, s63
    buffer_load_dwordx4 v[64:67], v2, s[4:7], s93 offen sc1
    v_exp_f32 v20, v20
    v_exp_f32 v21, v21
    v_exp_f32 v22, v22
    v_exp_f32 v23, v23
    v_exp_f32 v24, v24
    v_exp_f32 v25, v25
    v_smfmac_f32_32x32x32_bf16 v[208:223], v[132:135], v[16:23], v3
    s_mov_b64 exec, s[60:61]
    buffer_load_dwordx4 v[68:71], v12, s[4:7], s93 offen offset:1024 sc1
    buffer_load_dwordx4 v[72:75], v12, s[4:7], s93 offen offset:1536 sc1
    s_mov_b64 exec, -1
    buffer_store_dword v5, off, s[4:7], s91 sc1
    v_exp_f32 v26, v26
    v_exp_f32 v27, v27
    v_exp_f32 v28, v28
    v_exp_f32 v29, v29
    v_exp_f32 v30, v30
    v_exp_f32 v31, v31
    v_mfma_f32_32x32x16_bf16 v[48:63], v[140:143], a[132:135], 0
    v_mov_b64 v[116:117], v[236:237]
    v_mov_b64 v[118:119], v[236:237]
    v_mov_b64 v[120:121], v[236:237]
    v_mov_b64 v[122:123], v[236:237]
    v_exp_f32 v32, v32
    v_exp_f32 v33, v33
    v_exp_f32 v34, v34
    v_exp_f32 v35, v35
    v_smfmac_f32_32x32x32_bf16 v[208:223], v[136:139], v[24:31], v3
    s_add_u32 s88, s88, 4096
    s_and_b32 s88, s88, 0x1ffff
    s_add_u32 s93, s88, s63
    buffer_load_dwordx4 v[76:79], v2, s[4:7], s93 offen sc1
    v_exp_f32 v36, v36
    v_exp_f32 v37, v37
    v_exp_f32 v38, v38
    v_exp_f32 v39, v39
    v_exp_f32 v40, v40
    v_exp_f32 v41, v41
    v_smfmac_f32_32x32x32_bf16 v[160:175], v[144:147], v[32:39], v3
    s_mov_b64 exec, s[60:61]
    buffer_load_dwordx4 v[80:83], v12, s[4:7], s93 offen offset:1024 sc1
    buffer_load_dwordx4 v[84:87], v12, s[4:7], s93 offen offset:1536 sc1
    s_mov_b64 exec, -1
    v_exp_f32 v42, v42
    v_exp_f32 v43, v43
    v_exp_f32 v44, v44
    v_exp_f32 v45, v45
    v_exp_f32 v46, v46
    v_exp_f32 v47, v47
    v_mfma_f32_32x32x16_bf16 v[16:31], v[140:143], a[136:139], 0
    v_exp_f32 v48, v48
    v_exp_f32 v49, v49
    v_exp_f32 v50, v50
    v_exp_f32 v51, v51
    v_smfmac_f32_32x32x32_bf16 v[160:175], v[148:151], v[40:47], v3
    v_exp_f32 v52, v52
    v_exp_f32 v53, v53
    v_exp_f32 v54, v54
    v_exp_f32 v55, v55
    v_exp_f32 v56, v56
    v_exp_f32 v57, v57
    v_smfmac_f32_32x32x32_bf16 v[176:191], v[144:147], v[48:55], v3
    v_exp_f32 v58, v58
    v_exp_f32 v59, v59
    v_exp_f32 v60, v60
    v_exp_f32 v61, v61
    v_exp_f32 v62, v62
    v_exp_f32 v63, v63
    v_mfma_f32_32x32x16_bf16 v[32:47], v[140:143], a[140:143], 0
    v_exp_f32 v16, v16
    v_exp_f32 v17, v17
    v_exp_f32 v18, v18
    v_exp_f32 v19, v19
    v_smfmac_f32_32x32x32_bf16 v[176:191], v[148:151], v[56:63], v3
    v_exp_f32 v20, v20
    v_exp_f32 v21, v21
    v_exp_f32 v22, v22
    v_exp_f32 v23, v23
    v_exp_f32 v24, v24
    v_exp_f32 v25, v25
    v_smfmac_f32_32x32x32_bf16 v[192:207], v[144:147], v[16:23], v3
    s_barrier
    v_exp_f32 v26, v26
    v_exp_f32 v27, v27
    v_exp_f32 v28, v28
    v_exp_f32 v29, v29
    v_exp_f32 v30, v30
    v_exp_f32 v31, v31
    s_waitcnt vmcnt(4)
    v_mfma_f32_32x32x16_bf16 v[48:63], v[64:67], a[128:131], 0
    v_exp_f32 v32, v32
    v_exp_f32 v33, v33
    v_exp_f32 v34, v34
    v_exp_f32 v35, v35
    v_smfmac_f32_32x32x32_bf16 v[192:207], v[148:151], v[24:31], v3
    v_exp_f32 v36, v36
    v_exp_f32 v37, v37
    v_exp_f32 v38, v38
    v_exp_f32 v39, v39
    v_exp_f32 v40, v40
    v_exp_f32 v41, v41
    v_smfmac_f32_32x32x32_bf16 v[208:223], v[144:147], v[32:39], v3
    buffer_load_dword v9, v253, s[4:7], s84 offen sc1
    v_exp_f32 v42, v42
    v_exp_f32 v43, v43
    v_exp_f32 v44, v44
    v_exp_f32 v45, v45
    v_exp_f32 v46, v46
    v_exp_f32 v47, v47
    v_mfma_f32_32x32x16_bf16 v[16:31], v[64:67], a[132:135], 0
    v_exp_f32 v48, v48
    v_exp_f32 v49, v49
    v_exp_f32 v50, v50
    v_exp_f32 v51, v51
    v_smfmac_f32_32x32x32_bf16 v[208:223], v[148:151], v[40:47], v3
    v_exp_f32 v52, v52
    v_exp_f32 v53, v53
    v_exp_f32 v54, v54
    v_exp_f32 v55, v55
    v_exp_f32 v56, v56
    v_exp_f32 v57, v57
    v_smfmac_f32_32x32x32_bf16 v[160:175], v[68:71], v[48:55], v3
    v_exp_f32 v58, v58
    v_exp_f32 v59, v59
    v_exp_f32 v60, v60
    v_exp_f32 v61, v61
    v_exp_f32 v62, v62
    v_exp_f32 v63, v63
    v_mfma_f32_32x32x16_bf16 v[32:47], v[64:67], a[136:139], 0
    v_exp_f32 v16, v16
    v_exp_f32 v17, v17
    v_exp_f32 v18, v18
    v_exp_f32 v19, v19
    v_smfmac_f32_32x32x32_bf16 v[160:175], v[72:75], v[56:63], v3
    v_exp_f32 v20, v20
    v_exp_f32 v21, v21
    v_exp_f32 v22, v22
    v_exp_f32 v23, v23
    v_exp_f32 v24, v24
    v_exp_f32 v25, v25
    v_smfmac_f32_32x32x32_bf16 v[176:191], v[68:71], v[16:23], v3
    v_exp_f32 v26, v26
    v_exp_f32 v27, v27
    v_exp_f32 v28, v28
    v_exp_f32 v29, v29
    v_exp_f32 v30, v30
    v_exp_f32 v31, v31
    v_mfma_f32_32x32x16_bf16 v[48:63], v[64:67], a[140:143], 0
    v_exp_f32 v32, v32
    v_exp_f32 v33, v33
    v_exp_f32 v34, v34
    v_exp_f32 v35, v35
    v_smfmac_f32_32x32x32_bf16 v[176:191], v[72:75], v[24:31], v3
    v_exp_f32 v36, v36
    v_exp_f32 v37, v37
    v_exp_f32 v38, v38
    v_exp_f32 v39, v39
    v_exp_f32 v40, v40
    v_exp_f32 v41, v41
    v_smfmac_f32_32x32x32_bf16 v[192:207], v[68:71], v[32:39], v3
    v_exp_f32 v42, v42
    v_exp_f32 v43, v43
    v_exp_f32 v44, v44
    v_exp_f32 v45, v45
    v_exp_f32 v46, v46
    v_exp_f32 v47, v47
    s_waitcnt vmcnt(1)
    v_mfma_f32_32x32x16_bf16 v[16:31], v[76:79], a[128:131], 0
    v_exp_f32 v48, v48
    v_exp_f32 v49, v49
    v_exp_f32 v50, v50
    v_exp_f32 v51, v51
    v_smfmac_f32_32x32x32_bf16 v[192:207], v[72:75], v[40:47], v3
    s_mov_b32 s50, 0x80000
    s_waitcnt vmcnt(0)
    v_cmp_ne_u32 vcc, s47, v9
    s_cbranch_vccnz L_retry_22
L_got_23:
    s_mov_b32 s88, s90
    s_add_u32 s93, s88, s63
    buffer_load_dwordx4 v[88:91], v2, s[4:7], s93 offen sc1
    v_exp_f32 v52, v52
    v_exp_f32 v53, v53
    v_exp_f32 v54, v54
    v_exp_f32 v55, v55
    v_exp_f32 v56, v56
    v_exp_f32 v57, v57
    v_smfmac_f32_32x32x32_bf16 v[208:223], v[68:71], v[48:55], v3
    s_mov_b64 exec, s[60:61]
    buffer_load_dwordx4 v[92:95], v12, s[4:7], s93 offen offset:1024 sc1
    buffer_load_dwordx4 v[96:99], v12, s[4:7], s93 offen offset:1536 sc1
    s_mov_b64 exec, -1
    v_exp_f32 v58, v58
    v_exp_f32 v59, v59
    v_exp_f32 v60, v60
    v_exp_f32 v61, v61
    v_exp_f32 v62, v62
    v_exp_f32 v63, v63
    v_mfma_f32_32x32x16_bf16 v[32:47], v[76:79], a[132:135], 0
    v_exp_f32 v16, v16
    v_exp_f32 v17, v17
    v_exp_f32 v18, v18
    v_exp_f32 v19, v19
    v_smfmac_f32_32x32x32_bf16 v[208:223], v[72:75], v[56:63], v3
    s_add_u32 s88, s88, 4096
    s_and_b32 s88, s88, 0x1ffff
    s_add_u32 s93, s88, s63
    buffer_load_dwordx4 v[100:103], v2, s[4:7], s93 offen sc1
    v_exp_f32 v20, v20
    v_exp_f32 v21, v21
    v_exp_f32 v22, v22
    v_exp_f32 v23, v23
    v_exp_f32 v24, v24
    v_exp_f32 v25, v25
    v_smfmac_f32_32x32x32_bf16 v[160:175], v[80:83], v[16:23], v3
    s_mov_b64 exec, s[60:61]
    buffer_load_dwordx4 v[104:107], v12, s[4:7], s93 offen offset:1024 sc1
    buffer_load_dwordx4 v[108:111], v12, s[4:7], s93 offen offset:1536 sc1
    s_mov_b64 exec, -1
    v_exp_f32 v26, v26
    v_exp_f32 v27, v27
    v_exp_f32 v28, v28
    v_exp_f32 v29, v29
    v_exp_f32 v30, v30
    v_exp_f32 v31, v31
    v_mfma_f32_32x32x16_bf16 v[48:63], v[76:79], a[136:139], 0
    v_exp_f32 v32, v32
    v_exp_f32 v33, v33
    v_exp_f32 v34, v34
    v_exp_f32 v35, v35
    v_smfmac_f32_32x32x32_bf16 v[160:175], v[84:87], v[24:31], v3
    s_add_u32 s88, s88, 4096
    s_and_b32 s88, s88, 0x1ffff
    s_add_u32 s93, s88, s63
    buffer_load_dwordx4 v[112:115], v2, s[4:7], s93 offen sc1
    v_exp_f32 v36, v36
    v_exp_f32 v37, v37
    v_exp_f32 v38, v38
    v_exp_f32 v39, v39
    v_exp_f32 v40, v40
    v_exp_f32 v41, v41
    v_smfmac_f32_32x32x32_bf16 v[176:191], v[80:83], v[32:39], v3
    s_mov_b64 exec, s[60:61]
    buffer_load_dwordx4 v[116:119], v12, s[4:7], s93 offen offset:1024 sc1
    buffer_load_dwordx4 v[120:123], v12, s[4:7], s93 offen offset:1536 sc1
    s_mov_b64 exec, -1
    v_exp_f32 v42, v42
    v_exp_f32 v43, v43
    v_exp_f32 v44, v44
    v_exp_f32 v45, v45
    v_exp_f32 v46, v46
    v_exp_f32 v47, v47
    v_mfma_f32_32x32x16_bf16 v[16:31], v[76:79], a[140:143], 0
    v_exp_f32 v48, v48
    v_exp_f32 v49, v49
    v_exp_f32 v50, v50
    v_exp_f32 v51, v51
    v_smfmac_f32_32x32x32_bf16 v[176:191], v[84:87], v[40:47], v3
    s_add_u32 s88, s88, 4096
    s_and_b32 s88, s88, 0x1ffff
    s_add_u32 s93, s88, s63
    buffer_load_dwordx4 v[224:227], v2, s[4:7], s93 offen sc1
    v_exp_f32 v52, v52
    v_exp_f32 v53, v53
    v_exp_f32 v54, v54
    v_exp_f32 v55, v55
    v_exp_f32 v56, v56
    v_exp_f32 v57, v57
    v_smfmac_f32_32x32x32_bf16 v[192:207], v[80:83], v[48:55], v3
    buffer_load_dword v9, v254, s[4:7], s84 offen sc1
    s_mov_b64 exec, s[60:61]
    buffer_load_dwordx4 v[228:231], v12, s[4:7], s93 offen offset:1024 sc1
    buffer_load_dwordx4 v[232:235], v12, s[4:7], s93 offen offset:1536 sc1
    s_mov_b64 exec, -1
    v_exp_f32 v58, v58
    v_exp_f32 v59, v59
    v_exp_f32 v60, v60
    v_exp_f32 v61, v61
    v_exp_f32 v62, v62
    v_exp_f32 v63, v63
    s_waitcnt vmcnt(10)
    v_mfma_f32_32x32x16_bf16 v[32:47], v[88:91], a[128:131], 0
    v_exp_f32 v16, v16
    v_exp_f32 v17, v17
    v_exp_f32 v18, v18
    v_exp_f32 v19, v19
    v_smfmac_f32_32x32x32_bf16 v[192:207], v[84:87], v[56:63], v3
    v_exp_f32 v20, v20
    v_exp_f32 v21, v21
    v_exp_f32 v22, v22
    v_exp_f32 v23, v23
    v_exp_f32 v24, v24
    v_exp_f32 v25, v25
    v_smfmac_f32_32x32x32_bf16 v[208:223], v[80:83], v[16:23], v3
    v_exp_f32 v26, v26
    v_exp_f32 v27, v27
    v_exp_f32 v28, v28
    v_exp_f32 v29, v29
    v_exp_f32 v30, v30
    v_exp_f32 v31, v31
    v_mfma_f32_32x32x16_bf16 v[48:63], v[88:91], a[132:135], 0
    v_exp_f32 v32, v32
    v_exp_f32 v33, v33
    v_exp_f32 v34, v34
    v_exp_f32 v35, v35
    v_smfmac_f32_32x32x32_bf16 v[208:223], v[84:87], v[24:31], v3
    v_exp_f32 v36, v36
    v_exp_f32 v37, v37
    v_exp_f32 v38, v38
    v_exp_f32 v39, v39
    v_exp_f32 v40, v40
    v_exp_f32 v41, v41
    v_smfmac_f32_32x32x32_bf16 v[160:175], v[92:95], v[32:39], v3
    v_exp_f32 v42, v42
    v_exp_f32 v43, v43
    v_exp_f32 v44, v44
    v_exp_f32 v45, v45
    v_exp_f32 v46, v46
    v_exp_f32 v47, v47
    v_mfma_f32_32x32x16_bf16 v[16:31], v[88:91], a[136:139], 0
    v_exp_f32 v48, v48
    v_exp_f32 v49, v49
    v_exp_f32 v50, v50
    v_exp_f32 v51, v51
    v_smfmac_f32_32x32x32_bf16 v[160:175], v[96:99], v[40:47], v3
    v_exp_f32 v52, v52
    v_exp_f32 v53, v53
    v_exp_f32 v54, v54
    v_exp_f32 v55, v55
    v_exp_f32 v56, v56
    v_exp_f32 v57, v57
    v_smfmac_f32_32x32x32_bf16 v[176:191], v[92:95], v[48:55], v3
    v_exp_f32 v58, v58
    v_exp_f32 v59, v59
    v_exp_f32 v60, v60
    v_exp_f32 v61, v61
    v_exp_f32 v62, v62
    v_exp_f32 v63, v63
    v_mfma_f32_32x32x16_bf16 v[32:47], v[88:91], a[140:143], 0
    v_exp_f32 v16, v16
    v_exp_f32 v17, v17
    v_exp_f32 v18, v18
    v_exp_f32 v19, v19
    v_smfmac_f32_32x32x32_bf16 v[176:191], v[96:99], v[56:63], v3
    s_mov_b32 s50, 0x80000
    s_waitcnt vmcnt(2)
    v_cmp_ne_u32 vcc, s47, v9
    s_cbranch_vccnz L_retry_24
L_got_25:
    s_add_u32 s88, s88, 4096
    s_and_b32 s88, s88, 0x1ffff
    s_add_u32 s93, s88, s63
    buffer_load_dwordx4 v[128:131], v2, s[4:7], s93 offen sc1
    v_exp_f32 v20, v20
    v_exp_f32 v21, v21
    v_exp_f32 v22, v22
    v_exp_f32 v23, v23
    v_exp_f32 v24, v24
    v_exp_f32 v25, v25
    v_smfmac_f32_32x32x32_bf16 v[192:207], v[92:95], v[16:23], v3
    s_mov_b64 exec, s[60:61]
    buffer_load_dwordx4 v[132:135], v12, s[4:7], s93 offen offset:1024 sc1
    buffer_load_dwordx4 v[136:139], v12, s[4:7], s93 offen offset:1536 sc1
    s_mov_b64 exec, -1
    v_exp_f32 v26, v26
    v_exp_f32 v27, v27
    v_exp_f32 v28, v28
    v_exp_f32 v29, v29
    v_exp_f32 v30, v30
    v_exp_f32 v31, v31
    v_mfma_f32_32x32x16_bf16 v[48:63], v[100:103], a[128:131], 0
    v_exp_f32 v32, v32
    v_exp_f32 v33, v33
    v_exp_f32 v34, v34
    v_exp_f32 v35, v35
    v_smfmac_f32_32x32x32_bf16 v[192:207], v[96:99], v[24:31], v3
    s_add_u32 s88, s88, 4096
    s_and_b32 s88, s88, 0x1ffff
    s_add_u32 s93, s88, s63
    buffer_load_dwordx4 v[140:143], v2, s[4:7], s93 offen sc1
    v_exp_f32 v36, v36
    v_exp_f32 v37, v37
    v_exp_f32 v38, v38
    v_exp_f32 v39, v39
    v_exp_f32 v40, v40
    v_exp_f32 v41, v41
    v_smfmac_f32_32x32x32_bf16 v[208:223], v[92:95], v[32:39], v3
    s_mov_b64 exec, s[60:61]
    buffer_load_dwordx4 v[144:147], v12, s[4:7], s93 offen offset:1024 sc1
    buffer_load_dwordx4 v[148:151], v12, s[4:7], s93 offen offset:1536 sc1
    s_mov_b64 exec, -1
    v_exp_f32 v42, v42
    v_exp_f32 v43, v43
    v_exp_f32 v44, v44
    v_exp_f32 v45, v45
    v_exp_f32 v46, v46
    v_exp_f32 v47, v47
    v_mfma_f32_32x32x16_bf16 v[16:31], v[100:103], a[132:135], 0
    v_exp_f32 v48, v48
    v_exp_f32 v49, v49
    v_exp_f32 v50, v50
    v_exp_f32 v51, v51
    v_smfmac_f32_32x32x32_bf16 v[208:223], v[96:99], v[40:47], v3
    s_add_u32 s88, s88, 4096
    s_and_b32 s88, s88, 0x1ffff
    s_add_u32 s93, s88, s63
    buffer_load_dwordx4 v[64:67], v2, s[4:7], s93 offen sc1
    v_exp_f32 v52, v52
    v_exp_f32 v53, v53
    v_exp_f32 v54, v54
    v_exp_f32 v55, v55
    v_exp_f32 v56, v56
    v_exp_f32 v57, v57
    v_smfmac_f32_32x32x32_bf16 v[160:175], v[104:107], v[48:55], v3
    s_mov_b64 exec, s[60:61]
    buffer_load_dwordx4 v[68:71], v12, s[4:7], s93 offen offset:1024 sc1
    buffer_load_dwordx4 v[72:75], v12, s[4:7], s93 offen offset:1536 sc1
    s_mov_b64 exec, -1
    v_exp_f32 v58, v58
    v_exp_f32 v59, v59
    v_exp_f32 v60, v60
    v_exp_f32 v61, v61
    v_exp_f32 v62, v62
    v_exp_f32 v63, v63
    v_mfma_f32_32x32x16_bf16 v[32:47], v[100:103], a[136:139], 0
    v_exp_f32 v16, v16
    v_exp_f32 v17, v17
    v_exp_f32 v18, v18
    v_exp_f32 v19, v19
    v_smfmac_f32_32x32x32_bf16 v[160:175], v[108:111], v[56:63], v3
    s_add_u32 s88, s88, 4096
    s_and_b32 s88, s88, 0x1ffff
    s_add_u32 s93, s88, s63
    buffer_load_dwordx4 v[76:79], v2, s[4:7], s93 offen sc1
    v_exp_f32 v20, v20
    v_exp_f32 v21, v21
    v_exp_f32 v22, v22
    v_exp_f32 v23, v23
    v_exp_f32 v24, v24
    v_exp_f32 v25, v25
    v_smfmac_f32_32x32x32_bf16 v[176:191], v[104:107], v[16:23], v3
    s_mov_b64 exec, s[60:61]
    buffer_load_dwordx4 v[80:83], v12, s[4:7], s93 offen offset:1024 sc1
    buffer_load_dwordx4 v[84:87], v12, s[4:7], s93 offen offset:1536 sc1
    s_mov_b64 exec, -1
    v_exp_f32 v26, v26
    v_exp_f32 v27, v27
    v_exp_f32 v28, v28
    v_exp_f32 v29, v29
    v_exp_f32 v30, v30
    v_exp_f32 v31, v31
    v_mfma_f32_32x32x16_bf16 v[48:63], v[100:103], a[140:143], 0
    v_exp_f32 v32, v32
    v_exp_f32 v33, v33
    v_exp_f32 v34, v34
    v_exp_f32 v35, v35
    v_smfmac_f32_32x32x32_bf16 v[176:191], v[108:111], v[24:31], v3
    s_add_u32 s88, s88, 4096
    s_and_b32 s88, s88, 0x1ffff
    s_add_u32 s93, s88, s63
    buffer_load_dwordx4 v[88:91], v2, s[4:7], s93 offen sc1
    v_exp_f32 v36, v36
    v_exp_f32 v37, v37
    v_exp_f32 v38, v38
    v_exp_f32 v39, v39
    v_exp_f32 v40, v40
    v_exp_f32 v41, v41
    v_smfmac_f32_32x32x32_bf16 v[192:207], v[104:107], v[32:39], v3
    s_mov_b64 exec, s[60:61]
    buffer_load_dwordx4 v[92:95], v12, s[4:7], s93 offen offset:1024 sc1
    buffer_load_dwordx4 v[96:99], v12, s[4:7], s93 offen offset:1536 sc1
    s_mov_b64 exec, -1
    v_exp_f32 v42, v42
    v_exp_f32 v43, v43
    v_exp_f32 v44, v44
    v_exp_f32 v45, v45
    v_exp_f32 v46, v46
    v_exp_f32 v47, v47
    v_mfma_f32_32x32x16_bf16 v[16:31], v[112:115], a[128:131], 0
    v_exp_f32 v48, v48
    v_exp_f32 v49, v49
    v_exp_f32 v50, v50
    v_exp_f32 v51, v51
    v_smfmac_f32_32x32x32_bf16 v[192:207], v[108:111], v[40:47], v3
    v_exp_f32 v52, v52
    v_exp_f32 v53, v53
    v_exp_f32 v54, v54
    v_exp_f32 v55, v55
    v_exp_f32 v56, v56
    v_exp_f32 v57, v57
    v_smfmac_f32_32x32x32_bf16 v[208:223], v[104:107], v[48:55], v3
    v_exp_f32 v58, v58
    v_exp_f32 v59, v59
    v_exp_f32 v60, v60
    v_exp_f32 v61, v61
    v_exp_f32 v62, v62
    v_exp_f32 v63, v63
    v_mfma_f32_32x32x16_bf16 v[32:47], v[112:115], a[132:135], 0
    v_exp_f32 v16, v16
    v_exp_f32 v17, v17
    v_exp_f32 v18, v18
    v_exp_f32 v19, v19
    v_smfmac_f32_32x32x32_bf16 v[208:223], v[108:111], v[56:63], v3
    s_add_u32 s88, s88, 4096
    s_and_b32 s88, s88, 0x1ffff
    s_add_u32 s93, s88, s63
    buffer_load_dwordx4 v[100:103], v2, s[4:7], s93 offen sc1
    v_accvgpr_read_b32 v8, a191
    buffer_load_dword v255, v8, s[20:23], 0 offen offset:0
    v_exp_f32 v20, v20
    v_exp_f32 v21, v21
    v_exp_f32 v22, v22
    v_exp_f32 v23, v23
    v_exp_f32 v24, v24
    v_exp_f32 v25, v25
    v_smfmac_f32_32x32x32_bf16 v[160:175], v[116:119], v[16:23], v3
    s_mov_b64 exec, s[60:61]
    buffer_load_dwordx4 v[104:107], v12, s[4:7], s93 offen offset:1024 sc1
    buffer_load_dwordx4 v[108:111], v12, s[4:7], s93 offen offset:1536 sc1
    s_mov_b64 exec, -1
    v_exp_f32 v26, v26
    v_exp_f32 v27, v27
    v_exp_f32 v28, v28
    v_exp_f32 v29, v29
    v_exp_f32 v30, v30
    v_exp_f32 v31, v31
    v_mfma_f32_32x32x16_bf16 v[48:63], v[112:115], a[136:139], 0
    v_exp_f32 v32, v32
    v_exp_f32 v33, v33
    v_exp_f32 v34, v34
    v_exp_f32 v35, v35
    v_smfmac_f32_32x32x32_bf16 v[160:175], v[120:123], v[24:31], v3
    s_add_u32 m0, s86, 0
    s_add_u32 s51, s87, 0
    v_exp_f32 v36, v36
    v_exp_f32 v37, v37
    v_exp_f32 v38, v38
    v_exp_f32 v39, v39
    v_exp_f32 v40, v40
    v_exp_f32 v41, v41
    v_smfmac_f32_32x32x32_bf16 v[176:191], v[116:119], v[32:39], v3
    buffer_load_dwordx4 v247, s[16:19], s51 offen offset:0 lds
    v_exp_f32 v42, v42
    v_exp_f32 v43, v43
    v_exp_f32 v44, v44
    v_exp_f32 v45, v45
    v_exp_f32 v46, v46
    v_exp_f32 v47, v47
    v_mfma_f32_32x32x16_bf16 v[16:31], v[112:115], a[140:143], 0
    v_exp_f32 v48, v48
    v_exp_f32 v49, v49
    v_exp_f32 v50, v50
    v_exp_f32 v51, v51
    v_smfmac_f32_32x32x32_bf16 v[176:191], v[120:123], v[40:47], v3
    v_exp_f32 v52, v52
    v_exp_f32 v53, v53
    v_exp_f32 v54, v54
    v_exp_f32 v55, v55
    v_exp_f32 v56, v56
    v_exp_f32 v57, v57
    v_smfmac_f32_32x32x32_bf16 v[192:207], v[116:119], v[48:55], v3
    buffer_load_dwordx4 v248, s[16:19], s51 offen offset:1024 lds
    v_exp_f32 v58, v58
    v_exp_f32 v59, v59
    v_exp_f32 v60, v60
    v_exp_f32 v61, v61
    v_exp_f32 v62, v62
    v_exp_f32 v63, v63
    s_waitcnt vmcnt(21)
    v_mfma_f32_32x32x16_bf16 v[32:47], v[224:227], a[128:131], 0
    v_exp_f32 v16, v16
    v_exp_f32 v17, v17
    v_exp_f32 v18, v18
    v_exp_f32 v19, v19
    v_smfmac_f32_32x32x32_bf16 v[192:207], v[120:123], v[56:63], v3
    s_add_u32 m0, s86, 2048
    s_add_u32 s51, s87, 16384
    v_exp_f32 v20, v20
    v_exp_f32 v21, v21
    v_exp_f32 v22, v22
    v_exp_f32 v23, v23
    v_exp_f32 v24, v24
    v_exp_f32 v25, v25
    v_smfmac_f32_32x32x32_bf16 v[208:223], v[116:119], v[16:23], v3
    buffer_load_dwordx4 v247, s[16:19], s51 offen offset:0 lds
    v_exp_f32 v26, v26
    v_exp_f32 v27, v27
    v_exp_f32 v28, v28
    v_exp_f32 v29, v29
    v_exp_f32 v30, v30
    v_exp_f32 v31, v31
    v_mfma_f32_32x32x16_bf16 v[48:63], v[224:227], a[132:135], 0
    buffer_load_dwordx4 v248, s[16:19], s51 offen offset:1024 lds
    v_exp_f32 v32, v32
    v_exp_f32 v33, v33
    v_exp_f32 v34, v34
    v_exp_f32 v35, v35
    v_smfmac_f32_32x32x32_bf16 v[208:223], v[120:123], v[24:31], v3
    s_add_u32 s88, s88, 4096
    s_and_b32 s88, s88, 0x1ffff
    s_add_u32 s93, s88, s63
    buffer_load_dwordx4 v[112:115], v2, s[4:7], s93 offen sc1
    v_exp_f32 v36, v36
    v_exp_f32 v37, v37
    v_exp_f32 v38, v38
    v_exp_f32 v39, v39
    v_exp_f32 v40, v40
    v_exp_f32 v41, v41
    v_smfmac_f32_32x32x32_bf16 v[160:175], v[228:231], v[32:39], v3
    s_mov_b64 exec, s[60:61]
    buffer_load_dwordx4 v[116:119], v12, s[4:7], s93 offen offset:1024 sc1
    buffer_load_dwordx4 v[120:123], v12, s[4:7], s93 offen offset:1536 sc1
    s_mov_b64 exec, -1
    v_exp_f32 v42, v42
    v_exp_f32 v43, v43
    v_exp_f32 v44, v44
    v_exp_f32 v45, v45
    v_exp_f32 v46, v46
    v_exp_f32 v47, v47
    v_mfma_f32_32x32x16_bf16 v[16:31], v[224:227], a[136:139], 0
    v_exp_f32 v48, v48
    v_exp_f32 v49, v49
    v_exp_f32 v50, v50
    v_exp_f32 v51, v51
    v_smfmac_f32_32x32x32_bf16 v[160:175], v[232:235], v[40:47], v3
    s_add_u32 m0, s86, 4096
    s_add_u32 s51, s87, 32768
    v_exp_f32 v52, v52
    v_exp_f32 v53, v53
    v_exp_f32 v54, v54
    v_exp_f32 v55, v55
    v_exp_f32 v56, v56
    v_exp_f32 v57, v57
    v_smfmac_f32_32x32x32_bf16 v[176:191], v[228:231], v[48:55], v3
    buffer_load_dwordx4 v247, s[16:19], s51 offen offset:0 lds
    v_exp_f32 v58, v58
    v_exp_f32 v59, v59
    v_exp_f32 v60, v60
    v_exp_f32 v61, v61
    v_exp_f32 v62, v62
    v_exp_f32 v63, v63
    v_mfma_f32_32x32x16_bf16 v[32:47], v[224:227], a[140:143], 0
    v_exp_f32 v16, v16
    v_exp_f32 v17, v17
    v_exp_f32 v18, v18
    v_exp_f32 v19, v19
    v_smfmac_f32_32x32x32_bf16 v[176:191], v[232:235], v[56:63], v3
    v_exp_f32 v20, v20
    v_exp_f32 v21, v21
    v_exp_f32 v22, v22
    v_exp_f32 v23, v23
    v_exp_f32 v24, v24
    v_exp_f32 v25, v25
    v_smfmac_f32_32x32x32_bf16 v[192:207], v[228:231], v[16:23], v3
    buffer_load_dwordx4 v248, s[16:19], s51 offen offset:1024 lds
    v_exp_f32 v26, v26
    v_exp_f32 v27, v27
    v_exp_f32 v28, v28
    v_exp_f32 v29, v29
    v_exp_f32 v30, v30
    v_exp_f32 v31, v31
    s_waitcnt vmcnt(25)
    v_mfma_f32_32x32x16_bf16 v[48:63], v[128:131], a[128:131], 0
    v_exp_f32 v32, v32
    v_exp_f32 v33, v33
    v_exp_f32 v34, v34
    v_exp_f32 v35, v35
    v_smfmac_f32_32x32x32_bf16 v[192:207], v[232:235], v[24:31], v3
    s_add_u32 m0, s86, 6144
    s_add_u32 s51, s87, 49152
    v_exp_f32 v36, v36
    v_exp_f32 v37, v37
    v_exp_f32 v38, v38
    v_exp_f32 v39, v39
    v_exp_f32 v40, v40
    v_exp_f32 v41, v41
    v_smfmac_f32_32x32x32_bf16 v[208:223], v[228:231], v[32:39], v3
    buffer_load_dwordx4 v247, s[16:19], s51 offen offset:0 lds
    v_exp_f32 v42, v42
    v_exp_f32 v43, v43
    v_exp_f32 v44, v44
    v_exp_f32 v45, v45
    v_exp_f32 v46, v46
    v_exp_f32 v47, v47
    v_mfma_f32_32x32x16_bf16 v[16:31], v[128:131], a[132:135], 0
    buffer_load_dwordx4 v248, s[16:19], s51 offen offset:1024 lds
    v_exp_f32 v48, v48
    v_exp_f32 v49, v49
    v_exp_f32 v50, v50
    v_exp_f32 v51, v51
    v_smfmac_f32_32x32x32_bf16 v[208:223], v[232:235], v[40:47], v3
    s_add_u32 s88, s88, 4096
    s_and_b32 s88, s88, 0x1ffff
    s_add_u32 s93, s88, s63
    buffer_load_dwordx4 v[224:227], v2, s[4:7], s93 offen sc1
    v_exp_f32 v52, v52
    v_exp_f32 v53, v53
    v_exp_f32 v54, v54
    v_exp_f32 v55, v55
    v_exp_f32 v56, v56
    v_exp_f32 v57, v57
    v_smfmac_f32_32x32x32_bf16 v[160:175], v[132:135], v[48:55], v3
    s_mov_b64 exec, s[60:61]
    buffer_load_dwordx4 v[228:231], v12, s[4:7], s93 offen offset:1024 sc1
    buffer_load_dwordx4 v[232:235], v12, s[4:7], s93 offen offset:1536 sc1
    s_mov_b64 exec, -1
    v_exp_f32 v58, v58
    v_exp_f32 v59, v59
    v_exp_f32 v60, v60
    v_exp_f32 v61, v61
    v_exp_f32 v62, v62
    v_exp_f32 v63, v63
    v_mfma_f32_32x32x16_bf16 v[32:47], v[128:131], a[136:139], 0
    v_exp_f32 v16, v16
    v_exp_f32 v17, v17
    v_exp_f32 v18, v18
    v_exp_f32 v19, v19
    v_smfmac_f32_32x32x32_bf16 v[160:175], v[136:139], v[56:63], v3
    s_add_u32 m0, s86, 8192
    s_add_u32 s51, s87, 65536
    v_exp_f32 v20, v20
    v_exp_f32 v21, v21
    v_exp_f32 v22, v22
    v_exp_f32 v23, v23
    v_exp_f32 v24, v24
    v_exp_f32 v25, v25
    v_smfmac_f32_32x32x32_bf16 v[176:191], v[132:135], v[16:23], v3
    buffer_load_dwordx4 v247, s[16:19], s51 offen offset:0 lds
    v_exp_f32 v26, v26
    v_exp_f32 v27, v27
    v_exp_f32 v28, v28
    v_exp_f32 v29, v29
    v_exp_f32 v30, v30
    v_exp_f32 v31, v31
    v_mfma_f32_32x32x16_bf16 v[48:63], v[128:131], a[140:143], 0
    v_exp_f32 v32, v32
    v_exp_f32 v33, v33
    v_exp_f32 v34, v34
    v_exp_f32 v35, v35
    v_smfmac_f32_32x32x32_bf16 v[176:191], v[136:139], v[24:31], v3
    v_exp_f32 v36, v36
    v_exp_f32 v37, v37
    v_exp_f32 v38, v38
    v_exp_f32 v39, v39
    v_exp_f32 v40, v40
    v_exp_f32 v41, v41
    v_smfmac_f32_32x32x32_bf16 v[192:207], v[132:135], v[32:39], v3
    buffer_load_dwordx4 v248, s[16:19], s51 offen offset:1024 lds
    v_exp_f32 v42, v42
    v_exp_f32 v43, v43
    v_exp_f32 v44, v44
    v_exp_f32 v45, v45
    v_exp_f32 v46, v46
    v_exp_f32 v47, v47
    s_waitcnt vmcnt(29)
    v_mfma_f32_32x32x16_bf16 v[16:31], v[140:143], a[128:131], 0
    v_exp_f32 v48, v48
    v_exp_f32 v49, v49
    v_exp_f32 v50, v50
    v_exp_f32 v51, v51
    v_smfmac_f32_32x32x32_bf16 v[192:207], v[136:139], v[40:47], v3
    s_add_u32 m0, s86, 10240
    s_add_u32 s51, s87, 81920
    v_exp_f32 v52, v52
    v_exp_f32 v53, v53
    v_exp_f32 v54, v54
    v_exp_f32 v55, v55
    v_exp_f32 v56, v56
    v_exp_f32 v57, v57
    v_smfmac_f32_32x32x32_bf16 v[208:223], v[132:135], v[48:55], v3
    buffer_load_dwordx4 v247, s[16:19], s51 offen offset:0 lds
    v_exp_f32 v58, v58
    v_exp_f32 v59, v59
    v_exp_f32 v60, v60
    v_exp_f32 v61, v61
    v_exp_f32 v62, v62
    v_exp_f32 v63, v63
    v_mfma_f32_32x32x16_bf16 v[32:47], v[140:143], a[132:135], 0
    buffer_load_dwordx4 v248, s[16:19], s51 offen offset:1024 lds
    v_exp_f32 v16, v16
    v_exp_f32 v17, v17
    v_exp_f32 v18, v18
    v_exp_f32 v19, v19
    v_smfmac_f32_32x32x32_bf16 v[208:223], v[136:139], v[56:63], v3
    s_add_u32 s88, s88, 4096
    s_and_b32 s88, s88, 0x1ffff
    s_add_u32 s93, s88, s63
    buffer_load_dwordx4 v[128:131], v2, s[4:7], s93 offen sc1
    v_exp_f32 v20, v20
    v_exp_f32 v21, v21
    v_exp_f32 v22, v22
    v_exp_f32 v23, v23
    v_exp_f32 v24, v24
    v_exp_f32 v25, v25
    v_smfmac_f32_32x32x32_bf16 v[160:175], v[144:147], v[16:23], v3
    s_mov_b64 exec, s[60:61]
    buffer_load_dwordx4 v[132:135], v12, s[4:7], s93 offen offset:1024 sc1
    buffer_load_dwordx4 v[136:139], v12, s[4:7], s93 offen offset:1536 sc1
    s_mov_b64 exec, -1
    v_exp_f32 v26, v26
    v_exp_f32 v27, v27
    v_exp_f32 v28, v28
    v_exp_f32 v29, v29
    v_exp_f32 v30, v30
    v_exp_f32 v31, v31
    v_mfma_f32_32x32x16_bf16 v[48:63], v[140:143], a[136:139], 0
    v_exp_f32 v32, v32
    v_exp_f32 v33, v33
    v_exp_f32 v34, v34
    v_exp_f32 v35, v35
    v_smfmac_f32_32x32x32_bf16 v[160:175], v[148:151], v[24:31], v3
    s_add_u32 m0, s86, 12288
    s_add_u32 s51, s87, 98304
    v_exp_f32 v36, v36
    v_exp_f32 v37, v37
    v_exp_f32 v38, v38
    v_exp_f32 v39, v39
    v_exp_f32 v40, v40
    v_exp_f32 v41, v41
    v_smfmac_f32_32x32x32_bf16 v[176:191], v[144:147], v[32:39], v3
    buffer_load_dwordx4 v247, s[16:19], s51 offen offset:0 lds
    v_exp_f32 v42, v42
    v_exp_f32 v43, v43
    v_exp_f32 v44, v44
    v_exp_f32 v45, v45
    v_exp_f32 v46, v46
    v_exp_f32 v47, v47
    v_mfma_f32_32x32x16_bf16 v[16:31], v[140:143], a[140:143], 0
    v_exp_f32 v48, v48
    v_exp_f32 v49, v49
    v_exp_f32 v50, v50
    v_exp_f32 v51, v51
    v_smfmac_f32_32x32x32_bf16 v[176:191], v[148:151], v[40:47], v3
    v_exp_f32 v52, v52
    v_exp_f32 v53, v53
    v_exp_f32 v54, v54
    v_exp_f32 v55, v55
    v_exp_f32 v56, v56
    v_exp_f32 v57, v57
    v_smfmac_f32_32x32x32_bf16 v[192:207], v[144:147], v[48:55], v3
    buffer_load_dwordx4 v248, s[16:19], s51 offen offset:1024 lds
    v_exp_f32 v58, v58
    v_exp_f32 v59, v59
    v_exp_f32 v60, v60
    v_exp_f32 v61, v61
    v_exp_f32 v62, v62
    v_exp_f32 v63, v63
    s_waitcnt vmcnt(33)
    v_mfma_f32_32x32x16_bf16 v[32:47], v[64:67], a[128:131], 0
    v_exp_f32 v16, v16
    v_exp_f32 v17, v17
    v_exp_f32 v18, v18
    v_exp_f32 v19, v19
    v_smfmac_f32_32x32x32_bf16 v[192:207], v[148:151], v[56:63], v3
    s_add_u32 m0, s86, 14336
    s_add_u32 s51, s87, 114688
    v_exp_f32 v20, v20
    v_exp_f32 v21, v21
    v_exp_f32 v22, v22
    v_exp_f32 v23, v23
    v_exp_f32 v24, v24
    v_exp_f32 v25, v25
    v_smfmac_f32_32x32x32_bf16 v[208:223], v[144:147], v[16:23], v3
    buffer_load_dwordx4 v247, s[16:19], s51 offen offset:0 lds
    v_exp_f32 v26, v26
    v_exp_f32 v27, v27
    v_exp_f32 v28, v28
    v_exp_f32 v29, v29
    v_exp_f32 v30, v30
    v_exp_f32 v31, v31
    v_mfma_f32_32x32x16_bf16 v[48:63], v[64:67], a[132:135], 0
    buffer_load_dwordx4 v248, s[16:19], s51 offen offset:1024 lds
    v_exp_f32 v32, v32
    v_exp_f32 v33, v33
    v_exp_f32 v34, v34
    v_exp_f32 v35, v35
    v_smfmac_f32_32x32x32_bf16 v[208:223], v[148:151], v[24:31], v3
    s_add_u32 s88, s88, 4096
    s_and_b32 s88, s88, 0x1ffff
    s_add_u32 s93, s88, s63
    buffer_load_dwordx4 v[140:143], v2, s[4:7], s93 offen sc1
    v_exp_f32 v36, v36
    v_exp_f32 v37, v37
    v_exp_f32 v38, v38
    v_exp_f32 v39, v39
    v_exp_f32 v40, v40
    v_exp_f32 v41, v41
    v_smfmac_f32_32x32x32_bf16 v[160:175], v[68:71], v[32:39], v3
    s_mov_b64 exec, s[60:61]
    buffer_load_dwordx4 v[144:147], v12, s[4:7], s93 offen offset:1024 sc1
    buffer_load_dwordx4 v[148:151], v12, s[4:7], s93 offen offset:1536 sc1
    s_mov_b64 exec, -1
    v_exp_f32 v42, v42
    v_exp_f32 v43, v43
    v_exp_f32 v44, v44
    v_exp_f32 v45, v45
    v_exp_f32 v46, v46
    v_exp_f32 v47, v47
    v_mfma_f32_32x32x16_bf16 v[16:31], v[64:67], a[136:139], 0
    v_exp_f32 v48, v48
    v_exp_f32 v49, v49
    v_exp_f32 v50, v50
    v_exp_f32 v51, v51
    v_smfmac_f32_32x32x32_bf16 v[160:175], v[72:75], v[40:47], v3
    s_add_u32 m0, s66, 0
    s_add_u32 s51, s67, 0
    v_exp_f32 v52, v52
    v_exp_f32 v53, v53
    v_exp_f32 v54, v54
    v_exp_f32 v55, v55
    v_exp_f32 v56, v56
    v_exp_f32 v57, v57
    v_smfmac_f32_32x32x32_bf16 v[176:191], v[68:71], v[48:55], v3
    buffer_load_dwordx4 v240, s[20:23], s51 offen offset:0 lds
    v_exp_f32 v58, v58
    v_exp_f32 v59, v59
    v_exp_f32 v60, v60
    v_exp_f32 v61, v61
    v_exp_f32 v62, v62
    v_exp_f32 v63, v63
    v_mfma_f32_32x32x16_bf16 v[32:47], v[64:67], a[140:143], 0
    v_exp_f32 v16, v16
    v_exp_f32 v17, v17
    v_exp_f32 v18, v18
    v_exp_f32 v19, v19
    v_smfmac_f32_32x32x32_bf16 v[176:191], v[72:75], v[56:63], v3
    v_exp_f32 v20, v20
    v_exp_f32 v21, v21
    v_exp_f32 v22, v22
    v_exp_f32 v23, v23
    v_exp_f32 v24, v24
    v_exp_f32 v25, v25
    v_smfmac_f32_32x32x32_bf16 v[192:207], v[68:71], v[16:23], v3
    buffer_load_dwordx4 v241, s[20:23], s51 offen offset:1024 lds
    v_exp_f32 v26, v26
    v_exp_f32 v27, v27
    v_exp_f32 v28, v28
    v_exp_f32 v29, v29
    v_exp_f32 v30, v30
    v_exp_f32 v31, v31
    s_waitcnt vmcnt(37)
    v_mfma_f32_32x32x16_bf16 v[48:63], v[76:79], a[128:131], 0
    v_exp_f32 v32, v32
    v_exp_f32 v33, v33
    v_exp_f32 v34, v34
    v_exp_f32 v35, v35
    v_smfmac_f32_32x32x32_bf16 v[192:207], v[72:75], v[24:31], v3
    v_exp_f32 v36, v36
    v_exp_f32 v37, v37
    v_exp_f32 v38, v38
    v_exp_f32 v39, v39
    v_exp_f32 v40, v40
    v_exp_f32 v41, v41
    v_smfmac_f32_32x32x32_bf16 v[208:223], v[68:71], v[32:39], v3
    buffer_load_dwordx4 v242, s[20:23], s51 offen offset:2048 lds
    v_exp_f32 v42, v42
    v_exp_f32 v43, v43
    v_exp_f32 v44, v44
    v_exp_f32 v45, v45
    v_exp_f32 v46, v46
    v_exp_f32 v47, v47
    v_mfma_f32_32x32x16_bf16 v[16:31], v[76:79], a[132:135], 0
    buffer_load_dwordx4 v243, s[20:23], s51 offen offset:3072 lds
    v_exp_f32 v48, v48
    v_exp_f32 v49, v49
    v_exp_f32 v50, v50
    v_exp_f32 v51, v51
    v_smfmac_f32_32x32x32_bf16 v[208:223], v[72:75], v[40:47], v3
    s_add_u32 s88, s88, 4096
    s_and_b32 s88, s88, 0x1ffff
    s_add_u32 s93, s88, s63
    buffer_load_dwordx4 v[64:67], v2, s[4:7], s93 offen sc1
    v_exp_f32 v52, v52
    v_exp_f32 v53, v53
    v_exp_f32 v54, v54
    v_exp_f32 v55, v55
    v_exp_f32 v56, v56
    v_exp_f32 v57, v57
    v_smfmac_f32_32x32x32_bf16 v[160:175], v[80:83], v[48:55], v3
    s_mov_b64 exec, s[60:61]
    buffer_load_dwordx4 v[68:71], v12, s[4:7], s93 offen offset:1024 sc1
    buffer_load_dwordx4 v[72:75], v12, s[4:7], s93 offen offset:1536 sc1
    s_mov_b64 exec, -1
    v_exp_f32 v58, v58
    v_exp_f32 v59, v59
    v_exp_f32 v60, v60
    v_exp_f32 v61, v61
    v_exp_f32 v62, v62
    v_exp_f32 v63, v63
    v_mfma_f32_32x32x16_bf16 v[32:47], v[76:79], a[136:139], 0
    v_exp_f32 v16, v16
    v_exp_f32 v17, v17
    v_exp_f32 v18, v18
    v_exp_f32 v19, v19
    v_smfmac_f32_32x32x32_bf16 v[160:175], v[84:87], v[56:63], v3
    s_add_u32 m0, s66, 4096
    s_nop 0
    v_exp_f32 v20, v20
    v_exp_f32 v21, v21
    v_exp_f32 v22, v22
    v_exp_f32 v23, v23
    v_exp_f32 v24, v24
    v_exp_f32 v25, v25
    v_smfmac_f32_32x32x32_bf16 v[176:191], v[80:83], v[16:23], v3
    buffer_load_dwordx4 v244, s[20:23], s51 offen offset:0 lds
    v_exp_f32 v26, v26
    v_exp_f32 v27, v27
    v_exp_f32 v28, v28
    v_exp_f32 v29, v29
    v_exp_f32 v30, v30
    v_exp_f32 v31, v31
    v_mfma_f32_32x32x16_bf16 v[48:63], v[76:79], a[140:143], 0
    v_exp_f32 v32, v32
    v_exp_f32 v33, v33
    v_exp_f32 v34, v34
    v_exp_f32 v35, v35
    v_smfmac_f32_32x32x32_bf16 v[176:191], v[84:87], v[24:31], v3
    s_waitcnt vmcnt(11)
    s_barrier
    v_exp_f32 v36, v36
    v_exp_f32 v37, v37
    v_exp_f32 v38, v38
    v_exp_f32 v39, v39
    v_exp_f32 v40, v40
    v_exp_f32 v41, v41
    v_smfmac_f32_32x32x32_bf16 v[192:207], v[80:83], v[32:39], v3
    buffer_load_dwordx4 v245, s[20:23], s51 offen offset:1024 lds
    v_exp_f32 v42, v42
    v_exp_f32 v43, v43
    v_exp_f32 v44, v44
    v_exp_f32 v45, v45
    v_exp_f32 v46, v46
    v_exp_f32 v47, v47
    v_mfma_f32_32x32x16_bf16 v[16:31], v[88:91], a[128:131], 0
    ds_read_b64_tr_b16 a[4:5], v250 offset:0
    ds_read_b64_tr_b16 a[6:7], v250 offset:512
    v_exp_f32 v48, v48
    v_exp_f32 v49, v49
    v_exp_f32 v50, v50
    v_exp_f32 v51, v51
    v_smfmac_f32_32x32x32_bf16 v[192:207], v[84:87], v[40:47], v3
    ds_read_b64_tr_b16 a[0:1], v249 offset:0
    ds_read_b64_tr_b16 a[2:3], v249 offset:512
    v_exp_f32 v52, v52
    v_exp_f32 v53, v53
    v_exp_f32 v54, v54
    v_exp_f32 v55, v55
    v_exp_f32 v56, v56
    v_exp_f32 v57, v57
    v_smfmac_f32_32x32x32_bf16 v[208:223], v[80:83], v[48:55], v3
    buffer_load_dwordx4 v246, s[20:23], s51 offen offset:2048 lds
    s_add_u32 m0, s66, 29184
    s_add_u32 s51, s67, 229376
    v_exp_f32 v58, v58
    v_exp_f32 v59, v59
    v_exp_f32 v60, v60
    v_exp_f32 v61, v61
    v_exp_f32 v62, v62
    v_exp_f32 v63, v63
    v_mfma_f32_32x32x16_bf16 v[32:47], v[88:91], a[132:135], 0
    buffer_load_dwordx4 v240, s[20:23], s51 offen offset:0 lds
    v_exp_f32 v16, v16
    v_exp_f32 v17, v17
    v_exp_f32 v18, v18
    v_exp_f32 v19, v19
    v_smfmac_f32_32x32x32_bf16 v[208:223], v[84:87], v[56:63], v3
    s_add_u32 s88, s88, 4096
    s_and_b32 s88, s88, 0x1ffff
    s_add_u32 s93, s88, s63
    buffer_load_dwordx4 v[76:79], v2, s[4:7], s93 offen sc1
    v_exp_f32 v20, v20
    v_exp_f32 v21, v21
    v_exp_f32 v22, v22
    v_exp_f32 v23, v23
    v_exp_f32 v24, v24
    v_exp_f32 v25, v25
    v_smfmac_f32_32x32x32_bf16 v[160:175], v[92:95], v[16:23], v3
    s_mov_b64 exec, s[60:61]
    buffer_load_dwordx4 v[80:83], v12, s[4:7], s93 offen offset:1024 sc1
    buffer_load_dwordx4 v[84:87], v12, s[4:7], s93 offen offset:1536 sc1
    s_mov_b64 exec, -1
    v_exp_f32 v26, v26
    v_exp_f32 v27, v27
    v_exp_f32 v28, v28
    v_exp_f32 v29, v29
    v_exp_f32 v30, v30
    v_exp_f32 v31, v31
    v_mfma_f32_32x32x16_bf16 v[48:63], v[88:91], a[136:139], 0
    ds_read_b64_tr_b16 a[12:13], v252 offset:0
    ds_read_b64_tr_b16 a[14:15], v252 offset:512
    v_exp_f32 v32, v32
    v_exp_f32 v33, v33
    v_exp_f32 v34, v34
    v_exp_f32 v35, v35
    v_smfmac_f32_32x32x32_bf16 v[160:175], v[96:99], v[24:31], v3
    ds_read_b64_tr_b16 a[8:9], v251 offset:0
    ds_read_b64_tr_b16 a[10:11], v251 offset:512
    v_exp_f32 v36, v36
    v_exp_f32 v37, v37
    v_exp_f32 v38, v38
    v_exp_f32 v39, v39
    v_exp_f32 v40, v40
    v_exp_f32 v41, v41
    v_smfmac_f32_32x32x32_bf16 v[176:191], v[92:95], v[32:39], v3
    buffer_load_dwordx4 v241, s[20:23], s51 offen offset:1024 lds
    v_exp_f32 v42, v42
    v_exp_f32 v43, v43
    v_exp_f32 v44, v44
    v_exp_f32 v45, v45
    v_exp_f32 v46, v46
    v_exp_f32 v47, v47
    v_mfma_f32_32x32x16_bf16 v[16:31], v[88:91], a[140:143], 0
    ds_read_b64_tr_b16 a[20:21], v250 offset:4096
    ds_read_b64_tr_b16 a[22:23], v250 offset:4608
    v_exp_f32 v48, v48
    v_exp_f32 v49, v49
    v_exp_f32 v50, v50
    v_exp_f32 v51, v51
    v_smfmac_f32_32x32x32_bf16 v[176:191], v[96:99], v[40:47], v3
    ds_read_b64_tr_b16 a[16:17], v249 offset:4096
    ds_read_b64_tr_b16 a[18:19], v249 offset:4608
    v_exp_f32 v52, v52
    v_exp_f32 v53, v53
    v_exp_f32 v54, v54
    v_exp_f32 v55, v55
    v_exp_f32 v56, v56
    v_exp_f32 v57, v57
    v_smfmac_f32_32x32x32_bf16 v[192:207], v[92:95], v[48:55], v3
    buffer_load_dwordx4 v242, s[20:23], s51 offen offset:2048 lds
    v_exp_f32 v58, v58
    v_exp_f32 v59, v59
    v_exp_f32 v60, v60
    v_exp_f32 v61, v61
    v_exp_f32 v62, v62
    v_exp_f32 v63, v63
    v_mfma_f32_32x32x16_bf16 v[32:47], v[100:103], a[128:131], 0
    ds_read_b64_tr_b16 a[28:29], v252 offset:4096
    ds_read_b64_tr_b16 a[30:31], v252 offset:4608
    v_exp_f32 v16, v16
    v_exp_f32 v17, v17
    v_exp_f32 v18, v18
    v_exp_f32 v19, v19
    v_smfmac_f32_32x32x32_bf16 v[192:207], v[96:99], v[56:63], v3
    ds_read_b64_tr_b16 a[24:25], v251 offset:4096
    ds_read_b64_tr_b16 a[26:27], v251 offset:4608
    v_exp_f32 v20, v20
    v_exp_f32 v21, v21
    v_exp_f32 v22, v22
    v_exp_f32 v23, v23
    v_exp_f32 v24, v24
    v_exp_f32 v25, v25
    v_smfmac_f32_32x32x32_bf16 v[208:223], v[92:95], v[16:23], v3
    buffer_load_dwordx4 v243, s[20:23], s51 offen offset:3072 lds
    s_add_u32 m0, s66, 33280
    s_nop 0
    v_exp_f32 v26, v26
    v_exp_f32 v27, v27
    v_exp_f32 v28, v28
    v_exp_f32 v29, v29
    v_exp_f32 v30, v30
    v_exp_f32 v31, v31
    v_mfma_f32_32x32x16_bf16 v[48:63], v[100:103], a[132:135], 0
    buffer_load_dwordx4 v244, s[20:23], s51 offen offset:0 lds
    v_exp_f32 v32, v32
    v_exp_f32 v33, v33
    v_exp_f32 v34, v34
    v_exp_f32 v35, v35
    v_smfmac_f32_32x32x32_bf16 v[208:223], v[96:99], v[24:31], v3
    s_add_u32 s88, s88, 4096
    s_and_b32 s88, s88, 0x1ffff
    s_add_u32 s93, s88, s63
    buffer_load_dwordx4 v[88:91], v2, s[4:7], s93 offen sc1
    v_exp_f32 v36, v36
    v_exp_f32 v37, v37
    v_exp_f32 v38, v38
    v_exp_f32 v39, v39
    v_exp_f32 v40, v40
    v_exp_f32 v41, v41
    v_smfmac_f32_32x32x32_bf16 v[160:175], v[104:107], v[32:39], v3
    s_mov_b64 exec, s[60:61]
    buffer_load_dwordx4 v[92:95], v12, s[4:7], s93 offen offset:1024 sc1
    buffer_load_dwordx4 v[96:99], v12, s[4:7], s93 offen offset:1536 sc1
    s_mov_b64 exec, -1
    v_exp_f32 v42, v42
    v_exp_f32 v43, v43
    v_exp_f32 v44, v44
    v_exp_f32 v45, v45
    v_exp_f32 v46, v46
    v_exp_f32 v47, v47
    v_mfma_f32_32x32x16_bf16 v[16:31], v[100:103], a[136:139], 0
    ds_read_b64_tr_b16 a[36:37], v250 offset:8192
    ds_read_b64_tr_b16 a[38:39], v250 offset:8704
    v_exp_f32 v48, v48
    v_exp_f32 v49, v49
    v_exp_f32 v50, v50
    v_exp_f32 v51, v51
    v_smfmac_f32_32x32x32_bf16 v[160:175], v[108:111], v[40:47], v3
    ds_read_b64_tr_b16 a[32:33], v249 offset:8192
    ds_read_b64_tr_b16 a[34:35], v249 offset:8704
    v_exp_f32 v52, v52
    v_exp_f32 v53, v53
    v_exp_f32 v54, v54
    v_exp_f32 v55, v55
    v_exp_f32 v56, v56
    v_exp_f32 v57, v57
    v_smfmac_f32_32x32x32_bf16 v[176:191], v[104:107], v[48:55], v3
    buffer_load_dwordx4 v245, s[20:23], s51 offen offset:1024 lds
    v_exp_f32 v58, v58
    v_exp_f32 v59, v59
    v_exp_f32 v60, v60
    v_exp_f32 v61, v61
    v_exp_f32 v62, v62
    v_exp_f32 v63, v63
    v_mfma_f32_32x32x16_bf16 v[32:47], v[100:103], a[140:143], 0
    ds_read_b64_tr_b16 a[44:45], v252 offset:8192
    ds_read_b64_tr_b16 a[46:47], v252 offset:8704
    v_exp_f32 v16, v16
    v_exp_f32 v17, v17
    v_exp_f32 v18, v18
    v_exp_f32 v19, v19
    v_smfmac_f32_32x32x32_bf16 v[176:191], v[108:111], v[56:63], v3
    ds_read_b64_tr_b16 a[40:41], v251 offset:8192
    ds_read_b64_tr_b16 a[42:43], v251 offset:8704
    v_exp_f32 v20, v20
    v_exp_f32 v21, v21
    v_exp_f32 v22, v22
    v_exp_f32 v23, v23
    v_exp_f32 v24, v24
    v_exp_f32 v25, v25
    v_smfmac_f32_32x32x32_bf16 v[192:207], v[104:107], v[16:23], v3
    buffer_load_dwordx4 v246, s[20:23], s51 offen offset:2048 lds
    v_exp_f32 v26, v26
    v_exp_f32 v27, v27
    v_exp_f32 v28, v28
    v_exp_f32 v29, v29
    v_exp_f32 v30, v30
    v_exp_f32 v31, v31
    v_mfma_f32_32x32x16_bf16 v[48:63], v[112:115], a[128:131], 0
    ds_read_b64_tr_b16 a[52:53], v250 offset:12288
    ds_read_b64_tr_b16 a[54:55], v250 offset:12800
    v_exp_f32 v32, v32
    v_exp_f32 v33, v33
    v_exp_f32 v34, v34
    v_exp_f32 v35, v35
    v_smfmac_f32_32x32x32_bf16 v[192:207], v[108:111], v[24:31], v3
    s_add_u32 m0, s66, 58368
    s_add_u32 s51, s67, 458752
    ds_read_b64_tr_b16 a[48:49], v249 offset:12288
    ds_read_b64_tr_b16 a[50:51], v249 offset:12800
    v_exp_f32 v36, v36
    v_exp_f32 v37, v37
    v_exp_f32 v38, v38
    v_exp_f32 v39, v39
    v_exp_f32 v40, v40
    v_exp_f32 v41, v41
    v_smfmac_f32_32x32x32_bf16 v[208:223], v[104:107], v[32:39], v3
    buffer_load_dwordx4 v240, s[20:23], s51 offen offset:0 lds
    v_exp_f32 v42, v42
    v_exp_f32 v43, v43
    v_exp_f32 v44, v44
    v_exp_f32 v45, v45
    v_exp_f32 v46, v46
    v_exp_f32 v47, v47
    v_mfma_f32_32x32x16_bf16 v[16:31], v[112:115], a[132:135], 0
    buffer_load_dwordx4 v241, s[20:23], s51 offen offset:1024 lds
    v_exp_f32 v48, v48
    v_exp_f32 v49, v49
    v_exp_f32 v50, v50
    v_exp_f32 v51, v51
    v_smfmac_f32_32x32x32_bf16 v[208:223], v[108:111], v[40:47], v3
    s_add_u32 s88, s88, 4096
    s_and_b32 s88, s88, 0x1ffff
    s_add_u32 s93, s88, s63
    buffer_load_dwordx4 v[100:103], v2, s[4:7], s93 offen sc1
    s_getpc_b64 s[68:69]
L_pc_26:
    s_lshl_b32 s70, s45, 2
    s_add_u32 s70, s70, s46
    s_lshl_b32 s70, s70, 8
    v_and_b32 v8, 1, v1
    v_lshlrev_b32 v8, 7, v8
    v_add_u32 v8, s70, v8
    v_min_u32 v8, L_phaseD-L_u64-4, v8
    v_add_u32 v8, L_u64-L_pc_26, v8
    global_load_dword v254, v8, s[68:69]
    v_exp_f32 v52, v52
    v_exp_f32 v53, v53
    v_exp_f32 v54, v54
    v_exp_f32 v55, v55
    v_exp_f32 v56, v56
    v_exp_f32 v57, v57
    v_smfmac_f32_32x32x32_bf16 v[160:175], v[116:119], v[48:55], v3
    s_mov_b64 exec, s[60:61]
    buffer_load_dwordx4 v[104:107], v12, s[4:7], s93 offen offset:1024 sc1
    buffer_load_dwordx4 v[108:111], v12, s[4:7], s93 offen offset:1536 sc1
    s_mov_b64 exec, -1
    v_exp_f32 v58, v58
    v_exp_f32 v59, v59
    v_exp_f32 v60, v60
    v_exp_f32 v61, v61
    v_exp_f32 v62, v62
    v_exp_f32 v63, v63
    v_mfma_f32_32x32x16_bf16 v[32:47], v[112:115], a[136:139], 0
    ds_read_b64_tr_b16 a[60:61], v252 offset:12288
    ds_read_b64_tr_b16 a[62:63], v252 offset:12800
    v_exp_f32 v16, v16
    v_exp_f32 v17, v17
    v_exp_f32 v18, v18
    v_exp_f32 v19, v19
    v_smfmac_f32_32x32x32_bf16 v[160:175], v[120:123], v[56:63], v3
    ds_read_b64_tr_b16 a[56:57], v251 offset:12288
    ds_read_b64_tr_b16 a[58:59], v251 offset:12800
    v_exp_f32 v20, v20
    v_exp_f32 v21, v21
    v_exp_f32 v22, v22
    v_exp_f32 v23, v23
    v_exp_f32 v24, v24
    v_exp_f32 v25, v25
    v_smfmac_f32_32x32x32_bf16 v[176:191], v[116:119], v[16:23], v3
    buffer_load_dwordx4 v242, s[20:23], s51 offen offset:2048 lds
    v_exp_f32 v26, v26
    v_exp_f32 v27, v27
    v_exp_f32 v28, v28
    v_exp_f32 v29, v29
    v_exp_f32 v30, v30
    v_exp_f32 v31, v31
    v_mfma_f32_32x32x16_bf16 v[48:63], v[112:115], a[140:143], 0
    ds_read_b64_tr_b16 a[68:69], v250 offset:16384
    ds_read_b64_tr_b16 a[70:71], v250 offset:16896
    v_exp_f32 v32, v32
    v_exp_f32 v33, v33
    v_exp_f32 v34, v34
    v_exp_f32 v35, v35
    v_smfmac_f32_32x32x32_bf16 v[176:191], v[120:123], v[24:31], v3
    ds_read_b64_tr_b16 a[64:65], v249 offset:16384
    ds_read_b64_tr_b16 a[66:67], v249 offset:16896
    v_exp_f32 v36, v36
    v_exp_f32 v37, v37
    v_exp_f32 v38, v38
    v_exp_f32 v39, v39
    v_exp_f32 v40, v40
    v_exp_f32 v41, v41
    v_smfmac_f32_32x32x32_bf16 v[192:207], v[116:119], v[32:39], v3
    buffer_load_dwordx4 v243, s[20:23], s51 offen offset:3072 lds
    v_exp_f32 v42, v42
    v_exp_f32 v43, v43
    v_exp_f32 v44, v44
    v_exp_f32 v45, v45
    v_exp_f32 v46, v46
    v_exp_f32 v47, v47
    v_mfma_f32_32x32x16_bf16 v[16:31], v[224:227], a[128:131], 0
    ds_read_b64_tr_b16 a[76:77], v252 offset:16384
    ds_read_b64_tr_b16 a[78:79], v252 offset:16896
    v_exp_f32 v48, v48
    v_exp_f32 v49, v49
    v_exp_f32 v50, v50
    v_exp_f32 v51, v51
    v_smfmac_f32_32x32x32_bf16 v[192:207], v[120:123], v[40:47], v3
    s_add_u32 m0, s66, 62464
    s_nop 0
    ds_read_b64_tr_b16 a[72:73], v251 offset:16384
    ds_read_b64_tr_b16 a[74:75], v251 offset:16896
    v_exp_f32 v52, v52
    v_exp_f32 v53, v53
    v_exp_f32 v54, v54
    v_exp_f32 v55, v55
    v_exp_f32 v56, v56
    v_exp_f32 v57, v57
    v_smfmac_f32_32x32x32_bf16 v[208:223], v[116:119], v[48:55], v3
    buffer_load_dwordx4 v244, s[20:23], s51 offen offset:0 lds
    v_exp_f32 v58, v58
    v_exp_f32 v59, v59
    v_exp_f32 v60, v60
    v_exp_f32 v61, v61
    v_exp_f32 v62, v62
    v_exp_f32 v63, v63
    v_mfma_f32_32x32x16_bf16 v[32:47], v[224:227], a[132:135], 0
    buffer_load_dwordx4 v245, s[20:23], s51 offen offset:1024 lds
    v_exp_f32 v16, v16
    v_exp_f32 v17, v17
    v_exp_f32 v18, v18
    v_exp_f32 v19, v19
    v_smfmac_f32_32x32x32_bf16 v[208:223], v[120:123], v[56:63], v3
    s_add_u32 s88, s88, 4096
    s_and_b32 s88, s88, 0x1ffff
    s_add_u32 s93, s88, s63
    buffer_load_dwordx4 v[112:115], v2, s[4:7], s93 offen sc1
    v_exp_f32 v20, v20
    v_exp_f32 v21, v21
    v_exp_f32 v22, v22
    v_exp_f32 v23, v23
    v_exp_f32 v24, v24
    v_exp_f32 v25, v25
    v_smfmac_f32_32x32x32_bf16 v[160:175], v[228:231], v[16:23], v3
    s_mov_b64 exec, s[60:61]
    buffer_load_dwordx4 v[116:119], v12, s[4:7], s93 offen offset:1024 sc1
    buffer_load_dwordx4 v[120:123], v12, s[4:7], s93 offen offset:1536 sc1
    s_mov_b64 exec, -1
    v_exp_f32 v26, v26
    v_exp_f32 v27, v27
    v_exp_f32 v28, v28
    v_exp_f32 v29, v29
    v_exp_f32 v30, v30
    v_exp_f32 v31, v31
    v_mfma_f32_32x32x16_bf16 v[48:63], v[224:227], a[136:139], 0
    ds_read_b64_tr_b16 a[84:85], v250 offset:20480
    ds_read_b64_tr_b16 a[86:87], v250 offset:20992
    v_exp_f32 v32, v32
    v_exp_f32 v33, v33
    v_exp_f32 v34, v34
    v_exp_f32 v35, v35
    v_smfmac_f32_32x32x32_bf16 v[160:175], v[232:235], v[24:31], v3
    ds_read_b64_tr_b16 a[80:81], v249 offset:20480
    ds_read_b64_tr_b16 a[82:83], v249 offset:20992
    v_exp_f32 v36, v36
    v_exp_f32 v37, v37
    v_exp_f32 v38, v38
    v_exp_f32 v39, v39
    v_exp_f32 v40, v40
    v_exp_f32 v41, v41
    v_smfmac_f32_32x32x32_bf16 v[176:191], v[228:231], v[32:39], v3
    buffer_load_dwordx4 v246, s[20:23], s51 offen offset:2048 lds
    v_exp_f32 v42, v42
    v_exp_f32 v43, v43
    v_exp_f32 v44, v44
    v_exp_f32 v45, v45
    v_exp_f32 v46, v46
    v_exp_f32 v47, v47
    v_mfma_f32_32x32x16_bf16 v[16:31], v[224:227], a[140:143], 0
    ds_read_b64_tr_b16 a[92:93], v252 offset:20480
    ds_read_b64_tr_b16 a[94:95], v252 offset:20992
    v_exp_f32 v48, v48
    v_exp_f32 v49, v49
    v_exp_f32 v50, v50
    v_exp_f32 v51, v51
    v_smfmac_f32_32x32x32_bf16 v[176:191], v[232:235], v[40:47], v3
    ds_read_b64_tr_b16 a[88:89], v251 offset:20480
    ds_read_b64_tr_b16 a[90:91], v251 offset:20992
    v_exp_f32 v52, v52
    v_exp_f32 v53, v53
    v_exp_f32 v54, v54
    v_exp_f32 v55, v55
    v_exp_f32 v56, v56
    v_exp_f32 v57, v57
    v_smfmac_f32_32x32x32_bf16 v[192:207], v[228:231], v[48:55], v3
    v_accvgpr_read_b32 v8, a161
    buffer_load_dword v255, v8, s[28:31], 0 offen offset:0
    v_exp_f32 v58, v58
    v_exp_f32 v59, v59
    v_exp_f32 v60, v60
    v_exp_f32 v61, v61
    v_exp_f32 v62, v62
    v_exp_f32 v63, v63
    v_mfma_f32_32x32x16_bf16 v[32:47], v[128:131], a[128:131], 0
    ds_read_b64_tr_b16 a[100:101], v250 offset:24576
    ds_read_b64_tr_b16 a[102:103], v250 offset:25088
    v_exp_f32 v16, v16
    v_exp_f32 v17, v17
    v_exp_f32 v18, v18
    v_exp_f32 v19, v19
    v_smfmac_f32_32x32x32_bf16 v[192:207], v[232:235], v[56:63], v3
    ds_read_b64_tr_b16 a[96:97], v249 offset:24576
    ds_read_b64_tr_b16 a[98:99], v249 offset:25088
    v_exp_f32 v20, v20
    v_exp_f32 v21, v21
    v_exp_f32 v22, v22
    v_exp_f32 v23, v23
    v_exp_f32 v24, v24
    v_exp_f32 v25, v25
    v_smfmac_f32_32x32x32_bf16 v[208:223], v[228:231], v[16:23], v3
    v_exp_f32 v26, v26
    v_exp_f32 v27, v27
    v_exp_f32 v28, v28
    v_exp_f32 v29, v29
    v_exp_f32 v30, v30
    v_exp_f32 v31, v31
L_u64:
    v_mfma_f32_32x32x16_bf16 v[48:63], v[128:131], a[132:135], 0
    v_exp_f32 v32, v32
    v_exp_f32 v33, v33
    v_exp_f32 v34, v34
    v_exp_f32 v35, v35
    v_smfmac_f32_32x32x32_bf16 v[208:223], v[232:235], v[24:31], v3
    s_add_u32 s88, s88, 4096
    s_and_b32 s88, s88, 0x1ffff
    s_add_u32 s93, s88, s63
    buffer_load_dwordx4 v[224:227], v2, s[4:7], s93 offen sc1
    v_exp_f32 v36, v36
    v_exp_f32 v37, v37
    v_exp_f32 v38, v38
    v_exp_f32 v39, v39
    v_exp_f32 v40, v40
    v_exp_f32 v41, v41
    v_smfmac_f32_32x32x32_bf16 v[160:175], v[132:135], v[32:39], v3
    s_mov_b64 exec, s[60:61]
    buffer_load_dwordx4 v[228:231], v12, s[4:7], s93 offen offset:1024 sc1
    buffer_load_dwordx4 v[232:235], v12, s[4:7], s93 offen offset:1536 sc1
    s_mov_b64 exec, -1
    v_exp_f32 v42, v42
    v_exp_f32 v43, v43
    v_exp_f32 v44, v44
    v_exp_f32 v45, v45
    v_exp_f32 v46, v46
    v_exp_f32 v47, v47
    v_mfma_f32_32x32x16_bf16 v[16:31], v[128:131], a[136:139], 0
    ds_read_b64_tr_b16 a[108:109], v252 offset:24576
    ds_read_b64_tr_b16 a[110:111], v252 offset:25088
    v_exp_f32 v48, v48
    v_exp_f32 v49, v49
    v_exp_f32 v50, v50
    v_exp_f32 v51, v51
    v_smfmac_f32_32x32x32_bf16 v[160:175], v[136:139], v[40:47], v3
    ds_read_b64_tr_b16 a[104:105], v251 offset:24576
    ds_read_b64_tr_b16 a[106:107], v251 offset:25088
    v_exp_f32 v52, v52
    v_exp_f32 v53, v53
    v_exp_f32 v54, v54
    v_exp_f32 v55, v55
    v_exp_f32 v56, v56
    v_exp_f32 v57, v57
    v_smfmac_f32_32x32x32_bf16 v[176:191], v[132:135], v[48:55], v3
    v_exp_f32 v58, v58
    v_exp_f32 v59, v59
    v_exp_f32 v60, v60
    v_exp_f32 v61, v61
    v_exp_f32 v62, v62
    v_exp_f32 v63, v63
    v_mfma_f32_32x32x16_bf16 v[32:47], v[128:131], a[140:143], 0
    ds_read_b64_tr_b16 a[116:117], v250 offset:28672
    ds_read_b64_tr_b16 a[118:119], v250 offset:29184
    v_exp_f32 v16, v16
    v_exp_f32 v17, v17
    v_exp_f32 v18, v18
    v_exp_f32 v19, v19
    v_smfmac_f32_32x32x32_bf16 v[176:191], v[136:139], v[56:63], v3
    ds_read_b64_tr_b16 a[112:113], v249 offset:28672
    ds_read_b64_tr_b16 a[114:115], v249 offset:29184
    v_exp_f32 v20, v20
    v_exp_f32 v21, v21
    v_exp_f32 v22, v22
    v_exp_f32 v23, v23
    v_exp_f32 v24, v24
    v_exp_f32 v25, v25
    v_smfmac_f32_32x32x32_bf16 v[192:207], v[132:135], v[16:23], v3
    v_exp_f32 v26, v26
    v_exp_f32 v27, v27
    v_exp_f32 v28, v28
    v_exp_f32 v29, v29
    v_exp_f32 v30, v30
    v_exp_f32 v31, v31
    s_waitcnt vmcnt(41)
    v_mfma_f32_32x32x16_bf16 v[48:63], v[140:143], a[128:131], 0
    ds_read_b64_tr_b16 a[124:125], v252 offset:28672
    ds_read_b64_tr_b16 a[126:127], v252 offset:29184
    v_exp_f32 v32, v32
    v_exp_f32 v33, v33
    v_exp_f32 v34, v34
    v_exp_f32 v35, v35
    v_smfmac_f32_32x32x32_bf16 v[192:207], v[136:139], v[24:31], v3
    ds_read_b64_tr_b16 a[120:121], v251 offset:28672
    ds_read_b64_tr_b16 a[122:123], v251 offset:29184
    v_exp_f32 v36, v36
    v_exp_f32 v37, v37
    v_exp_f32 v38, v38
    v_exp_f32 v39, v39
    v_exp_f32 v40, v40
    v_exp_f32 v41, v41
    v_smfmac_f32_32x32x32_bf16 v[208:223], v[132:135], v[32:39], v3
    v_exp_f32 v42, v42
    v_exp_f32 v43, v43
    v_exp_f32 v44, v44
    v_exp_f32 v45, v45
    v_exp_f32 v46, v46
    v_exp_f32 v47, v47
    v_mfma_f32_32x32x16_bf16 v[16:31], v[140:143], a[132:135], 0
    v_exp_f32 v48, v48
    v_exp_f32 v49, v49
    v_exp_f32 v50, v50
    v_exp_f32 v51, v51
    v_smfmac_f32_32x32x32_bf16 v[208:223], v[136:139], v[40:47], v3
    s_add_u32 s88, s88, 4096
    s_and_b32 s88, s88, 0x1ffff
    s_add_u32 s93, s88, s63
    buffer_load_dwordx4 v[128:131], v2, s[4:7], s93 offen sc1
    v_exp_f32 v52, v52
    v_exp_f32 v53, v53
    v_exp_f32 v54, v54
    v_exp_f32 v55, v55
    v_exp_f32 v56, v56
    v_exp_f32 v57, v57
    v_smfmac_f32_32x32x32_bf16 v[160:175], v[144:147], v[48:55], v3
    s_mov_b64 exec, s[60:61]
    buffer_load_dwordx4 v[132:135], v12, s[4:7], s93 offen offset:1024 sc1
    buffer_load_dwordx4 v[136:139], v12, s[4:7], s93 offen offset:1536 sc1
    s_mov_b64 exec, -1
    v_exp_f32 v58, v58
    v_exp_f32 v59, v59
    v_exp_f32 v60, v60
    v_exp_f32 v61, v61
    v_exp_f32 v62, v62
    v_exp_f32 v63, v63
    v_mfma_f32_32x32x16_bf16 v[32:47], v[140:143], a[136:139], 0
    v_exp_f32 v16, v16
    v_exp_f32 v17, v17
    v_exp_f32 v18, v18
    v_exp_f32 v19, v19
    v_smfmac_f32_32x32x32_bf16 v[160:175], v[148:151], v[56:63], v3
    s_waitcnt lgkmcnt(0)
    s_barrier
    s_mul_i32 s53, s46, 458752
    v_exp_f32 v20, v20
    v_exp_f32 v21, v21
    v_exp_f32 v22, v22
    v_exp_f32 v23, v23
    v_exp_f32 v24, v24
    v_exp_f32 v25, v25
    v_smfmac_f32_32x32x32_bf16 v[176:191], v[144:147], v[16:23], v3
    v_add_u32 v249, s86, v4
    v_accvgpr_read_b32 v247, a184
    v_add_u32 v248, 7168, v247
    v_xor_b32 v250, 32, v249
    v_xor_b32 v251, 64, v249
    v_xor_b32 v252, 96, v249
    v_exp_f32 v26, v26
    v_exp_f32 v27, v27
    v_exp_f32 v28, v28
    v_exp_f32 v29, v29
    v_exp_f32 v30, v30
    v_exp_f32 v31, v31
    v_mfma_f32_32x32x16_bf16 v[48:63], v[140:143], a[140:143], 0
    v_exp_f32 v32, v32
    v_exp_f32 v33, v33
    v_exp_f32 v34, v34
    v_exp_f32 v35, v35
    v_smfmac_f32_32x32x32_bf16 v[176:191], v[148:151], v[24:31], v3
    s_add_u32 m0, s86, 0
    s_add_u32 s51, s53, 0
    v_exp_f32 v36, v36
    v_exp_f32 v37, v37
    v_exp_f32 v38, v38
    v_exp_f32 v39, v39
    v_exp_f32 v40, v40
    v_exp_f32 v41, v41
    v_smfmac_f32_32x32x32_bf16 v[192:207], v[144:147], v[32:39], v3
    buffer_load_dwordx4 v247, s[28:31], s51 offen offset:0 lds
    v_exp_f32 v42, v42
    v_exp_f32 v43, v43
    v_exp_f32 v44, v44
    v_exp_f32 v45, v45
    v_exp_f32 v46, v46
    v_exp_f32 v47, v47
    s_waitcnt vmcnt(38)
    v_mfma_f32_32x32x16_bf16 v[16:31], v[64:67], a[128:131], 0
    v_exp_f32 v48, v48
    v_exp_f32 v49, v49
    v_exp_f32 v50, v50
    v_exp_f32 v51, v51
    v_smfmac_f32_32x32x32_bf16 v[192:207], v[148:151], v[40:47], v3
    v_exp_f32 v52, v52
    v_exp_f32 v53, v53
    v_exp_f32 v54, v54
    v_exp_f32 v55, v55
    v_exp_f32 v56, v56
    v_exp_f32 v57, v57
    v_smfmac_f32_32x32x32_bf16 v[208:223], v[144:147], v[48:55], v3
    buffer_load_dwordx4 v248, s[28:31], s51 offen offset:1024 lds
    s_add_u32 m0, s86, 2048
    s_add_u32 s51, s53, 16384
    v_exp_f32 v58, v58
    v_exp_f32 v59, v59
    v_exp_f32 v60, v60
    v_exp_f32 v61, v61
    v_exp_f32 v62, v62
    v_exp_f32 v63, v63
    v_mfma_f32_32x32x16_bf16 v[32:47], v[64:67], a[132:135], 0
    buffer_load_dwordx4 v247, s[28:31], s51 offen offset:0 lds
    v_exp_f32 v16, v16
    v_exp_f32 v17, v17
    v_exp_f32 v18, v18
    v_exp_f32 v19, v19
    v_smfmac_f32_32x32x32_bf16 v[208:223], v[148:151], v[56:63], v3
    s_add_u32 s88, s88, 4096
    s_and_b32 s88, s88, 0x1ffff
    s_add_u32 s93, s88, s63
    buffer_load_dwordx4 v[140:143], v2, s[4:7], s93 offen sc1
    v_exp_f32 v20, v20
    v_exp_f32 v21, v21
    v_exp_f32 v22, v22
    v_exp_f32 v23, v23
    v_exp_f32 v24, v24
    v_exp_f32 v25, v25
    v_smfmac_f32_32x32x32_bf16 v[160:175], v[68:71], v[16:23], v3
    s_mov_b64 exec, s[60:61]
    buffer_load_dwordx4 v[144:147], v12, s[4:7], s93 offen offset:1024 sc1
    buffer_load_dwordx4 v[148:151], v12, s[4:7], s93 offen offset:1536 sc1
    s_mov_b64 exec, -1
    v_exp_f32 v26, v26
    v_exp_f32 v27, v27
    v_exp_f32 v28, v28
    v_exp_f32 v29, v29
    v_exp_f32 v30, v30
    v_exp_f32 v31, v31
    v_mfma_f32_32x32x16_bf16 v[48:63], v[64:67], a[136:139], 0
    v_exp_f32 v32, v32
    v_exp_f32 v33, v33
    v_exp_f32 v34, v34
    v_exp_f32 v35, v35
    v_smfmac_f32_32x32x32_bf16 v[160:175], v[72:75], v[24:31], v3
    v_exp_f32 v36, v36
    v_exp_f32 v37, v37
    v_exp_f32 v38, v38
    v_exp_f32 v39, v39
    v_exp_f32 v40, v40
    v_exp_f32 v41, v41
    v_smfmac_f32_32x32x32_bf16 v[176:191], v[68:71], v[32:39], v3
    buffer_load_dwordx4 v248, s[28:31], s51 offen offset:1024 lds
    v_exp_f32 v42, v42
    v_exp_f32 v43, v43
    v_exp_f32 v44, v44
    v_exp_f32 v45, v45
    v_exp_f32 v46, v46
    v_exp_f32 v47, v47
    v_mfma_f32_32x32x16_bf16 v[16:31], v[64:67], a[140:143], 0
    v_exp_f32 v48, v48
    v_exp_f32 v49, v49
    v_exp_f32 v50, v50
    v_exp_f32 v51, v51
    v_smfmac_f32_32x32x32_bf16 v[176:191], v[72:75], v[40:47], v3
    s_add_u32 m0, s86, 4096
    s_add_u32 s51, s53, 32768
    v_exp_f32 v52, v52
    v_exp_f32 v53, v53
    v_exp_f32 v54, v54
    v_exp_f32 v55, v55
    v_exp_f32 v56, v56
    v_exp_f32 v57, v57
    v_smfmac_f32_32x32x32_bf16 v[192:207], v[68:71], v[48:55], v3
    buffer_load_dwordx4 v247, s[28:31], s51 offen offset:0 lds
    v_exp_f32 v58, v58
    v_exp_f32 v59, v59
    v_exp_f32 v60, v60
    v_exp_f32 v61, v61
    v_exp_f32 v62, v62
    v_exp_f32 v63, v63
    s_waitcnt vmcnt(38)
    v_mfma_f32_32x32x16_bf16 v[32:47], v[76:79], a[128:131], 0
    v_exp_f32 v16, v16
    v_exp_f32 v17, v17
    v_exp_f32 v18, v18
    v_exp_f32 v19, v19
    v_smfmac_f32_32x32x32_bf16 v[192:207], v[72:75], v[56:63], v3
    v_exp_f32 v20, v20
    v_exp_f32 v21, v21
    v_exp_f32 v22, v22
    v_exp_f32 v23, v23
    v_exp_f32 v24, v24
    v_exp_f32 v25, v25
    v_smfmac_f32_32x32x32_bf16 v[208:223], v[68:71], v[16:23], v3
    buffer_load_dwordx4 v248, s[28:31], s51 offen offset:1024 lds
    s_add_u32 m0, s86, 6144
    s_add_u32 s51, s53, 49152
    v_exp_f32 v26, v26
    v_exp_f32 v27, v27
    v_exp_f32 v28, v28
    v_exp_f32 v29, v29
    v_exp_f32 v30, v30
    v_exp_f32 v31, v31
    v_mfma_f32_32x32x16_bf16 v[48:63], v[76:79], a[132:135], 0
    buffer_load_dwordx4 v247, s[28:31], s51 offen offset:0 lds
    v_exp_f32 v32, v32
    v_exp_f32 v33, v33
    v_exp_f32 v34, v34
    v_exp_f32 v35, v35
    v_smfmac_f32_32x32x32_bf16 v[208:223], v[72:75], v[24:31], v3
    s_add_u32 s88, s88, 4096
    s_and_b32 s88, s88, 0x1ffff
    s_add_u32 s93, s88, s63
    buffer_load_dwordx4 v[64:67], v2, s[4:7], s93 offen sc1
    v_exp_f32 v36, v36
    v_exp_f32 v37, v37
    v_exp_f32 v38, v38
    v_exp_f32 v39, v39
    v_exp_f32 v40, v40
    v_exp_f32 v41, v41
    v_smfmac_f32_32x32x32_bf16 v[160:175], v[80:83], v[32:39], v3
    s_mov_b64 exec, s[60:61]
    buffer_load_dwordx4 v[68:71], v12, s[4:7], s93 offen offset:1024 sc1
    buffer_load_dwordx4 v[72:75], v12, s[4:7], s93 offen offset:1536 sc1
    s_mov_b64 exec, -1
    v_exp_f32 v42, v42
    v_exp_f32 v43, v43
    v_exp_f32 v44, v44
    v_exp_f32 v45, v45
    v_exp_f32 v46, v46
    v_exp_f32 v47, v47
    v_mfma_f32_32x32x16_bf16 v[16:31], v[76:79], a[136:139], 0
    v_exp_f32 v48, v48
    v_exp_f32 v49, v49
    v_exp_f32 v50, v50
    v_exp_f32 v51, v51
    v_smfmac_f32_32x32x32_bf16 v[160:175], v[84:87], v[40:47], v3
    v_exp_f32 v52, v52
    v_exp_f32 v53, v53
    v_exp_f32 v54, v54
    v_exp_f32 v55, v55
    v_exp_f32 v56, v56
    v_exp_f32 v57, v57
    v_smfmac_f32_32x32x32_bf16 v[176:191], v[80:83], v[48:55], v3
    buffer_load_dwordx4 v248, s[28:31], s51 offen offset:1024 lds
    v_exp_f32 v58, v58
    v_exp_f32 v59, v59
    v_exp_f32 v60, v60
    v_exp_f32 v61, v61
    v_exp_f32 v62, v62
    v_exp_f32 v63, v63
    v_mfma_f32_32x32x16_bf16 v[32:47], v[76:79], a[140:143], 0
    v_exp_f32 v16, v16
    v_exp_f32 v17, v17
    v_exp_f32 v18, v18
    v_exp_f32 v19, v19
    v_smfmac_f32_32x32x32_bf16 v[176:191], v[84:87], v[56:63], v3
    s_add_u32 m0, s86, 8192
    s_add_u32 s51, s53, 131072
    v_exp_f32 v20, v20
    v_exp_f32 v21, v21
    v_exp_f32 v22, v22
    v_exp_f32 v23, v23
    v_exp_f32 v24, v24
    v_exp_f32 v25, v25
    v_smfmac_f32_32x32x32_bf16 v[192:207], v[80:83], v[16:23], v3
    buffer_load_dwordx4 v247, s[28:31], s51 offen offset:0 lds
    v_exp_f32 v26, v26
    v_exp_f32 v27, v27
    v_exp_f32 v28, v28
    v_exp_f32 v29, v29
    v_exp_f32 v30, v30
    v_exp_f32 v31, v31
    s_waitcnt vmcnt(38)
    v_mfma_f32_32x32x16_bf16 v[48:63], v[88:91], a[128:131], 0
    v_exp_f32 v32, v32
    v_exp_f32 v33, v33
    v_exp_f32 v34, v34
    v_exp_f32 v35, v35
    v_smfmac_f32_32x32x32_bf16 v[192:207], v[84:87], v[24:31], v3
    v_exp_f32 v36, v36
    v_exp_f32 v37, v37
    v_exp_f32 v38, v38
    v_exp_f32 v39, v39
    v_exp_f32 v40, v40
    v_exp_f32 v41, v41
    v_smfmac_f32_32x32x32_bf16 v[208:223], v[80:83], v[32:39], v3
    buffer_load_dwordx4 v248, s[28:31], s51 offen offset:1024 lds
    s_add_u32 m0, s86, 10240
    s_add_u32 s51, s53, 147456
    v_exp_f32 v42, v42
    v_exp_f32 v43, v43
    v_exp_f32 v44, v44
    v_exp_f32 v45, v45
    v_exp_f32 v46, v46
    v_exp_f32 v47, v47
    v_mfma_f32_32x32x16_bf16 v[16:31], v[88:91], a[132:135], 0
    buffer_load_dwordx4 v247, s[28:31], s51 offen offset:0 lds
    v_exp_f32 v48, v48
    v_exp_f32 v49, v49
    v_exp_f32 v50, v50
    v_exp_f32 v51, v51
    v_smfmac_f32_32x32x32_bf16 v[208:223], v[84:87], v[40:47], v3
    s_add_u32 s88, s88, 4096
    s_and_b32 s88, s88, 0x1ffff
    s_add_u32 s93, s88, s63
    buffer_load_dwordx4 v[76:79], v2, s[4:7], s93 offen sc1
    v_exp_f32 v52, v52
    v_exp_f32 v53, v53
    v_exp_f32 v54, v54
    v_exp_f32 v55, v55
    v_exp_f32 v56, v56
    v_exp_f32 v57, v57
    v_smfmac_f32_32x32x32_bf16 v[160:175], v[92:95], v[48:55], v3
    s_mov_b64 exec, s[60:61]
    buffer_load_dwordx4 v[80:83], v12, s[4:7], s93 offen offset:1024 sc1
    buffer_load_dwordx4 v[84:87], v12, s[4:7], s93 offen offset:1536 sc1
    s_mov_b64 exec, -1
    v_exp_f32 v58, v58
    v_exp_f32 v59, v59
    v_exp_f32 v60, v60
    v_exp_f32 v61, v61
    v_exp_f32 v62, v62
    v_exp_f32 v63, v63
    v_mfma_f32_32x32x16_bf16 v[32:47], v[88:91], a[136:139], 0
    v_exp_f32 v16, v16
    v_exp_f32 v17, v17
    v_exp_f32 v18, v18
    v_exp_f32 v19, v19
    v_smfmac_f32_32x32x32_bf16 v[160:175], v[96:99], v[56:63], v3
    v_exp_f32 v20, v20
    v_exp_f32 v21, v21
    v_exp_f32 v22, v22
    v_exp_f32 v23, v23
    v_exp_f32 v24, v24
    v_exp_f32 v25, v25
    v_smfmac_f32_32x32x32_bf16 v[176:191], v[92:95], v[16:23], v3
    buffer_load_dwordx4 v248, s[28:31], s51 offen offset:1024 lds
    v_exp_f32 v26, v26
    v_exp_f32 v27, v27
    v_exp_f32 v28, v28
    v_exp_f32 v29, v29
    v_exp_f32 v30, v30
    v_exp_f32 v31, v31
    v_mfma_f32_32x32x16_bf16 v[48:63], v[88:91], a[140:143], 0
    v_exp_f32 v32, v32
    v_exp_f32 v33, v33
    v_exp_f32 v34, v34
    v_exp_f32 v35, v35
    v_smfmac_f32_32x32x32_bf16 v[176:191], v[96:99], v[24:31], v3
    s_add_u32 m0, s86, 12288
    s_add_u32 s51, s53, 163840
    v_exp_f32 v36, v36
    v_exp_f32 v37, v37
    v_exp_f32 v38, v38
    v_exp_f32 v39, v39
    v_exp_f32 v40, v40
    v_exp_f32 v41, v41
    v_smfmac_f32_32x32x32_bf16 v[192:207], v[92:95], v[32:39], v3
    buffer_load_dwordx4 v247, s[28:31], s51 offen offset:0 lds
    v_exp_f32 v42, v42
    v_exp_f32 v43, v43
    v_exp_f32 v44, v44
    v_exp_f32 v45, v45
    v_exp_f32 v46, v46
    v_exp_f32 v47, v47
    s_waitcnt vmcnt(37)
    v_mfma_f32_32x32x16_bf16 v[16:31], v[100:103], a[128:131], 0
    v_exp_f32 v48, v48
    v_exp_f32 v49, v49
    v_exp_f32 v50, v50
    v_exp_f32 v51, v51
    v_smfmac_f32_32x32x32_bf16 v[192:207], v[96:99], v[40:47], v3
    v_exp_f32 v52, v52
    v_exp_f32 v53, v53
    v_exp_f32 v54, v54
    v_exp_f32 v55, v55
    v_exp_f32 v56, v56
    v_exp_f32 v57, v57
    v_smfmac_f32_32x32x32_bf16 v[208:223], v[92:95], v[48:55], v3
    buffer_load_dwordx4 v248, s[28:31], s51 offen offset:1024 lds
    s_add_u32 m0, s86, 14336
    s_add_u32 s51, s53, 180224
    v_exp_f32 v58, v58
    v_exp_f32 v59, v59
    v_exp_f32 v60, v60
    v_exp_f32 v61, v61
    v_exp_f32 v62, v62
    v_exp_f32 v63, v63
    v_mfma_f32_32x32x16_bf16 v[32:47], v[100:103], a[132:135], 0
    buffer_load_dwordx4 v247, s[28:31], s51 offen offset:0 lds
    v_exp_f32 v16, v16
    v_exp_f32 v17, v17
    v_exp_f32 v18, v18
    v_exp_f32 v19, v19
    v_smfmac_f32_32x32x32_bf16 v[208:223], v[96:99], v[56:63], v3
    s_add_u32 s88, s88, 4096
    s_and_b32 s88, s88, 0x1ffff
    s_add_u32 s93, s88, s63
    buffer_load_dwordx4 v[88:91], v2, s[4:7], s93 offen sc1
    v_exp_f32 v20, v20
    v_exp_f32 v21, v21
    v_exp_f32 v22, v22
    v_exp_f32 v23, v23
    v_exp_f32 v24, v24
    v_exp_f32 v25, v25
    v_smfmac_f32_32x32x32_bf16 v[160:175], v[104:107], v[16:23], v3
    s_mov_b64 exec, s[60:61]
    buffer_load_dwordx4 v[92:95], v12, s[4:7], s93 offen offset:1024 sc1
    buffer_load_dwordx4 v[96:99], v12, s[4:7], s93 offen offset:1536 sc1
    s_mov_b64 exec, -1
    v_exp_f32 v26, v26
    v_exp_f32 v27, v27
    v_exp_f32 v28, v28
    v_exp_f32 v29, v29
    v_exp_f32 v30, v30
    v_exp_f32 v31, v31
    v_mfma_f32_32x32x16_bf16 v[48:63], v[100:103], a[136:139], 0
    v_exp_f32 v32, v32
    v_exp_f32 v33, v33
    v_exp_f32 v34, v34
    v_exp_f32 v35, v35
    v_smfmac_f32_32x32x32_bf16 v[160:175], v[108:111], v[24:31], v3
    v_exp_f32 v36, v36
    v_exp_f32 v37, v37
    v_exp_f32 v38, v38
    v_exp_f32 v39, v39
    v_exp_f32 v40, v40
    v_exp_f32 v41, v41
    v_smfmac_f32_32x32x32_bf16 v[176:191], v[104:107], v[32:39], v3
    buffer_load_dwordx4 v248, s[28:31], s51 offen offset:1024 lds
    v_exp_f32 v42, v42
    v_exp_f32 v43, v43
    v_exp_f32 v44, v44
    v_exp_f32 v45, v45
    v_exp_f32 v46, v46
    v_exp_f32 v47, v47
    v_mfma_f32_32x32x16_bf16 v[16:31], v[100:103], a[140:143], 0
    v_exp_f32 v48, v48
    v_exp_f32 v49, v49
    v_exp_f32 v50, v50
    v_exp_f32 v51, v51
    v_smfmac_f32_32x32x32_bf16 v[176:191], v[108:111], v[40:47], v3
    v_lshlrev_b32 v7, 1, v13
    v_exp_f32 v52, v52
    v_exp_f32 v53, v53
    v_exp_f32 v54, v54
    v_exp_f32 v55, v55
    v_exp_f32 v56, v56
    v_exp_f32 v57, v57
    v_smfmac_f32_32x32x32_bf16 v[192:207], v[104:107], v[48:55], v3
    v_exp_f32 v58, v58
    v_exp_f32 v59, v59
    v_exp_f32 v60, v60
    v_exp_f32 v61, v61
    v_exp_f32 v62, v62
    v_exp_f32 v63, v63
    s_waitcnt vmcnt(36)
    v_mfma_f32_32x32x16_bf16 v[32:47], v[112:115], a[128:131], 0
    v_exp_f32 v16, v16
    v_exp_f32 v17, v17
    v_exp_f32 v18, v18
    v_exp_f32 v19, v19
    v_smfmac_f32_32x32x32_bf16 v[192:207], v[108:111], v[56:63], v3
    s_add_u32 s59, s74, 0
    buffer_load_dwordx2 a[168:169], v7, s[4:7], s59 offen sc1
    v_exp_f32 v20, v20
    v_exp_f32 v21, v21
    v_exp_f32 v22, v22
    v_exp_f32 v23, v23
    v_exp_f32 v24, v24
    v_exp_f32 v25, v25
    v_smfmac_f32_32x32x32_bf16 v[208:223], v[104:107], v[16:23], v3
    v_exp_f32 v26, v26
    v_exp_f32 v27, v27
    v_exp_f32 v28, v28
    v_exp_f32 v29, v29
    v_exp_f32 v30, v30
    v_exp_f32 v31, v31
    v_mfma_f32_32x32x16_bf16 v[48:63], v[112:115], a[132:135], 0
    v_exp_f32 v32, v32
    v_exp_f32 v33, v33
    v_exp_f32 v34, v34
    v_exp_f32 v35, v35
    v_smfmac_f32_32x32x32_bf16 v[208:223], v[108:111], v[24:31], v3
    s_add_u32 s88, s88, 4096
    s_and_b32 s88, s88, 0x1ffff
    s_add_u32 s93, s88, s63
    buffer_load_dwordx4 v[100:103], v2, s[4:7], s93 offen sc1
    v_exp_f32 v36, v36
    v_exp_f32 v37, v37
    v_exp_f32 v38, v38
    v_exp_f32 v39, v39
    v_exp_f32 v40, v40
    v_exp_f32 v41, v41
    v_smfmac_f32_32x32x32_bf16 v[160:175], v[116:119], v[32:39], v3
    s_mov_b64 exec, s[60:61]
    buffer_load_dwordx4 v[104:107], v12, s[4:7], s93 offen offset:1024 sc1
    buffer_load_dwordx4 v[108:111], v12, s[4:7], s93 offen offset:1536 sc1
    s_mov_b64 exec, -1
    v_accvgpr_read_b32 v8, a160
    buffer_load_dword v255, v8, s[20:23], 0 offen offset:0
    v_exp_f32 v42, v42
    v_exp_f32 v43, v43
    v_exp_f32 v44, v44
    v_exp_f32 v45, v45
    v_exp_f32 v46, v46
    v_exp_f32 v47, v47
    v_mfma_f32_32x32x16_bf16 v[16:31], v[112:115], a[136:139], 0
    v_exp_f32 v48, v48
    v_exp_f32 v49, v49
    v_exp_f32 v50, v50
    v_exp_f32 v51, v51
    v_smfmac_f32_32x32x32_bf16 v[160:175], v[120:123], v[40:47], v3
    s_add_u32 s59, s74, 16384
    buffer_load_dwordx2 a[170:171], v7, s[4:7], s59 offen sc1
    v_exp_f32 v52, v52
    v_exp_f32 v53, v53
    v_exp_f32 v54, v54
    v_exp_f32 v55, v55
    v_exp_f32 v56, v56
    v_exp_f32 v57, v57
    v_smfmac_f32_32x32x32_bf16 v[176:191], v[116:119], v[48:55], v3
    v_exp_f32 v58, v58
    v_exp_f32 v59, v59
    v_exp_f32 v60, v60
    v_exp_f32 v61, v61
    v_exp_f32 v62, v62
    v_exp_f32 v63, v63
    v_mfma_f32_32x32x16_bf16 v[32:47], v[112:115], a[140:143], 0
    v_exp_f32 v16, v16
    v_exp_f32 v17, v17
    v_exp_f32 v18, v18
    v_exp_f32 v19, v19
    v_smfmac_f32_32x32x32_bf16 v[176:191], v[120:123], v[56:63], v3
    s_add_u32 s59, s74, 32768
    buffer_load_dwordx2 a[172:173], v7, s[4:7], s59 offen sc1
    v_exp_f32 v20, v20
    v_exp_f32 v21, v21
    v_exp_f32 v22, v22
    v_exp_f32 v23, v23
    v_exp_f32 v24, v24
    v_exp_f32 v25, v25
    v_smfmac_f32_32x32x32_bf16 v[192:207], v[116:119], v[16:23], v3
    v_exp_f32 v26, v26
    v_exp_f32 v27, v27
    v_exp_f32 v28, v28
    v_exp_f32 v29, v29
    v_exp_f32 v30, v30
    v_exp_f32 v31, v31
    s_waitcnt vmcnt(38)
    v_mfma_f32_32x32x16_bf16 v[48:63], v[224:227], a[128:131], 0
    v_exp_f32 v32, v32
    v_exp_f32 v33, v33
    v_exp_f32 v34, v34
    v_exp_f32 v35, v35
    v_smfmac_f32_32x32x32_bf16 v[192:207], v[120:123], v[24:31], v3
    s_add_u32 s59, s74, 49152
    buffer_load_dwordx2 a[174:175], v7, s[4:7], s59 offen sc1
    v_exp_f32 v36, v36
    v_exp_f32 v37, v37
    v_exp_f32 v38, v38
    v_exp_f32 v39, v39
    v_exp_f32 v40, v40
    v_exp_f32 v41, v41
    v_smfmac_f32_32x32x32_bf16 v[208:223], v[116:119], v[32:39], v3
    v_accvgpr_read_b32 v7, a190
    buffer_load_dwordx2 a[176:177], v7, s[8:11], 0 offen offset:0
    buffer_load_dwordx2 a[178:179], v7, s[8:11], 0 offen offset:32
    v_exp_f32 v42, v42
    v_exp_f32 v43, v43
    v_exp_f32 v44, v44
    v_exp_f32 v45, v45
    v_exp_f32 v46, v46
    v_exp_f32 v47, v47
    v_mfma_f32_32x32x16_bf16 v[16:31], v[224:227], a[132:135], 0
    v_exp_f32 v48, v48
    v_exp_f32 v49, v49
    v_exp_f32 v50, v50
    v_exp_f32 v51, v51
    v_smfmac_f32_32x32x32_bf16 v[208:223], v[120:123], v[40:47], v3
    s_add_u32 s88, s88, 4096
    s_and_b32 s88, s88, 0x1ffff
    s_add_u32 s93, s88, s63
    buffer_load_dwordx4 v[112:115], v2, s[4:7], s93 offen sc1
    v_exp_f32 v52, v52
    v_exp_f32 v53, v53
    v_exp_f32 v54, v54
    v_exp_f32 v55, v55
    v_exp_f32 v56, v56
    v_exp_f32 v57, v57
    v_smfmac_f32_32x32x32_bf16 v[160:175], v[228:231], v[48:55], v3
    s_mov_b64 exec, s[60:61]
    buffer_load_dwordx4 v[116:119], v12, s[4:7], s93 offen offset:1024 sc1
    buffer_load_dwordx4 v[120:123], v12, s[4:7], s93 offen offset:1536 sc1
    s_mov_b64 exec, -1
    v_exp_f32 v58, v58
    v_exp_f32 v59, v59
    v_exp_f32 v60, v60
    v_exp_f32 v61, v61
    v_exp_f32 v62, v62
    v_exp_f32 v63, v63
    v_mfma_f32_32x32x16_bf16 v[32:47], v[224:227], a[136:139], 0
    v_exp_f32 v16, v16
    v_exp_f32 v17, v17
    v_exp_f32 v18, v18
    v_exp_f32 v19, v19
    v_smfmac_f32_32x32x32_bf16 v[160:175], v[232:235], v[56:63], v3
    s_waitcnt vmcnt(13)
    v_exp_f32 v20, v20
    v_exp_f32 v21, v21
    v_exp_f32 v22, v22
    v_exp_f32 v23, v23
    v_exp_f32 v24, v24
    v_exp_f32 v25, v25
    v_smfmac_f32_32x32x32_bf16 v[176:191], v[228:231], v[16:23], v3
    buffer_load_dwordx2 a[180:181], v7, s[8:11], 0 offen offset:64
    buffer_load_dwordx2 a[182:183], v7, s[8:11], 0 offen offset:96
    v_exp_f32 v26, v26
    v_exp_f32 v27, v27
    v_exp_f32 v28, v28
    v_exp_f32 v29, v29
    v_exp_f32 v30, v30
    v_exp_f32 v31, v31
    v_mfma_f32_32x32x16_bf16 v[48:63], v[224:227], a[140:143], 0
    v_exp_f32 v32, v32
    v_exp_f32 v33, v33
    v_exp_f32 v34, v34
    v_exp_f32 v35, v35
    v_smfmac_f32_32x32x32_bf16 v[176:191], v[232:235], v[24:31], v3
    ds_read_b64_tr_b16 a[192:193], v249 offset:0
    ds_read_b64_tr_b16 a[194:195], v249 offset:2048
    v_exp_f32 v36, v36
    v_exp_f32 v37, v37
    v_exp_f32 v38, v38
    v_exp_f32 v39, v39
    v_exp_f32 v40, v40
    v_exp_f32 v41, v41
    v_smfmac_f32_32x32x32_bf16 v[192:207], v[228:231], v[32:39], v3
    v_exp_f32 v42, v42
    v_exp_f32 v43, v43
    v_exp_f32 v44, v44
    v_exp_f32 v45, v45
    v_exp_f32 v46, v46
    v_exp_f32 v47, v47
    v_mfma_f32_32x32x16_bf16 v[16:31], v[128:131], a[128:131], 0
    v_exp_f32 v48, v48
    v_exp_f32 v49, v49
    v_exp_f32 v50, v50
    v_exp_f32 v51, v51
    v_smfmac_f32_32x32x32_bf16 v[192:207], v[232:235], v[40:47], v3
    ds_read_b64_tr_b16 a[196:197], v250 offset:0
    ds_read_b64_tr_b16 a[198:199], v250 offset:2048
    s_getpc_b64 s[68:69]
L_pc_27:
    s_lshl_b32 s70, s45, 2
    s_add_u32 s70, s70, s46
    s_lshl_b32 s70, s70, 8
    v_and_b32 v8, 1, v1
    v_lshlrev_b32 v8, 7, v8
    v_add_u32 v8, s70, v8
    v_min_u32 v8, L_tail_end-L_u96-4, v8
    v_add_u32 v8, L_u96-L_pc_27, v8
    global_load_dword v254, v8, s[68:69]
    v_exp_f32 v52, v52
    v_exp_f32 v53, v53
    v_exp_f32 v54, v54
    v_exp_f32 v55, v55
    v_exp_f32 v56, v56
    v_exp_f32 v57, v57
    v_smfmac_f32_32x32x32_bf16 v[208:223], v[228:231], v[48:55], v3
    v_exp_f32 v58, v58
    v_exp_f32 v59, v59
    v_exp_f32 v60, v60
    v_exp_f32 v61, v61
    v_exp_f32 v62, v62
    v_exp_f32 v63, v63
L_u96:
    v_mfma_f32_32x32x16_bf16 v[32:47], v[128:131], a[132:135], 0
    v_exp_f32 v16, v16
    v_exp_f32 v17, v17
    v_exp_f32 v18, v18
    v_exp_f32 v19, v19
    v_smfmac_f32_32x32x32_bf16 v[208:223], v[232:235], v[56:63], v3
    s_add_u32 s88, s88, 4096
    s_and_b32 s88, s88, 0x1ffff
    s_add_u32 s93, s88, s63
    buffer_load_dwordx4 v[224:227], v2, s[4:7], s93 offen sc1
    v_exp_f32 v20, v20
    v_exp_f32 v21, v21
    v_exp_f32 v22, v22
    v_exp_f32 v23, v23
    v_exp_f32 v24, v24
    v_exp_f32 v25, v25
    v_smfmac_f32_32x32x32_bf16 v[160:175], v[132:135], v[16:23], v3
    s_mov_b64 exec, s[60:61]
    buffer_load_dwordx4 v[228:231], v12, s[4:7], s93 offen offset:1024 sc1
    buffer_load_dwordx4 v[232:235], v12, s[4:7], s93 offen offset:1536 sc1
    s_mov_b64 exec, -1
    v_exp_f32 v26, v26
    v_exp_f32 v27, v27
    v_exp_f32 v28, v28
    v_exp_f32 v29, v29
    v_exp_f32 v30, v30
    v_exp_f32 v31, v31
    v_mfma_f32_32x32x16_bf16 v[48:63], v[128:131], a[136:139], 0
    v_exp_f32 v32, v32
    v_exp_f32 v33, v33
    v_exp_f32 v34, v34
    v_exp_f32 v35, v35
    v_smfmac_f32_32x32x32_bf16 v[160:175], v[136:139], v[24:31], v3
    ds_read_b64_tr_b16 a[200:201], v251 offset:0
    ds_read_b64_tr_b16 a[202:203], v251 offset:2048
    v_accvgpr_read_b32 v8, a163
    buffer_load_dword v255, v8, s[4:7], 0 offen offset:0
    v_exp_f32 v36, v36
    v_exp_f32 v37, v37
    v_exp_f32 v38, v38
    v_exp_f32 v39, v39
    v_exp_f32 v40, v40
    v_exp_f32 v41, v41
    v_smfmac_f32_32x32x32_bf16 v[176:191], v[132:135], v[32:39], v3
    v_exp_f32 v42, v42
    v_exp_f32 v43, v43
    v_exp_f32 v44, v44
    v_exp_f32 v45, v45
    v_exp_f32 v46, v46
    v_exp_f32 v47, v47
    v_mfma_f32_32x32x16_bf16 v[16:31], v[128:131], a[140:143], 0
    v_exp_f32 v48, v48
    v_exp_f32 v49, v49
    v_exp_f32 v50, v50
    v_exp_f32 v51, v51
    v_smfmac_f32_32x32x32_bf16 v[176:191], v[136:139], v[40:47], v3
    ds_read_b64_tr_b16 a[204:205], v252 offset:0
    ds_read_b64_tr_b16 a[206:207], v252 offset:2048
    v_exp_f32 v52, v52
    v_exp_f32 v53, v53
    v_exp_f32 v54, v54
    v_exp_f32 v55, v55
    v_exp_f32 v56, v56
    v_exp_f32 v57, v57
    v_smfmac_f32_32x32x32_bf16 v[192:207], v[132:135], v[48:55], v3
    v_exp_f32 v58, v58
    v_exp_f32 v59, v59
    v_exp_f32 v60, v60
    v_exp_f32 v61, v61
    v_exp_f32 v62, v62
    v_exp_f32 v63, v63
    v_mfma_f32_32x32x16_bf16 v[32:47], v[140:143], a[128:131], 0
    v_exp_f32 v16, v16
    v_exp_f32 v17, v17
    v_exp_f32 v18, v18
    v_exp_f32 v19, v19
    v_smfmac_f32_32x32x32_bf16 v[192:207], v[136:139], v[56:63], v3
    ds_read_b64_tr_b16 a[208:209], v249 offset:4096
    ds_read_b64_tr_b16 a[210:211], v249 offset:6144
    v_exp_f32 v20, v20
    v_exp_f32 v21, v21
    v_exp_f32 v22, v22
    v_exp_f32 v23, v23
    v_exp_f32 v24, v24
    v_exp_f32 v25, v25
    v_smfmac_f32_32x32x32_bf16 v[208:223], v[132:135], v[16:23], v3
    v_accvgpr_read_b32 v8, a163
    buffer_load_dword v255, v8, s[4:7], 0 offen offset:1792
    v_exp_f32 v26, v26
    v_exp_f32 v27, v27
    v_exp_f32 v28, v28
    v_exp_f32 v29, v29
    v_exp_f32 v30, v30
    v_exp_f32 v31, v31
    v_mfma_f32_32x32x16_bf16 v[48:63], v[140:143], a[132:135], 0
    v_exp_f32 v32, v32
    v_exp_f32 v33, v33
    v_exp_f32 v34, v34
    v_exp_f32 v35, v35
    v_smfmac_f32_32x32x32_bf16 v[208:223], v[136:139], v[24:31], v3
    ds_read_b64_tr_b16 a[212:213], v250 offset:4096
    ds_read_b64_tr_b16 a[214:215], v250 offset:6144
    v_exp_f32 v36, v36
    v_exp_f32 v37, v37
    v_exp_f32 v38, v38
    v_exp_f32 v39, v39
    v_exp_f32 v40, v40
    v_exp_f32 v41, v41
    v_smfmac_f32_32x32x32_bf16 v[160:175], v[144:147], v[32:39], v3
    v_exp_f32 v42, v42
    v_exp_f32 v43, v43
    v_exp_f32 v44, v44
    v_exp_f32 v45, v45
    v_exp_f32 v46, v46
    v_exp_f32 v47, v47
    v_mfma_f32_32x32x16_bf16 v[16:31], v[140:143], a[136:139], 0
    v_exp_f32 v48, v48
    v_exp_f32 v49, v49
    v_exp_f32 v50, v50
    v_exp_f32 v51, v51
    v_smfmac_f32_32x32x32_bf16 v[160:175], v[148:151], v[40:47], v3
    ds_read_b64_tr_b16 a[216:217], v251 offset:4096
    ds_read_b64_tr_b16 a[218:219], v251 offset:6144
    v_exp_f32 v52, v52
    v_exp_f32 v53, v53
    v_exp_f32 v54, v54
    v_exp_f32 v55, v55
    v_exp_f32 v56, v56
    v_exp_f32 v57, v57
    v_smfmac_f32_32x32x32_bf16 v[176:191], v[144:147], v[48:55], v3
    v_accvgpr_read_b32 v8, a164
    buffer_load_dword v255, v8, s[4:7], 0 offen offset:0
    v_exp_f32 v58, v58
    v_exp_f32 v59, v59
    v_exp_f32 v60, v60
    v_exp_f32 v61, v61
    v_exp_f32 v62, v62
    v_exp_f32 v63, v63
    v_mfma_f32_32x32x16_bf16 v[32:47], v[140:143], a[140:143], 0
    v_exp_f32 v16, v16
    v_exp_f32 v17, v17
    v_exp_f32 v18, v18
    v_exp_f32 v19, v19
    v_smfmac_f32_32x32x32_bf16 v[176:191], v[148:151], v[56:63], v3
    ds_read_b64_tr_b16 a[220:221], v252 offset:4096
    ds_read_b64_tr_b16 a[222:223], v252 offset:6144
    v_exp_f32 v20, v20
    v_exp_f32 v21, v21
    v_exp_f32 v22, v22
    v_exp_f32 v23, v23
    v_exp_f32 v24, v24
    v_exp_f32 v25, v25
    v_smfmac_f32_32x32x32_bf16 v[192:207], v[144:147], v[16:23], v3
    v_exp_f32 v26, v26
    v_exp_f32 v27, v27
    v_exp_f32 v28, v28
    v_exp_f32 v29, v29
    v_exp_f32 v30, v30
    v_exp_f32 v31, v31
    v_mfma_f32_32x32x16_bf16 v[48:63], v[64:67], a[128:131], 0
    v_exp_f32 v32, v32
    v_exp_f32 v33, v33
    v_exp_f32 v34, v34
    v_exp_f32 v35, v35
    v_smfmac_f32_32x32x32_bf16 v[192:207], v[148:151], v[24:31], v3
    ds_read_b64_tr_b16 a[224:225], v249 offset:8192
    ds_read_b64_tr_b16 a[226:227], v249 offset:10240
    v_exp_f32 v36, v36
    v_exp_f32 v37, v37
    v_exp_f32 v38, v38
    v_exp_f32 v39, v39
    v_exp_f32 v40, v40
    v_exp_f32 v41, v41
    v_smfmac_f32_32x32x32_bf16 v[208:223], v[144:147], v[32:39], v3
    v_exp_f32 v42, v42
    v_exp_f32 v43, v43
    v_exp_f32 v44, v44
    v_exp_f32 v45, v45
    v_exp_f32 v46, v46
    v_exp_f32 v47, v47
    v_mfma_f32_32x32x16_bf16 v[16:31], v[64:67], a[132:135], 0
    v_exp_f32 v48, v48
    v_exp_f32 v49, v49
    v_exp_f32 v50, v50
    v_exp_f32 v51, v51
    v_smfmac_f32_32x32x32_bf16 v[208:223], v[148:151], v[40:47], v3
    ds_read_b64_tr_b16 a[228:229], v250 offset:8192
    ds_read_b64_tr_b16 a[230:231], v250 offset:10240
    v_exp_f32 v52, v52
    v_exp_f32 v53, v53
    v_exp_f32 v54, v54
    v_exp_f32 v55, v55
    v_exp_f32 v56, v56
    v_exp_f32 v57, v57
    v_smfmac_f32_32x32x32_bf16 v[160:175], v[68:71], v[48:55], v3
    v_exp_f32 v58, v58
    v_exp_f32 v59, v59
    v_exp_f32 v60, v60
    v_exp_f32 v61, v61
    v_exp_f32 v62, v62
    v_exp_f32 v63, v63
    v_mfma_f32_32x32x16_bf16 v[32:47], v[64:67], a[136:139], 0
    v_exp_f32 v16, v16
    v_exp_f32 v17, v17
    v_exp_f32 v18, v18
    v_exp_f32 v19, v19
    v_smfmac_f32_32x32x32_bf16 v[160:175], v[72:75], v[56:63], v3
    ds_read_b64_tr_b16 a[232:233], v251 offset:8192
    ds_read_b64_tr_b16 a[234:235], v251 offset:10240
    v_exp_f32 v20, v20
    v_exp_f32 v21, v21
    v_exp_f32 v22, v22
    v_exp_f32 v23, v23
    v_exp_f32 v24, v24
    v_exp_f32 v25, v25
    v_smfmac_f32_32x32x32_bf16 v[176:191], v[68:71], v[16:23], v3
    v_exp_f32 v26, v26
    v_exp_f32 v27, v27
    v_exp_f32 v28, v28
    v_exp_f32 v29, v29
    v_exp_f32 v30, v30
    v_exp_f32 v31, v31
    v_mfma_f32_32x32x16_bf16 v[48:63], v[64:67], a[140:143], 0
    v_exp_f32 v32, v32
    v_exp_f32 v33, v33
    v_exp_f32 v34, v34
    v_exp_f32 v35, v35
    v_smfmac_f32_32x32x32_bf16 v[176:191], v[72:75], v[24:31], v3
    ds_read_b64_tr_b16 a[236:237], v252 offset:8192
    ds_read_b64_tr_b16 a[238:239], v252 offset:10240
    v_exp_f32 v36, v36
    v_exp_f32 v37, v37
    v_exp_f32 v38, v38
    v_exp_f32 v39, v39
    v_exp_f32 v40, v40
    v_exp_f32 v41, v41
    v_smfmac_f32_32x32x32_bf16 v[192:207], v[68:71], v[32:39], v3
    v_exp_f32 v42, v42
    v_exp_f32 v43, v43
    v_exp_f32 v44, v44
    v_exp_f32 v45, v45
    v_exp_f32 v46, v46
    v_exp_f32 v47, v47
    v_mfma_f32_32x32x16_bf16 v[16:31], v[76:79], a[128:131], 0
    v_exp_f32 v48, v48
    v_exp_f32 v49, v49
    v_exp_f32 v50, v50
    v_exp_f32 v51, v51
    v_smfmac_f32_32x32x32_bf16 v[192:207], v[72:75], v[40:47], v3
    ds_read_b64_tr_b16 a[240:241], v249 offset:12288
    ds_read_b64_tr_b16 a[242:243], v249 offset:14336
    v_exp_f32 v52, v52
    v_exp_f32 v53, v53
    v_exp_f32 v54, v54
    v_exp_f32 v55, v55
    v_exp_f32 v56, v56
    v_exp_f32 v57, v57
    v_smfmac_f32_32x32x32_bf16 v[208:223], v[68:71], v[48:55], v3
    v_accvgpr_read_b32 v8, a162
    buffer_load_dword v255, v8, s[20:23], 0 offen offset:0
    v_exp_f32 v58, v58
    v_exp_f32 v59, v59
    v_exp_f32 v60, v60
    v_exp_f32 v61, v61
    v_exp_f32 v62, v62
    v_exp_f32 v63, v63
    v_mfma_f32_32x32x16_bf16 v[32:47], v[76:79], a[132:135], 0
    v_exp_f32 v16, v16
    v_exp_f32 v17, v17
    v_exp_f32 v18, v18
    v_exp_f32 v19, v19
    v_smfmac_f32_32x32x32_bf16 v[208:223], v[72:75], v[56:63], v3
    ds_read_b64_tr_b16 a[244:245], v250 offset:12288
    ds_read_b64_tr_b16 a[246:247], v250 offset:14336
    v_exp_f32 v20, v20
    v_exp_f32 v21, v21
    v_exp_f32 v22, v22
    v_exp_f32 v23, v23
    v_exp_f32 v24, v24
    v_exp_f32 v25, v25
    v_smfmac_f32_32x32x32_bf16 v[160:175], v[80:83], v[16:23], v3
    v_exp_f32 v26, v26
    v_exp_f32 v27, v27
    v_exp_f32 v28, v28
    v_exp_f32 v29, v29
    v_exp_f32 v30, v30
    v_exp_f32 v31, v31
    v_mfma_f32_32x32x16_bf16 v[48:63], v[76:79], a[136:139], 0
    v_exp_f32 v32, v32
    v_exp_f32 v33, v33
    v_exp_f32 v34, v34
    v_exp_f32 v35, v35
    v_smfmac_f32_32x32x32_bf16 v[160:175], v[84:87], v[24:31], v3
    ds_read_b64_tr_b16 a[248:249], v251 offset:12288
    ds_read_b64_tr_b16 a[250:251], v251 offset:14336
    v_exp_f32 v36, v36
    v_exp_f32 v37, v37
    v_exp_f32 v38, v38
    v_exp_f32 v39, v39
    v_exp_f32 v40, v40
    v_exp_f32 v41, v41
    v_smfmac_f32_32x32x32_bf16 v[176:191], v[80:83], v[32:39], v3
    v_exp_f32 v42, v42
    v_exp_f32 v43, v43
    v_exp_f32 v44, v44
    v_exp_f32 v45, v45
    v_exp_f32 v46, v46
    v_exp_f32 v47, v47
    v_mfma_f32_32x32x16_bf16 v[16:31], v[76:79], a[140:143], 0
    v_exp_f32 v48, v48
    v_exp_f32 v49, v49
    v_exp_f32 v50, v50
    v_exp_f32 v51, v51
    v_smfmac_f32_32x32x32_bf16 v[176:191], v[84:87], v[40:47], v3
    ds_read_b64_tr_b16 a[252:253], v252 offset:12288
    ds_read_b64_tr_b16 a[254:255], v252 offset:14336
    v_exp_f32 v52, v52
    v_exp_f32 v53, v53
    v_exp_f32 v54, v54
    v_exp_f32 v55, v55
    v_exp_f32 v56, v56
    v_exp_f32 v57, v57
    v_smfmac_f32_32x32x32_bf16 v[192:207], v[80:83], v[48:55], v3
    v_exp_f32 v58, v58
    v_exp_f32 v59, v59
    v_exp_f32 v60, v60
    v_exp_f32 v61, v61
    v_exp_f32 v62, v62
    v_exp_f32 v63, v63
    v_mfma_f32_32x32x16_bf16 v[32:47], v[88:91], a[128:131], 0
    v_exp_f32 v16, v16
    v_exp_f32 v17, v17
    v_exp_f32 v18, v18
    v_exp_f32 v19, v19
    v_smfmac_f32_32x32x32_bf16 v[192:207], v[84:87], v[56:63], v3
    v_exp_f32 v20, v20
    v_exp_f32 v21, v21
    v_exp_f32 v22, v22
    v_exp_f32 v23, v23
    v_exp_f32 v24, v24
    v_exp_f32 v25, v25
    v_smfmac_f32_32x32x32_bf16 v[208:223], v[80:83], v[16:23], v3
    v_accvgpr_read_b32 v8, a162
    buffer_load_dword v255, v8, s[20:23], 0 offen offset:3584
    v_exp_f32 v26, v26
    v_exp_f32 v27, v27
    v_exp_f32 v28, v28
    v_exp_f32 v29, v29
    v_exp_f32 v30, v30
    v_exp_f32 v31, v31
    v_mfma_f32_32x32x16_bf16 v[48:63], v[88:91], a[132:135], 0
    v_exp_f32 v32, v32
    v_exp_f32 v33, v33
    v_exp_f32 v34, v34
    v_exp_f32 v35, v35
    v_smfmac_f32_32x32x32_bf16 v[208:223], v[84:87], v[24:31], v3
    v_exp_f32 v36, v36
    v_exp_f32 v37, v37
    v_exp_f32 v38, v38
    v_exp_f32 v39, v39
    v_exp_f32 v40, v40
    v_exp_f32 v41, v41
    v_smfmac_f32_32x32x32_bf16 v[160:175], v[92:95], v[32:39], v3
    v_exp_f32 v42, v42
    v_exp_f32 v43, v43
    v_exp_f32 v44, v44
    v_exp_f32 v45, v45
    v_exp_f32 v46, v46
    v_exp_f32 v47, v47
    v_mfma_f32_32x32x16_bf16 v[16:31], v[88:91], a[136:139], 0
    v_exp_f32 v48, v48
    v_exp_f32 v49, v49
    v_exp_f32 v50, v50
    v_exp_f32 v51, v51
    v_smfmac_f32_32x32x32_bf16 v[160:175], v[96:99], v[40:47], v3
    v_exp_f32 v52, v52
    v_exp_f32 v53, v53
    v_exp_f32 v54, v54
    v_exp_f32 v55, v55
    v_exp_f32 v56, v56
    v_exp_f32 v57, v57
    v_smfmac_f32_32x32x32_bf16 v[176:191], v[92:95], v[48:55], v3
    v_exp_f32 v58, v58
    v_exp_f32 v59, v59
    v_exp_f32 v60, v60
    v_exp_f32 v61, v61
    v_exp_f32 v62, v62
    v_exp_f32 v63, v63
    v_mfma_f32_32x32x16_bf16 v[32:47], v[88:91], a[140:143], 0
    v_exp_f32 v16, v16
    v_exp_f32 v17, v17
    v_exp_f32 v18, v18
    v_exp_f32 v19, v19
    v_smfmac_f32_32x32x32_bf16 v[176:191], v[96:99], v[56:63], v3
    v_exp_f32 v20, v20
    v_exp_f32 v21, v21
    v_exp_f32 v22, v22
    v_exp_f32 v23, v23
    v_exp_f32 v24, v24
    v_exp_f32 v25, v25
    v_smfmac_f32_32x32x32_bf16 v[192:207], v[92:95], v[16:23], v3
    v_exp_f32 v26, v26
    v_exp_f32 v27, v27
    v_exp_f32 v28, v28
    v_exp_f32 v29, v29
    v_exp_f32 v30, v30
    v_exp_f32 v31, v31
    s_waitcnt vmcnt(20)
    v_mfma_f32_32x32x16_bf16 v[48:63], v[100:103], a[128:131], 0
    v_exp_f32 v32, v32
    v_exp_f32 v33, v33
    v_exp_f32 v34, v34
    v_exp_f32 v35, v35
    v_smfmac_f32_32x32x32_bf16 v[192:207], v[96:99], v[24:31], v3
    v_exp_f32 v36, v36
    v_exp_f32 v37, v37
    v_exp_f32 v38, v38
    v_exp_f32 v39, v39
    v_exp_f32 v40, v40
    v_exp_f32 v41, v41
    v_smfmac_f32_32x32x32_bf16 v[208:223], v[92:95], v[32:39], v3
    v_exp_f32 v42, v42
    v_exp_f32 v43, v43
    v_exp_f32 v44, v44
    v_exp_f32 v45, v45
    v_exp_f32 v46, v46
    v_exp_f32 v47, v47
    v_mfma_f32_32x32x16_bf16 v[16:31], v[100:103], a[132:135], 0
    v_exp_f32 v48, v48
    v_exp_f32 v49, v49
    v_exp_f32 v50, v50
    v_exp_f32 v51, v51
    v_smfmac_f32_32x32x32_bf16 v[208:223], v[96:99], v[40:47], v3
    v_exp_f32 v52, v52
    v_exp_f32 v53, v53
    v_exp_f32 v54, v54
    v_exp_f32 v55, v55
    v_exp_f32 v56, v56
    v_exp_f32 v57, v57
    v_smfmac_f32_32x32x32_bf16 v[160:175], v[104:107], v[48:55], v3
    v_exp_f32 v58, v58
    v_exp_f32 v59, v59
    v_exp_f32 v60, v60
    v_exp_f32 v61, v61
    v_exp_f32 v62, v62
    v_exp_f32 v63, v63
    v_mfma_f32_32x32x16_bf16 v[32:47], v[100:103], a[136:139], 0
    v_exp_f32 v16, v16
    v_exp_f32 v17, v17
    v_exp_f32 v18, v18
    v_exp_f32 v19, v19
    v_smfmac_f32_32x32x32_bf16 v[160:175], v[108:111], v[56:63], v3
    v_exp_f32 v20, v20
    v_exp_f32 v21, v21
    v_exp_f32 v22, v22
    v_exp_f32 v23, v23
    v_exp_f32 v24, v24
    v_exp_f32 v25, v25
    v_smfmac_f32_32x32x32_bf16 v[176:191], v[104:107], v[16:23], v3
    v_exp_f32 v26, v26
    v_exp_f32 v27, v27
    v_exp_f32 v28, v28
    v_exp_f32 v29, v29
    v_exp_f32 v30, v30
    v_exp_f32 v31, v31
    v_mfma_f32_32x32x16_bf16 v[48:63], v[100:103], a[140:143], 0
    v_exp_f32 v32, v32
    v_exp_f32 v33, v33
    v_exp_f32 v34, v34
    v_exp_f32 v35, v35
    v_smfmac_f32_32x32x32_bf16 v[176:191], v[108:111], v[24:31], v3
    v_exp_f32 v36, v36
    v_exp_f32 v37, v37
    v_exp_f32 v38, v38
    v_exp_f32 v39, v39
    v_exp_f32 v40, v40
    v_exp_f32 v41, v41
    v_smfmac_f32_32x32x32_bf16 v[192:207], v[104:107], v[32:39], v3
    v_exp_f32 v42, v42
    v_exp_f32 v43, v43
    v_exp_f32 v44, v44
    v_exp_f32 v45, v45
    v_exp_f32 v46, v46
    v_exp_f32 v47, v47
    s_waitcnt vmcnt(11)
    v_mfma_f32_32x32x16_bf16 v[16:31], v[112:115], a[128:131], 0
    v_exp_f32 v48, v48
    v_exp_f32 v49, v49
    v_exp_f32 v50, v50
    v_exp_f32 v51, v51
    v_smfmac_f32_32x32x32_bf16 v[192:207], v[108:111], v[40:47], v3
    v_exp_f32 v52, v52
    v_exp_f32 v53, v53
    v_exp_f32 v54, v54
    v_exp_f32 v55, v55
    v_exp_f32 v56, v56
    v_exp_f32 v57, v57
    v_smfmac_f32_32x32x32_bf16 v[208:223], v[104:107], v[48:55], v3
    v_exp_f32 v58, v58
    v_exp_f32 v59, v59
    v_exp_f32 v60, v60
    v_exp_f32 v61, v61
    v_exp_f32 v62, v62
    v_exp_f32 v63, v63
    v_mfma_f32_32x32x16_bf16 v[32:47], v[112:115], a[132:135], 0
    v_exp_f32 v16, v16
    v_exp_f32 v17, v17
    v_exp_f32 v18, v18
    v_exp_f32 v19, v19
    v_smfmac_f32_32x32x32_bf16 v[208:223], v[108:111], v[56:63], v3
    v_exp_f32 v20, v20
    v_exp_f32 v21, v21
    v_exp_f32 v22, v22
    v_exp_f32 v23, v23
    v_exp_f32 v24, v24
    v_exp_f32 v25, v25
    v_smfmac_f32_32x32x32_bf16 v[160:175], v[116:119], v[16:23], v3
    v_exp_f32 v26, v26
    v_exp_f32 v27, v27
    v_exp_f32 v28, v28
    v_exp_f32 v29, v29
    v_exp_f32 v30, v30
    v_exp_f32 v31, v31
    v_mfma_f32_32x32x16_bf16 v[48:63], v[112:115], a[136:139], 0
    v_exp_f32 v32, v32
    v_exp_f32 v33, v33
    v_exp_f32 v34, v34
    v_exp_f32 v35, v35
    v_smfmac_f32_32x32x32_bf16 v[160:175], v[120:123], v[24:31], v3
    v_exp_f32 v36, v36
    v_exp_f32 v37, v37
    v_exp_f32 v38, v38
    v_exp_f32 v39, v39
    v_exp_f32 v40, v40
    v_exp_f32 v41, v41
    v_smfmac_f32_32x32x32_bf16 v[176:191], v[116:119], v[32:39], v3
    s_waitcnt lgkmcnt(0)
    v_add_u32 v249, s86, v2
    v_add_u32 v250, s86, v13
    s_xor_b32 s93, s46, 2
    s_lshl_b32 s93, s93, 14
    s_add_u32 s93, s93, 87552
    v_add_u32 v251, s93, v2
    v_add_u32 v252, s93, v13
    v_bfe_u32 v8, v1, 4, 1
    v_lshlrev_b32 v8, 14, v8
    v_lshrrev_b32 v6, 5, v1
    v_lshl_add_u32 v8, v6, 8, v8
    v_and_b32 v6, 15, v1
    v_lshl_add_u32 v8, v6, 4, v8
    v_exp_f32 v42, v42
    v_exp_f32 v43, v43
    v_exp_f32 v44, v44
    v_exp_f32 v45, v45
    v_exp_f32 v46, v46
    v_exp_f32 v47, v47
    v_mfma_f32_32x32x16_bf16 v[16:31], v[112:115], a[140:143], 0
    v_exp_f32 v48, v48
    v_exp_f32 v49, v49
    v_exp_f32 v50, v50
    v_exp_f32 v51, v51
    v_smfmac_f32_32x32x32_bf16 v[176:191], v[120:123], v[40:47], v3
    v_exp_f32 v52, v52
    v_exp_f32 v53, v53
    v_exp_f32 v54, v54
    v_exp_f32 v55, v55
    v_exp_f32 v56, v56
    v_exp_f32 v57, v57
    v_smfmac_f32_32x32x32_bf16 v[192:207], v[116:119], v[48:55], v3
    v_exp_f32 v58, v58
    v_exp_f32 v59, v59
    v_exp_f32 v60, v60
    v_exp_f32 v61, v61
    v_exp_f32 v62, v62
    v_exp_f32 v63, v63
    s_waitcnt vmcnt(5)
    v_mfma_f32_32x32x16_bf16 v[32:47], v[224:227], a[128:131], 0
    v_exp_f32 v16, v16
    v_exp_f32 v17, v17
    v_exp_f32 v18, v18
    v_exp_f32 v19, v19
    v_smfmac_f32_32x32x32_bf16 v[192:207], v[120:123], v[56:63], v3
    v_exp_f32 v20, v20
    v_exp_f32 v21, v21
    v_exp_f32 v22, v22
    v_exp_f32 v23, v23
    v_exp_f32 v24, v24
    v_exp_f32 v25, v25
    v_smfmac_f32_32x32x32_bf16 v[208:223], v[116:119], v[16:23], v3
    v_exp_f32 v26, v26
    v_exp_f32 v27, v27
    v_exp_f32 v28, v28
    v_exp_f32 v29, v29
    v_exp_f32 v30, v30
    v_exp_f32 v31, v31
    v_mfma_f32_32x32x16_bf16 v[48:63], v[224:227], a[132:135], 0
    v_exp_f32 v32, v32
    v_exp_f32 v33, v33
    v_exp_f32 v34, v34
    v_exp_f32 v35, v35
    v_smfmac_f32_32x32x32_bf16 v[208:223], v[120:123], v[24:31], v3
    v_exp_f32 v36, v36
    v_exp_f32 v37, v37
    v_exp_f32 v38, v38
    v_exp_f32 v39, v39
    v_exp_f32 v40, v40
    v_exp_f32 v41, v41
    v_smfmac_f32_32x32x32_bf16 v[160:175], v[228:231], v[32:39], v3
    v_exp_f32 v42, v42
    v_exp_f32 v43, v43
    v_exp_f32 v44, v44
    v_exp_f32 v45, v45
    v_exp_f32 v46, v46
    v_exp_f32 v47, v47
    v_mfma_f32_32x32x16_bf16 v[16:31], v[224:227], a[136:139], 0
    v_exp_f32 v48, v48
    v_exp_f32 v49, v49
    v_exp_f32 v50, v50
    v_exp_f32 v51, v51
    v_smfmac_f32_32x32x32_bf16 v[160:175], v[232:235], v[40:47], v3
    v_exp_f32 v52, v52
    v_exp_f32 v53, v53
    v_exp_f32 v54, v54
    v_exp_f32 v55, v55
    v_exp_f32 v56, v56
    v_exp_f32 v57, v57
    v_smfmac_f32_32x32x32_bf16 v[176:191], v[228:231], v[48:55], v3
    v_exp_f32 v58, v58
    v_exp_f32 v59, v59
    v_exp_f32 v60, v60
    v_exp_f32 v61, v61
    v_exp_f32 v62, v62
    v_exp_f32 v63, v63
    v_mfma_f32_32x32x16_bf16 v[32:47], v[224:227], a[140:143], 0
    v_exp_f32 v16, v16
    v_exp_f32 v17, v17
    v_exp_f32 v18, v18
    v_exp_f32 v19, v19
    v_smfmac_f32_32x32x32_bf16 v[176:191], v[232:235], v[56:63], v3
    ds_write_b128 v249, v[160:163] offset:0
    ds_write_b128 v249, v[164:167] offset:1024
    v_exp_f32 v20, v20
    v_exp_f32 v21, v21
    v_exp_f32 v22, v22
    v_exp_f32 v23, v23
    v_exp_f32 v24, v24
    v_exp_f32 v25, v25
    v_smfmac_f32_32x32x32_bf16 v[192:207], v[228:231], v[16:23], v3
    ds_write_b32 v250, v168 offset:2048
    v_exp_f32 v26, v26
    v_exp_f32 v27, v27
    v_exp_f32 v28, v28
    v_exp_f32 v29, v29
    v_exp_f32 v30, v30
    v_exp_f32 v31, v31
    v_exp_f32 v32, v32
    v_exp_f32 v33, v33
    v_exp_f32 v34, v34
    v_exp_f32 v35, v35
    v_smfmac_f32_32x32x32_bf16 v[192:207], v[232:235], v[24:31], v3
    ds_write_b128 v249, v[176:179] offset:2304
    ds_write_b128 v249, v[180:183] offset:3328
    v_exp_f32 v36, v36
    v_exp_f32 v37, v37
    v_exp_f32 v38, v38
    v_exp_f32 v39, v39
    v_exp_f32 v40, v40
    v_exp_f32 v41, v41
    v_smfmac_f32_32x32x32_bf16 v[208:223], v[228:231], v[32:39], v3
    ds_write_b32 v250, v184 offset:4352
    v_exp_f32 v42, v42
    v_exp_f32 v43, v43
    v_exp_f32 v44, v44
    v_exp_f32 v45, v45
    v_exp_f32 v46, v46
    v_exp_f32 v47, v47
    s_nop 1
    v_smfmac_f32_32x32x32_bf16 v[208:223], v[232:235], v[40:47], v3
    s_waitcnt lgkmcnt(0)
    s_barrier
    ds_read_b128 v[64:67], v251 offset:0
    ds_read_b128 v[68:71], v251 offset:1024
    ds_read_b32 v72, v252 offset:2048
    ds_read_b128 v[76:79], v251 offset:2304
    ds_read_b128 v[80:83], v251 offset:3328
    ds_read_b32 v84, v252 offset:4352
    s_mov_b32 s53, s94
    s_add_u32 s54, s94, 32768
    s_mov_b32 s52, s95
    s_mov_b32 s55, 0x2b800000
    s_mov_b32 s93, 0x71800000
    s_nop 1
    s_waitcnt lgkmcnt(3)
    v_pk_add_f32 v[192:193], v[192:193], v[64:65]
    v_pk_add_f32 v[194:195], v[194:195], v[66:67]
    v_pk_add_f32 v[196:197], v[196:197], v[68:69]
    v_pk_add_f32 v[198:199], v[198:199], v[70:71]
    v_add_f32 v200, v200, v72
    s_waitcnt lgkmcnt(0)
    v_pk_add_f32 v[208:209], v[208:209], v[76:77]
    v_pk_add_f32 v[210:211], v[210:211], v[78:79]
    v_pk_add_f32 v[212:213], v[212:213], v[80:81]
    v_pk_add_f32 v[214:215], v[214:215], v[82:83]
    v_add_f32 v216, v216, v84
    v_min_f32 v66, v200, v216
    v_add_f32 v67, v200, v216
    v_cmp_nle_f32 s[68:69], s55, v66
    v_cmp_nge_f32 s[70:71], s93, v67
    v_mov_b32 v68, 0
    v_pk_fma_f32 v[70:71], v[192:193], v[68:69], v[68:69] op_sel_hi:[1,0,0]
    v_pk_fma_f32 v[70:71], v[194:195], v[68:69], v[70:71] op_sel_hi:[1,0,1]
    v_pk_fma_f32 v[70:71], v[196:197], v[68:69], v[70:71] op_sel_hi:[1,0,1]
    v_pk_fma_f32 v[70:71], v[198:199], v[68:69], v[70:71] op_sel_hi:[1,0,1]
    v_pk_fma_f32 v[70:71], v[208:209], v[68:69], v[70:71] op_sel_hi:[1,0,1]
    v_pk_fma_f32 v[70:71], v[210:211], v[68:69], v[70:71] op_sel_hi:[1,0,1]
    v_pk_fma_f32 v[70:71], v[212:213], v[68:69], v[70:71] op_sel_hi:[1,0,1]
    v_pk_fma_f32 v[70:71], v[214:215], v[68:69], v[70:71] op_sel_hi:[1,0,1]
    v_cmp_u_f32 vcc, v70, v71
    s_or_b64 s[68:69], s[68:69], s[70:71]
    s_or_b64 vcc, vcc, s[68:69]
    s_cbranch_vccnz L_fallback
L_norm:
    v_rcp_f32 v200, v200
    v_rcp_f32 v216, v216
    s_nop 0
    v_pk_mul_f32 v[192:193], v[192:193], v[200:201] op_sel_hi:[1,0]
    v_pk_mul_f32 v[194:195], v[194:195], v[200:201] op_sel_hi:[1,0]
    v_pk_mul_f32 v[196:197], v[196:197], v[200:201] op_sel_hi:[1,0]
    v_pk_mul_f32 v[198:199], v[198:199], v[200:201] op_sel_hi:[1,0]
    v_cvt_pk_bf16_f32 v64, v192, v193
    v_cvt_pk_bf16_f32 v65, v194, v195
    v_cvt_pk_bf16_f32 v66, v196, v197
    v_cvt_pk_bf16_f32 v67, v198, v199
    v_pk_mul_f32 v[208:209], v[208:209], v[216:217] op_sel_hi:[1,0]
    v_pk_mul_f32 v[210:211], v[210:211], v[216:217] op_sel_hi:[1,0]
    v_pk_mul_f32 v[212:213], v[212:213], v[216:217] op_sel_hi:[1,0]
    v_pk_mul_f32 v[214:215], v[214:215], v[216:217] op_sel_hi:[1,0]
    v_cvt_pk_bf16_f32 v68, v208, v209
    v_cvt_pk_bf16_f32 v69, v210, v211
    v_cvt_pk_bf16_f32 v70, v212, v213
    v_cvt_pk_bf16_f32 v71, v214, v215
    s_cmp_eq_u32 s48, 0
    s_cbranch_scc1 L_slow_28
    buffer_store_dwordx4 v[64:67], v8, s[4:7], s53 offen
    buffer_store_dwordx4 v[68:71], v8, s[4:7], s54 offen
L_st_29:
    s_mov_b32 s75, s52
    s_lshr_b32 s52, s45, 3
    s_lshl_b32 s3, s44, 2
    s_add_u32 s52, s52, s3
    s_lshl_b32 s62, s52, 1
    s_add_u32 s62, s62, s24
    s_lshl_b32 s63, s62, 1
    s_add_u32 s63, s63, s25
    s_lshl_b32 s52, s52, 7
    s_add_u32 s52, s52, 32768
    s_lshl_b32 s53, s63, 14
    s_lshl_b32 s3, s25, 13
    s_add_u32 s53, s53, s3
    s_add_u32 s53, s53, 9437184
    s_xor_b32 s54, s53, 16384
    s_lshl_b32 s65, s63, 14
    s_lshl_b32 s3, s27, 7
    s_add_u32 s65, s65, s3
    v_lshrrev_b32 v250, 4, v1
    v_lshlrev_b32 v250, 4, v250
    v_add_u32 v250, 162816, v250
    s_lshl_b32 s51, s46, 12
    s_add_u32 s51, s51, 145920
    v_add_u32 v251, s51, v2
    s_xor_b32 s51, s46, 2
    s_lshl_b32 s51, s51, 12
    s_add_u32 s51, s51, 145920
    v_add_u32 v252, s51, v2
    s_cmp_eq_u32 s48, 0
    s_cbranch_scc1 L_slow_30
    s_waitcnt vmcnt(0)
    buffer_store_dword v5, off, s[4:7], s75
L_st_31:
    v_accvgpr_read_b32 v16, a168
    v_accvgpr_read_b32 v17, a169
    v_accvgpr_read_b32 v18, a170
    v_accvgpr_read_b32 v19, a171
    v_accvgpr_read_b32 v20, a172
    v_accvgpr_read_b32 v21, a173
    v_accvgpr_read_b32 v22, a174
    v_accvgpr_read_b32 v23, a175
    v_lshlrev_b32 v7, 1, v13
    s_mov_b32 s50, 0x80000
    v_xor_b32 v17, v5, v17
    v_xor_b32 v19, v5, v19
    v_xor_b32 v21, v5, v21
    v_xor_b32 v23, v5, v23
    v_or3_b32 v17, v17, v19, v21
    v_or_b32 v23, v23, v17
    v_cmp_ne_u32 vcc, 0, v23
    s_cbranch_vccnz L_retry_32
L_got_33:
    s_cmp_eq_u32 s46, 2
    s_cselect_b32 s57, 1.0, 0
    v_add_f32 v16, v16, v20
    v_add_f32 v18, v18, v22
    v_add_f32 v16, v16, v18
    s_lshl_b32 s59, s46, 8
    s_add_u32 s59, s59, 162816
    v_add_u32 v7, s59, v13
    v_cvt_pk_bf16_f32 v16, v16, v16
    v_and_b32 v16, 0xffff0000, v16
    v_add_f32 v16, s57, v16
    v_cvt_pk_bf16_f32 v16, v16, v16
    v_and_b32 v16, 0xffff0000, v16
    ds_write_b32 v7, v16
    v_accvgpr_read_b32 v32, a176
    v_accvgpr_read_b32 v33, a177
    v_accvgpr_read_b32 v34, a178
    v_accvgpr_read_b32 v35, a179
    v_accvgpr_read_b32 v36, a180
    v_accvgpr_read_b32 v37, a181
    v_accvgpr_read_b32 v38, a182
    v_accvgpr_read_b32 v39, a183
    v_lshlrev_b32 v144, 16, v32
    v_and_b32 v145, 0xffff0000, v32
    v_lshlrev_b32 v146, 16, v33
    v_and_b32 v147, 0xffff0000, v33
    v_lshlrev_b32 v148, 16, v34
    v_and_b32 v149, 0xffff0000, v34
    v_lshlrev_b32 v150, 16, v35
    v_and_b32 v151, 0xffff0000, v35
    v_lshlrev_b32 v152, 16, v36
    v_and_b32 v153, 0xffff0000, v36
    v_lshlrev_b32 v154, 16, v37
    v_and_b32 v155, 0xffff0000, v37
    v_lshlrev_b32 v156, 16, v38
    v_and_b32 v157, 0xffff0000, v38
    v_lshlrev_b32 v158, 16, v39
    v_and_b32 v159, 0xffff0000, v39
L_phaseD:
    s_waitcnt lgkmcnt(0)
    s_barrier
    ds_read_b128 v[40:43], v250 offset:0
    ds_read_b128 v[44:47], v250 offset:64
    ds_read_b128 v[48:51], v250 offset:128
    ds_read_b128 v[52:55], v250 offset:192
    ds_read_b128 v[160:163], v250 offset:256
    ds_read_b128 v[164:167], v250 offset:320
    ds_read_b128 v[168:171], v250 offset:384
    ds_read_b128 v[172:175], v250 offset:448
    ds_read_b128 v[176:179], v250 offset:512
    ds_read_b128 v[180:183], v250 offset:576
    ds_read_b128 v[184:187], v250 offset:640
    ds_read_b128 v[188:191], v250 offset:704
    s_mov_b32 s50, 0x80000
L_retry_34:
    buffer_load_dword v6, v10, s[4:7], s52 offen sc1
    s_sub_u32 s50, s50, 1
    s_waitcnt vmcnt(0)
    v_cmp_ne_u32 vcc, s47, v6
    s_cbranch_scc1 L_got_35
    s_cbranch_vccnz L_retry_34
L_got_35:
    buffer_load_dwordx4 v[68:71], v2, s[4:7], s54 offen offset:0 sc1
    buffer_load_dwordx4 v[64:67], v2, s[4:7], s53 offen offset:0 sc1
    buffer_load_dwordx4 v[76:79], v2, s[4:7], s54 offen offset:1024 sc1
    buffer_load_dwordx4 v[72:75], v2, s[4:7], s53 offen offset:1024 sc1
    buffer_load_dwordx4 v[84:87], v2, s[4:7], s54 offen offset:2048 sc1
    buffer_load_dwordx4 v[80:83], v2, s[4:7], s53 offen offset:2048 sc1
    buffer_load_dwordx4 v[92:95], v2, s[4:7], s54 offen offset:3072 sc1
    buffer_load_dwordx4 v[88:91], v2, s[4:7], s53 offen offset:3072 sc1
    s_add_u32 s54, s54, 4096
    buffer_load_dwordx4 v[100:103], v2, s[4:7], s54 offen offset:0 sc1
    s_add_u32 s53, s53, 4096
    buffer_load_dwordx4 v[96:99], v2, s[4:7], s53 offen offset:0 sc1
    s_waitcnt vmcnt(9)
    v_mfma_f32_16x16x32_bf16 v[128:131], a[0:3], v[68:71], 0
    buffer_load_dwordx4 v[108:111], v2, s[4:7], s54 offen offset:1024 sc1
    v_mfma_f32_16x16x32_bf16 v[132:135], a[4:7], v[68:71], 0
    s_lshl_b32 s52, s63, 11
    v_mfma_f32_16x16x32_bf16 v[136:139], a[8:11], v[68:71], 0
    v_mfma_f32_16x16x32_bf16 v[140:143], a[12:15], v[68:71], 0
    s_add_u32 s52, s52, 524288
    s_waitcnt vmcnt(9)
    v_mfma_f32_16x16x32_bf16 v[16:19], a[0:3], v[64:67], 0
    buffer_load_dwordx4 v[104:107], v2, s[4:7], s53 offen offset:1024 sc1
    v_mfma_f32_16x16x32_bf16 v[20:23], a[4:7], v[64:67], 0
    s_mov_b32 s56, s52
    v_mfma_f32_16x16x32_bf16 v[24:27], a[8:11], v[64:67], 0
    v_mfma_f32_16x16x32_bf16 v[28:31], a[12:15], v[64:67], 0
    s_lshl_b32 s3, s27, 8
    s_waitcnt vmcnt(9)
    v_mfma_f32_16x16x32_bf16 v[128:131], a[16:19], v[76:79], v[128:131]
    buffer_load_dwordx4 v[116:119], v2, s[4:7], s54 offen offset:2048 sc1
    v_mfma_f32_16x16x32_bf16 v[132:135], a[20:23], v[76:79], v[132:135]
    s_add_u32 s56, s56, s3
    v_mfma_f32_16x16x32_bf16 v[136:139], a[24:27], v[76:79], v[136:139]
    v_mfma_f32_16x16x32_bf16 v[140:143], a[28:31], v[76:79], v[140:143]
    s_lshl_b32 s58, s62, 7
    s_waitcnt vmcnt(9)
    v_mfma_f32_16x16x32_bf16 v[16:19], a[16:19], v[72:75], v[16:19]
    buffer_load_dwordx4 v[112:115], v2, s[4:7], s53 offen offset:2048 sc1
    v_mfma_f32_16x16x32_bf16 v[20:23], a[20:23], v[72:75], v[20:23]
    s_lshl_b32 s3, s25, 5
    v_mfma_f32_16x16x32_bf16 v[24:27], a[24:27], v[72:75], v[24:27]
    v_mfma_f32_16x16x32_bf16 v[28:31], a[28:31], v[72:75], v[28:31]
    s_add_u32 s58, s58, s3
    s_waitcnt vmcnt(9)
    v_mfma_f32_16x16x32_bf16 v[128:131], a[32:35], v[84:87], v[128:131]
    buffer_load_dwordx4 v[124:127], v2, s[4:7], s54 offen offset:3072 sc1
    v_mfma_f32_16x16x32_bf16 v[132:135], a[36:39], v[84:87], v[132:135]
    s_lshl_b32 s3, s27, 2
    v_mfma_f32_16x16x32_bf16 v[136:139], a[40:43], v[84:87], v[136:139]
    v_mfma_f32_16x16x32_bf16 v[140:143], a[44:47], v[84:87], v[140:143]
    s_add_u32 s58, s58, s3
    s_waitcnt vmcnt(9)
    v_mfma_f32_16x16x32_bf16 v[16:19], a[32:35], v[80:83], v[16:19]
    buffer_load_dwordx4 v[120:123], v2, s[4:7], s53 offen offset:3072 sc1
    v_mfma_f32_16x16x32_bf16 v[20:23], a[36:39], v[80:83], v[20:23]
    s_add_u32 s58, s58, 49152
    v_mfma_f32_16x16x32_bf16 v[24:27], a[40:43], v[80:83], v[24:27]
    v_mfma_f32_16x16x32_bf16 v[28:31], a[44:47], v[80:83], v[28:31]
    s_lshl_b32 s57, s63, 14
    s_waitcnt vmcnt(9)
    v_mfma_f32_16x16x32_bf16 v[128:131], a[48:51], v[92:95], v[128:131]
    v_mfma_f32_16x16x32_bf16 v[132:135], a[52:55], v[92:95], v[132:135]
    s_lshl_b32 s3, s27, 11
    v_mfma_f32_16x16x32_bf16 v[136:139], a[56:59], v[92:95], v[136:139]
    v_mfma_f32_16x16x32_bf16 v[140:143], a[60:63], v[92:95], v[140:143]
    s_add_u32 s57, s57, s3
    s_waitcnt vmcnt(8)
    v_mfma_f32_16x16x32_bf16 v[16:19], a[48:51], v[88:91], v[16:19]
    v_mfma_f32_16x16x32_bf16 v[20:23], a[52:55], v[88:91], v[20:23]
    s_add_u32 s57, s57, 9437184
    v_mfma_f32_16x16x32_bf16 v[24:27], a[56:59], v[88:91], v[24:27]
    v_mfma_f32_16x16x32_bf16 v[28:31], a[60:63], v[88:91], v[28:31]
    v_and_b32 v7, 15, v1
    s_waitcnt vmcnt(7)
    v_mfma_f32_16x16x32_bf16 v[128:131], a[64:67], v[100:103], v[128:131]
    v_mfma_f32_16x16x32_bf16 v[132:135], a[68:71], v[100:103], v[132:135]
    v_lshlrev_b32 v7, 4, v7
    v_mfma_f32_16x16x32_bf16 v[136:139], a[72:75], v[100:103], v[136:139]
    v_mfma_f32_16x16x32_bf16 v[140:143], a[76:79], v[100:103], v[140:143]
    v_bfe_u32 v6, v1, 4, 1
    s_waitcnt vmcnt(6)
    v_mfma_f32_16x16x32_bf16 v[16:19], a[64:67], v[96:99], v[16:19]
    v_mfma_f32_16x16x32_bf16 v[20:23], a[68:71], v[96:99], v[20:23]
    v_lshl_add_u32 v7, v6, 3, v7
    v_mfma_f32_16x16x32_bf16 v[24:27], a[72:75], v[96:99], v[24:27]
    v_mfma_f32_16x16x32_bf16 v[28:31], a[76:79], v[96:99], v[28:31]
    v_and_b32 v8, 15, v1
    s_waitcnt vmcnt(5)
    v_mfma_f32_16x16x32_bf16 v[128:131], a[80:83], v[108:111], v[128:131]
    s_add_u32 m0, s66, 87552
    s_add_u32 s51, s67, 688128
    v_mfma_f32_16x16x32_bf16 v[132:135], a[84:87], v[108:111], v[132:135]
    v_lshlrev_b32 v8, 4, v8
    v_mfma_f32_16x16x32_bf16 v[136:139], a[88:91], v[108:111], v[136:139]
    buffer_load_dwordx4 v240, s[20:23], s51 offen offset:0 lds
    v_mfma_f32_16x16x32_bf16 v[140:143], a[92:95], v[108:111], v[140:143]
    v_lshrrev_b32 v6, 4, v1
    s_waitcnt vmcnt(5)
    v_mfma_f32_16x16x32_bf16 v[16:19], a[80:83], v[104:107], v[16:19]
    buffer_load_dwordx4 v241, s[20:23], s51 offen offset:1024 lds
    v_mfma_f32_16x16x32_bf16 v[20:23], a[84:87], v[104:107], v[20:23]
    v_lshl_add_u32 v8, v6, 9, v8
    v_mfma_f32_16x16x32_bf16 v[24:27], a[88:91], v[104:107], v[24:27]
    buffer_load_dwordx4 v242, s[20:23], s51 offen offset:2048 lds
    v_mfma_f32_16x16x32_bf16 v[28:31], a[92:95], v[104:107], v[28:31]
    s_waitcnt vmcnt(6)
    v_mfma_f32_16x16x32_bf16 v[128:131], a[96:99], v[116:119], v[128:131]
    buffer_load_dwordx4 v243, s[20:23], s51 offen offset:3072 lds
    v_mfma_f32_16x16x32_bf16 v[132:135], a[100:103], v[116:119], v[132:135]
    v_mfma_f32_16x16x32_bf16 v[136:139], a[104:107], v[116:119], v[136:139]
    s_add_u32 m0, s66, 91648
    s_nop 0
    v_mfma_f32_16x16x32_bf16 v[140:143], a[108:111], v[116:119], v[140:143]
    s_waitcnt vmcnt(6)
    v_mfma_f32_16x16x32_bf16 v[16:19], a[96:99], v[112:115], v[16:19]
    buffer_load_dwordx4 v244, s[20:23], s51 offen offset:0 lds
    v_mfma_f32_16x16x32_bf16 v[20:23], a[100:103], v[112:115], v[20:23]
    v_mfma_f32_16x16x32_bf16 v[24:27], a[104:107], v[112:115], v[24:27]
    buffer_load_dwordx4 v245, s[20:23], s51 offen offset:1024 lds
    v_mfma_f32_16x16x32_bf16 v[28:31], a[108:111], v[112:115], v[28:31]
    s_waitcnt vmcnt(7)
    v_mfma_f32_16x16x32_bf16 v[128:131], a[112:115], v[124:127], v[128:131]
    buffer_load_dwordx4 v246, s[20:23], s51 offen offset:2048 lds
    v_mfma_f32_16x16x32_bf16 v[132:135], a[116:119], v[124:127], v[132:135]
    v_mfma_f32_16x16x32_bf16 v[136:139], a[120:123], v[124:127], v[136:139]
    v_mfma_f32_16x16x32_bf16 v[140:143], a[124:127], v[124:127], v[140:143]
    s_waitcnt vmcnt(7)
    v_mfma_f32_16x16x32_bf16 v[16:19], a[112:115], v[120:123], v[16:19]
    v_mfma_f32_16x16x32_bf16 v[20:23], a[116:119], v[120:123], v[20:23]
    v_mfma_f32_16x16x32_bf16 v[24:27], a[120:123], v[120:123], v[24:27]
    v_mfma_f32_16x16x32_bf16 v[28:31], a[124:127], v[120:123], v[28:31]
    s_nop 1
    ds_write_b128 v252, v[128:131] offset:0
    ds_write_b128 v252, v[132:135] offset:1024
    ds_write_b128 v252, v[136:139] offset:2048
    ds_write_b128 v252, v[140:143] offset:3072
    s_waitcnt lgkmcnt(0)
    s_barrier
    ds_read_b128 v[128:131], v251 offset:0
    ds_read_b128 v[132:135], v251 offset:1024
    ds_read_b128 v[136:139], v251 offset:2048
    ds_read_b128 v[140:143], v251 offset:3072
    s_waitcnt lgkmcnt(3)
    v_pk_add_f32 v[16:17], v[16:17], v[128:129]
    v_pk_add_f32 v[18:19], v[18:19], v[130:131]
    v_pk_fma_f32 v[16:17], v[16:17], v[40:41], v[144:145]
    v_pk_fma_f32 v[18:19], v[18:19], v[42:43], v[146:147]
    v_pk_mul_f32 v[34:35], v[16:17], v[16:17]
    v_pk_fma_f32 v[34:35], v[18:19], v[18:19], v[34:35]
    v_pk_add_f32 v[32:33], v[16:17], v[18:19]
    s_waitcnt lgkmcnt(2)
    v_pk_add_f32 v[20:21], v[20:21], v[132:133]
    v_pk_add_f32 v[22:23], v[22:23], v[134:135]
    v_pk_fma_f32 v[20:21], v[20:21], v[44:45], v[148:149]
    v_pk_fma_f32 v[22:23], v[22:23], v[46:47], v[150:151]
    v_pk_fma_f32 v[34:35], v[20:21], v[20:21], v[34:35]
    v_pk_add_f32 v[32:33], v[32:33], v[20:21]
    v_pk_fma_f32 v[34:35], v[22:23], v[22:23], v[34:35]
    v_pk_add_f32 v[32:33], v[32:33], v[22:23]
    s_waitcnt lgkmcnt(1)
    v_pk_add_f32 v[24:25], v[24:25], v[136:137]
    v_pk_add_f32 v[26:27], v[26:27], v[138:139]
    v_pk_fma_f32 v[24:25], v[24:25], v[48:49], v[152:153]
    v_pk_fma_f32 v[26:27], v[26:27], v[50:51], v[154:155]
    v_pk_fma_f32 v[34:35], v[24:25], v[24:25], v[34:35]
    v_pk_add_f32 v[32:33], v[32:33], v[24:25]
    v_pk_fma_f32 v[34:35], v[26:27], v[26:27], v[34:35]
    v_pk_add_f32 v[32:33], v[32:33], v[26:27]
    s_waitcnt lgkmcnt(0)
    v_pk_add_f32 v[28:29], v[28:29], v[140:141]
    v_pk_add_f32 v[30:31], v[30:31], v[142:143]
    v_pk_fma_f32 v[28:29], v[28:29], v[52:53], v[156:157]
    v_pk_fma_f32 v[30:31], v[30:31], v[54:55], v[158:159]
    v_pk_fma_f32 v[34:35], v[28:29], v[28:29], v[34:35]
    v_pk_add_f32 v[32:33], v[32:33], v[28:29]
    v_pk_fma_f32 v[34:35], v[30:31], v[30:31], v[34:35]
    v_pk_add_f32 v[32:33], v[32:33], v[30:31]
    v_add_f32 v32, v32, v33
    v_add_f32 v34, v34, v35
    v_mov_b32 v33, v5
    s_nop 0
    v_permlane16_swap_b32 v32, v34
    v_add_f32 v32, v32, v34
    v_mov_b32 v34, v32
    s_nop 1
    v_permlane32_swap_b32 v32, v34
    v_add_f32 v32, v32, v34
    s_cmp_eq_u32 s48, 0
    s_cbranch_scc1 L_slow_36
    buffer_store_dwordx2 v[32:33], v7, s[4:7], s56 offen
L_st_37:
    v_cvt_pk_bf16_f32 v232, v16, v17
    v_cvt_pk_bf16_f32 v233, v18, v19
    v_cvt_pk_bf16_f32 v234, v20, v21
    v_cvt_pk_bf16_f32 v235, v22, v23
    v_cvt_pk_bf16_f32 v236, v24, v25
    v_cvt_pk_bf16_f32 v237, v26, v27
    v_cvt_pk_bf16_f32 v238, v28, v29
    v_cvt_pk_bf16_f32 v239, v30, v31
    s_mov_b32 s50, 0x80000
L_retry_38:
    buffer_load_dwordx4 v[64:67], v8, s[4:7], s52 offen offset:0 sc1
    buffer_load_dwordx4 v[68:71], v8, s[4:7], s52 offen offset:256 sc1
    s_sub_u32 s50, s50, 1
    s_waitcnt vmcnt(0)
    v_xor_b32 v65, v5, v65
    v_xor_b32 v67, v5, v67
    v_xor_b32 v69, v5, v69
    v_xor_b32 v71, v5, v71
    v_or3_b32 v65, v65, v67, v69
    v_or_b32 v71, v71, v65
    v_cmp_ne_u32 vcc, 0, v71
    s_cbranch_scc1 L_got_39
    s_cbranch_vccnz L_retry_38
L_got_39:
    v_add_f32 v32, v64, v68
    v_add_f32 v33, v66, v70
    v_mov_b32 v34, v32
    v_mov_b32 v35, v33
    s_nop 0
    v_permlane16_swap_b32 v32, v34
    v_permlane16_swap_b32 v33, v35
    v_pk_add_f32 v[32:33], v[32:33], v[34:35]
    v_mov_b32 v34, v32
    v_mov_b32 v35, v33
    s_nop 0
    v_permlane32_swap_b32 v32, v34
    v_permlane32_swap_b32 v33, v35
    v_pk_add_f32 v[32:33], v[32:33], v[34:35]
    v_mul_f32 v32, 0x3b000000, v32
    v_mul_f32 v33, 0x3b000000, v33
    v_fma_f32 v34, -v32, v32, v33
    v_max_f32 v34, 0, v34
    v_cvt_pk_bf16_f32 v32, v32, v32
    v_and_b32 v32, 0xffff0000, v32
    v_cvt_pk_bf16_f32 v34, v34, v34
    v_and_b32 v34, 0xffff0000, v34
    v_add_f32 v34, 0x3727c5ac, v34
    v_cvt_pk_bf16_f32 v34, v34, v34
    v_and_b32 v34, 0xffff0000, v34
    v_sqrt_f32 v34, v34
    s_nop 0
    v_cvt_pk_bf16_f32 v34, v34, v34
    v_and_b32 v34, 0xffff0000, v34
    v_rcp_f32 v34, v34
    s_nop 0
    v_mul_f32 v32, v32, v34
    v_pk_fma_f32 v[16:17], v[16:17], v[34:35], v[32:33] op_sel_hi:[1,0,0] neg_lo:[0,0,1] neg_hi:[0,0,1]
    v_pk_fma_f32 v[18:19], v[18:19], v[34:35], v[32:33] op_sel_hi:[1,0,0] neg_lo:[0,0,1] neg_hi:[0,0,1]
    v_pk_fma_f32 v[20:21], v[20:21], v[34:35], v[32:33] op_sel_hi:[1,0,0] neg_lo:[0,0,1] neg_hi:[0,0,1]
    v_pk_fma_f32 v[22:23], v[22:23], v[34:35], v[32:33] op_sel_hi:[1,0,0] neg_lo:[0,0,1] neg_hi:[0,0,1]
    v_pk_fma_f32 v[24:25], v[24:25], v[34:35], v[32:33] op_sel_hi:[1,0,0] neg_lo:[0,0,1] neg_hi:[0,0,1]
    v_pk_fma_f32 v[26:27], v[26:27], v[34:35], v[32:33] op_sel_hi:[1,0,0] neg_lo:[0,0,1] neg_hi:[0,0,1]
    v_pk_fma_f32 v[28:29], v[28:29], v[34:35], v[32:33] op_sel_hi:[1,0,0] neg_lo:[0,0,1] neg_hi:[0,0,1]
    v_pk_fma_f32 v[30:31], v[30:31], v[34:35], v[32:33] op_sel_hi:[1,0,0] neg_lo:[0,0,1] neg_hi:[0,0,1]
    v_pk_fma_f32 v[16:17], v[16:17], v[176:177], v[160:161]
    v_pk_fma_f32 v[18:19], v[18:19], v[178:179], v[162:163]
    v_pk_fma_f32 v[20:21], v[20:21], v[180:181], v[164:165]
    v_pk_fma_f32 v[22:23], v[22:23], v[182:183], v[166:167]
    v_pk_fma_f32 v[24:25], v[24:25], v[184:185], v[168:169]
    v_pk_fma_f32 v[26:27], v[26:27], v[186:187], v[170:171]
    v_pk_fma_f32 v[28:29], v[28:29], v[188:189], v[172:173]
    v_pk_fma_f32 v[30:31], v[30:31], v[190:191], v[174:175]
    v_cvt_pk_bf16_f32 v40, v16, v17
    v_cvt_pk_bf16_f32 v41, v18, v19
    v_cvt_pk_bf16_f32 v42, v20, v21
    v_cvt_pk_bf16_f32 v43, v22, v23
    v_cvt_pk_bf16_f32 v44, v24, v25
    v_cvt_pk_bf16_f32 v45, v26, v27
    v_cvt_pk_bf16_f32 v46, v28, v29
    v_cvt_pk_bf16_f32 v47, v30, v31
    s_cmp_eq_u32 s48, 0
    s_cbranch_scc1 L_slow_40
    buffer_store_dwordx4 v[40:43], v2, s[4:7], s57 offen
    buffer_store_dwordx4 v[44:47], v2, s[4:7], s57 offen offset:1024
L_st_41:
    s_lshl_b32 s52, s64, 7
    s_add_u32 s52, s52, 49152
    s_lshl_b32 s53, s64, 15
    s_add_u32 s53, s53, 9437184
    s_add_u32 s54, s53, 16384
    s_and_b32 s55, s45, 1
    s_lshl_b32 s51, s55, 5
    v_lshrrev_b32 v251, 2, v1
    v_mul_u32_u24 v251, 224, v251
    v_and_b32 v6, 3, v1
    v_lshl_add_u32 v251, v6, 3, v251
    v_add_u32 v251, s51, v251
    v_add_u32 v252, 58368, v251
    v_add_u32 v253, 116736, v251
    s_mul_i32 s51, s55, 224
    v_subrev_u32 v220, s51, v251
    v_subrev_u32 v221, s51, v252
    v_subrev_u32 v222, s51, v253
    s_lshl_b32 s74, s46, 12
    s_mul_i32 s75, s46, 458752
    v_add_u32 v208, s74, v4
    v_xor_b32 v209, 32, v208
    v_xor_b32 v210, 64, v208
    v_xor_b32 v211, 96, v208
    v_add_u32 v212, 65536, v208
    v_add_u32 v213, 65536, v209
    v_add_u32 v214, 65536, v210
    v_add_u32 v215, 65536, v211
    v_add_u32 v216, 131072, v208
    v_add_u32 v217, 131072, v209
    v_add_u32 v218, 131072, v210
    v_add_u32 v219, 131072, v211
    s_cmp_eq_u32 s48, 0
    s_cbranch_scc1 L_slow_42
    s_waitcnt vmcnt(0)
    buffer_store_dword v5, off, s[4:7], s58
L_st_43:
    s_mov_b32 s50, 0x80000
L_retry_44:
    buffer_load_dword v6, v11, s[4:7], s52 offen sc1
    s_sub_u32 s50, s50, 1
    s_waitcnt vmcnt(0)
    v_cmp_ne_u32 vcc, s47, v6
    s_cbranch_scc1 L_got_45
    s_cbranch_vccnz L_retry_44
L_got_45:
    buffer_load_dwordx4 a[0:3], v2, s[4:7], s53 offen offset:0 sc1
    buffer_load_dwordx4 a[4:7], v2, s[4:7], s54 offen offset:0 sc1
    buffer_load_dwordx4 a[8:11], v2, s[4:7], s53 offen offset:1024 sc1
    buffer_load_dwordx4 a[12:15], v2, s[4:7], s54 offen offset:1024 sc1
    buffer_load_dwordx4 a[16:19], v2, s[4:7], s53 offen offset:2048 sc1
    buffer_load_dwordx4 a[20:23], v2, s[4:7], s54 offen offset:2048 sc1
    s_barrier
    ds_read_b64_tr_b16 v[176:177], v251 offset:0
    ds_read_b64_tr_b16 v[178:179], v251 offset:3584
    ds_read_b64_tr_b16 v[180:181], v251 offset:14592
    ds_read_b64_tr_b16 v[182:183], v251 offset:18176
    ds_read_b64_tr_b16 v[184:185], v251 offset:7296
    ds_read_b64_tr_b16 v[186:187], v251 offset:10880
    ds_read_b64_tr_b16 v[188:189], v251 offset:21888
    ds_read_b64_tr_b16 v[190:191], v251 offset:25472
    ds_read_b64_tr_b16 v[192:193], v251 offset:32
    ds_read_b64_tr_b16 v[194:195], v251 offset:3616
    ds_read_b64_tr_b16 v[196:197], v251 offset:14624
    ds_read_b64_tr_b16 v[198:199], v251 offset:18208
    s_mul_i32 s55, s45, 57344
    s_mul_i32 s3, s46, 14336
    s_add_u32 s55, s55, s3
    s_add_u32 s55, s55, 384
    v_min_u32 v8, 13, v1
    v_lshlrev_b32 v8, 10, v8
    s_waitcnt vmcnt(2) lgkmcnt(8)
    v_mfma_f32_16x16x32_bf16 v[64:67], v[176:179], a[0:3], 0
    ds_read_b64_tr_b16 v[200:201], v251 offset:7328
    v_mfma_f32_16x16x32_bf16 v[64:67], v[180:183], a[8:11], v[64:67]
    ds_read_b64_tr_b16 v[202:203], v251 offset:10912
    buffer_load_dwordx4 a[24:27], v2, s[4:7], s53 offen offset:3072 sc1
    v_mfma_f32_16x16x32_bf16 v[68:71], v[176:179], a[4:7], 0
    ds_read_b64_tr_b16 v[204:205], v251 offset:21920
    v_mfma_f32_16x16x32_bf16 v[68:71], v[180:183], a[12:15], v[68:71]
    ds_read_b64_tr_b16 v[206:207], v251 offset:25504
    s_waitcnt lgkmcnt(8)
    v_mfma_f32_16x16x32_bf16 v[72:75], v[184:187], a[0:3], 0
    ds_read_b64_tr_b16 v[176:177], v251 offset:64
    v_mfma_f32_16x16x32_bf16 v[72:75], v[188:191], a[8:11], v[72:75]
    ds_read_b64_tr_b16 v[178:179], v251 offset:3648
    buffer_load_dwordx4 a[28:31], v2, s[4:7], s54 offen offset:3072 sc1
    v_mfma_f32_16x16x32_bf16 v[76:79], v[184:187], a[4:7], 0
    ds_read_b64_tr_b16 v[180:181], v251 offset:14656
    v_mfma_f32_16x16x32_bf16 v[76:79], v[188:191], a[12:15], v[76:79]
    ds_read_b64_tr_b16 v[182:183], v251 offset:18240
    s_waitcnt lgkmcnt(8)
    v_mfma_f32_16x16x32_bf16 v[80:83], v[192:195], a[0:3], 0
    ds_read_b64_tr_b16 v[184:185], v251 offset:7360
    v_mfma_f32_16x16x32_bf16 v[80:83], v[196:199], a[8:11], v[80:83]
    ds_read_b64_tr_b16 v[186:187], v251 offset:10944
    s_add_u32 s53, s53, 4096
    buffer_load_dwordx4 a[32:35], v2, s[4:7], s53 offen offset:0 sc1
    v_mfma_f32_16x16x32_bf16 v[84:87], v[192:195], a[4:7], 0
    ds_read_b64_tr_b16 v[188:189], v251 offset:21952
    v_mfma_f32_16x16x32_bf16 v[84:87], v[196:199], a[12:15], v[84:87]
    ds_read_b64_tr_b16 v[190:191], v251 offset:25536
    s_waitcnt lgkmcnt(8)
    v_mfma_f32_16x16x32_bf16 v[88:91], v[200:203], a[0:3], 0
    ds_read_b64_tr_b16 v[192:193], v251 offset:96
    v_mfma_f32_16x16x32_bf16 v[88:91], v[204:207], a[8:11], v[88:91]
    ds_read_b64_tr_b16 v[194:195], v251 offset:3680
    s_add_u32 s54, s54, 4096
    buffer_load_dwordx4 a[36:39], v2, s[4:7], s54 offen offset:0 sc1
    v_mfma_f32_16x16x32_bf16 v[92:95], v[200:203], a[4:7], 0
    ds_read_b64_tr_b16 v[196:197], v251 offset:14688
    v_mfma_f32_16x16x32_bf16 v[92:95], v[204:207], a[12:15], v[92:95]
    ds_read_b64_tr_b16 v[198:199], v251 offset:18272
    s_waitcnt lgkmcnt(8)
    v_mfma_f32_16x16x32_bf16 v[96:99], v[176:179], a[0:3], 0
    ds_read_b64_tr_b16 v[200:201], v251 offset:7392
    v_mfma_f32_16x16x32_bf16 v[96:99], v[180:183], a[8:11], v[96:99]
    ds_read_b64_tr_b16 v[202:203], v251 offset:10976
    v_mfma_f32_16x16x32_bf16 v[100:103], v[176:179], a[4:7], 0
    ds_read_b64_tr_b16 v[204:205], v251 offset:21984
    v_mfma_f32_16x16x32_bf16 v[100:103], v[180:183], a[12:15], v[100:103]
    ds_read_b64_tr_b16 v[206:207], v251 offset:25568
    buffer_load_dwordx4 a[40:43], v2, s[4:7], s53 offen offset:1024 sc1
    s_waitcnt lgkmcnt(8)
    v_mfma_f32_16x16x32_bf16 v[104:107], v[184:187], a[0:3], 0
    ds_read_b64_tr_b16 v[176:177], v251 offset:128
    v_mfma_f32_16x16x32_bf16 v[104:107], v[188:191], a[8:11], v[104:107]
    ds_read_b64_tr_b16 v[178:179], v251 offset:3712
    v_mfma_f32_16x16x32_bf16 v[108:111], v[184:187], a[4:7], 0
    ds_read_b64_tr_b16 v[180:181], v251 offset:14720
    v_mfma_f32_16x16x32_bf16 v[108:111], v[188:191], a[12:15], v[108:111]
    ds_read_b64_tr_b16 v[182:183], v251 offset:18304
    buffer_load_dwordx4 a[44:47], v2, s[4:7], s54 offen offset:1024 sc1
    s_waitcnt lgkmcnt(8)
    v_mfma_f32_16x16x32_bf16 v[112:115], v[192:195], a[0:3], 0
    ds_read_b64_tr_b16 v[184:185], v251 offset:7424
    v_mfma_f32_16x16x32_bf16 v[112:115], v[196:199], a[8:11], v[112:115]
    ds_read_b64_tr_b16 v[186:187], v251 offset:11008
    v_mfma_f32_16x16x32_bf16 v[116:119], v[192:195], a[4:7], 0
    ds_read_b64_tr_b16 v[188:189], v251 offset:22016
    v_mfma_f32_16x16x32_bf16 v[116:119], v[196:199], a[12:15], v[116:119]
    ds_read_b64_tr_b16 v[190:191], v251 offset:25600
    buffer_load_dwordx4 a[48:51], v2, s[4:7], s53 offen offset:2048 sc1
    s_waitcnt lgkmcnt(8)
    v_mfma_f32_16x16x32_bf16 v[120:123], v[200:203], a[0:3], 0
    ds_read_b64_tr_b16 v[192:193], v251 offset:160
    v_mfma_f32_16x16x32_bf16 v[120:123], v[204:207], a[8:11], v[120:123]
    ds_read_b64_tr_b16 v[194:195], v251 offset:3744
    v_mfma_f32_16x16x32_bf16 v[124:127], v[200:203], a[4:7], 0
    ds_read_b64_tr_b16 v[196:197], v251 offset:14752
    v_mfma_f32_16x16x32_bf16 v[124:127], v[204:207], a[12:15], v[124:127]
    ds_read_b64_tr_b16 v[198:199], v251 offset:18336
    s_waitcnt lgkmcnt(8)
    v_mfma_f32_16x16x32_bf16 v[128:131], v[176:179], a[0:3], 0
    ds_read_b64_tr_b16 v[200:201], v251 offset:7456
    v_mfma_f32_16x16x32_bf16 v[128:131], v[180:183], a[8:11], v[128:131]
    ds_read_b64_tr_b16 v[202:203], v251 offset:11040
    buffer_load_dwordx4 a[52:55], v2, s[4:7], s54 offen offset:2048 sc1
    v_mfma_f32_16x16x32_bf16 v[132:135], v[176:179], a[4:7], 0
    ds_read_b64_tr_b16 v[204:205], v251 offset:22048
    v_mfma_f32_16x16x32_bf16 v[132:135], v[180:183], a[12:15], v[132:135]
    ds_read_b64_tr_b16 v[206:207], v251 offset:25632
    s_add_u32 m0, s66, 116736
    s_add_u32 s51, s67, 917504
    s_waitcnt lgkmcnt(8)
    v_mfma_f32_16x16x32_bf16 v[136:139], v[184:187], a[0:3], 0
    ds_read_b64_tr_b16 v[176:177], v220 offset:192
    v_mfma_f32_16x16x32_bf16 v[136:139], v[188:191], a[8:11], v[136:139]
    ds_read_b64_tr_b16 v[178:179], v220 offset:3776
    buffer_load_dwordx4 a[56:59], v2, s[4:7], s53 offen offset:3072 sc1
    v_mfma_f32_16x16x32_bf16 v[140:143], v[184:187], a[4:7], 0
    ds_read_b64_tr_b16 v[180:181], v220 offset:14784
    v_mfma_f32_16x16x32_bf16 v[140:143], v[188:191], a[12:15], v[140:143]
    ds_read_b64_tr_b16 v[182:183], v220 offset:18368
    s_waitcnt lgkmcnt(8)
    v_mfma_f32_16x16x32_bf16 v[144:147], v[192:195], a[0:3], 0
    ds_read_b64_tr_b16 v[184:185], v220 offset:7488
    v_mfma_f32_16x16x32_bf16 v[144:147], v[196:199], a[8:11], v[144:147]
    ds_read_b64_tr_b16 v[186:187], v220 offset:11072
    buffer_load_dwordx4 a[60:63], v2, s[4:7], s54 offen offset:3072 sc1
    v_mfma_f32_16x16x32_bf16 v[148:151], v[192:195], a[4:7], 0
    ds_read_b64_tr_b16 v[188:189], v220 offset:22080
    v_mfma_f32_16x16x32_bf16 v[148:151], v[196:199], a[12:15], v[148:151]
    ds_read_b64_tr_b16 v[190:191], v220 offset:25664
    buffer_load_dwordx4 v240, s[20:23], s51 offen offset:0 lds
    s_waitcnt lgkmcnt(8)
    v_mfma_f32_16x16x32_bf16 v[152:155], v[200:203], a[0:3], 0
    ds_read_b64_tr_b16 v[192:193], v251 offset:29184
    v_mfma_f32_16x16x32_bf16 v[152:155], v[204:207], a[8:11], v[152:155]
    ds_read_b64_tr_b16 v[194:195], v251 offset:32768
    v_mfma_f32_16x16x32_bf16 v[156:159], v[200:203], a[4:7], 0
    ds_read_b64_tr_b16 v[196:197], v251 offset:43776
    v_mfma_f32_16x16x32_bf16 v[156:159], v[204:207], a[12:15], v[156:159]
    ds_read_b64_tr_b16 v[198:199], v251 offset:47360
    s_add_u32 s53, s53, 4096
    buffer_load_dwordx4 a[64:67], v2, s[4:7], s53 offen offset:0 sc1
    s_waitcnt lgkmcnt(8)
    v_mfma_f32_16x16x32_bf16 v[160:163], v[176:179], a[0:3], 0
    ds_read_b64_tr_b16 v[200:201], v251 offset:36480
    v_mfma_f32_16x16x32_bf16 v[160:163], v[180:183], a[8:11], v[160:163]
    ds_read_b64_tr_b16 v[202:203], v251 offset:40064
    buffer_load_dwordx4 v241, s[20:23], s51 offen offset:1024 lds
    v_mfma_f32_16x16x32_bf16 v[164:167], v[176:179], a[4:7], 0
    ds_read_b64_tr_b16 v[204:205], v251 offset:51072
    v_mfma_f32_16x16x32_bf16 v[164:167], v[180:183], a[12:15], v[164:167]
    ds_read_b64_tr_b16 v[206:207], v251 offset:54656
    s_add_u32 s54, s54, 4096
    buffer_load_dwordx4 a[68:71], v2, s[4:7], s54 offen offset:0 sc1
    s_waitcnt lgkmcnt(8)
    v_mfma_f32_16x16x32_bf16 v[168:171], v[184:187], a[0:3], 0
    ds_read_b64_tr_b16 v[176:177], v251 offset:29216
    v_mfma_f32_16x16x32_bf16 v[168:171], v[188:191], a[8:11], v[168:171]
    ds_read_b64_tr_b16 v[178:179], v251 offset:32800
    v_mfma_f32_16x16x32_bf16 v[172:175], v[184:187], a[4:7], 0
    ds_read_b64_tr_b16 v[180:181], v251 offset:43808
    v_mfma_f32_16x16x32_bf16 v[172:175], v[188:191], a[12:15], v[172:175]
    ds_read_b64_tr_b16 v[182:183], v251 offset:47392
    buffer_load_dwordx4 a[72:75], v2, s[4:7], s53 offen offset:1024 sc1
    s_waitcnt vmcnt(13) lgkmcnt(8)
    v_mfma_f32_16x16x32_bf16 v[64:67], v[192:195], a[16:19], v[64:67]
    ds_read_b64_tr_b16 v[184:185], v251 offset:36512
    v_mfma_f32_16x16x32_bf16 v[64:67], v[196:199], a[24:27], v[64:67]
    ds_read_b64_tr_b16 v[186:187], v251 offset:40096
    buffer_load_dwordx4 v242, s[20:23], s51 offen offset:2048 lds
    v_mfma_f32_16x16x32_bf16 v[68:71], v[192:195], a[20:23], v[68:71]
    ds_read_b64_tr_b16 v[188:189], v251 offset:51104
    v_mfma_f32_16x16x32_bf16 v[68:71], v[196:199], a[28:31], v[68:71]
    ds_read_b64_tr_b16 v[190:191], v251 offset:54688
    s_waitcnt lgkmcnt(8)
    v_mfma_f32_16x16x32_bf16 v[72:75], v[200:203], a[16:19], v[72:75]
    ds_read_b64_tr_b16 v[192:193], v251 offset:29248
    v_mfma_f32_16x16x32_bf16 v[72:75], v[204:207], a[24:27], v[72:75]
    ds_read_b64_tr_b16 v[194:195], v251 offset:32832
    buffer_load_dwordx4 a[76:79], v2, s[4:7], s54 offen offset:1024 sc1
    v_mfma_f32_16x16x32_bf16 v[76:79], v[200:203], a[20:23], v[76:79]
    ds_read_b64_tr_b16 v[196:197], v251 offset:43840
    v_mfma_f32_16x16x32_bf16 v[76:79], v[204:207], a[28:31], v[76:79]
    ds_read_b64_tr_b16 v[198:199], v251 offset:47424
    buffer_load_dwordx4 v243, s[20:23], s51 offen offset:3072 lds
    s_waitcnt lgkmcnt(8)
    v_mfma_f32_16x16x32_bf16 v[80:83], v[176:179], a[16:19], v[80:83]
    ds_read_b64_tr_b16 v[200:201], v251 offset:36544
    v_mfma_f32_16x16x32_bf16 v[80:83], v[180:183], a[24:27], v[80:83]
    ds_read_b64_tr_b16 v[202:203], v251 offset:40128
    buffer_load_dwordx4 a[80:83], v2, s[4:7], s53 offen offset:2048 sc1
    v_mfma_f32_16x16x32_bf16 v[84:87], v[176:179], a[20:23], v[84:87]
    ds_read_b64_tr_b16 v[204:205], v251 offset:51136
    v_mfma_f32_16x16x32_bf16 v[84:87], v[180:183], a[28:31], v[84:87]
    ds_read_b64_tr_b16 v[206:207], v251 offset:54720
    s_waitcnt lgkmcnt(8)
    v_mfma_f32_16x16x32_bf16 v[88:91], v[184:187], a[16:19], v[88:91]
    ds_read_b64_tr_b16 v[176:177], v251 offset:29280
    v_mfma_f32_16x16x32_bf16 v[88:91], v[188:191], a[24:27], v[88:91]
    ds_read_b64_tr_b16 v[178:179], v251 offset:32864
    buffer_load_dwordx4 a[84:87], v2, s[4:7], s54 offen offset:2048 sc1
    v_mfma_f32_16x16x32_bf16 v[92:95], v[184:187], a[20:23], v[92:95]
    ds_read_b64_tr_b16 v[180:181], v251 offset:43872
    v_mfma_f32_16x16x32_bf16 v[92:95], v[188:191], a[28:31], v[92:95]
    ds_read_b64_tr_b16 v[182:183], v251 offset:47456
    s_add_u32 m0, s66, 120832
    s_nop 0
    s_waitcnt lgkmcnt(8)
    v_mfma_f32_16x16x32_bf16 v[96:99], v[192:195], a[16:19], v[96:99]
    ds_read_b64_tr_b16 v[184:185], v251 offset:36576
    v_mfma_f32_16x16x32_bf16 v[96:99], v[196:199], a[24:27], v[96:99]
    ds_read_b64_tr_b16 v[186:187], v251 offset:40160
    buffer_load_dwordx4 a[88:91], v2, s[4:7], s53 offen offset:3072 sc1
    v_mfma_f32_16x16x32_bf16 v[100:103], v[192:195], a[20:23], v[100:103]
    ds_read_b64_tr_b16 v[188:189], v251 offset:51168
    v_mfma_f32_16x16x32_bf16 v[100:103], v[196:199], a[28:31], v[100:103]
    ds_read_b64_tr_b16 v[190:191], v251 offset:54752
    s_waitcnt lgkmcnt(8)
    v_mfma_f32_16x16x32_bf16 v[104:107], v[200:203], a[16:19], v[104:107]
    ds_read_b64_tr_b16 v[192:193], v251 offset:29312
    v_mfma_f32_16x16x32_bf16 v[104:107], v[204:207], a[24:27], v[104:107]
    ds_read_b64_tr_b16 v[194:195], v251 offset:32896
    buffer_load_dwordx4 v244, s[20:23], s51 offen offset:0 lds
    v_mfma_f32_16x16x32_bf16 v[108:111], v[200:203], a[20:23], v[108:111]
    ds_read_b64_tr_b16 v[196:197], v251 offset:43904
    v_mfma_f32_16x16x32_bf16 v[108:111], v[204:207], a[28:31], v[108:111]
    ds_read_b64_tr_b16 v[198:199], v251 offset:47488
    buffer_load_dwordx4 a[92:95], v2, s[4:7], s54 offen offset:3072 sc1
    s_waitcnt lgkmcnt(8)
    v_mfma_f32_16x16x32_bf16 v[112:115], v[176:179], a[16:19], v[112:115]
    ds_read_b64_tr_b16 v[200:201], v251 offset:36608
    v_mfma_f32_16x16x32_bf16 v[112:115], v[180:183], a[24:27], v[112:115]
    ds_read_b64_tr_b16 v[202:203], v251 offset:40192
    v_mfma_f32_16x16x32_bf16 v[116:119], v[176:179], a[20:23], v[116:119]
    ds_read_b64_tr_b16 v[204:205], v251 offset:51200
    v_mfma_f32_16x16x32_bf16 v[116:119], v[180:183], a[28:31], v[116:119]
    ds_read_b64_tr_b16 v[206:207], v251 offset:54784
    s_add_u32 s53, s53, 4096
    buffer_load_dwordx4 a[96:99], v2, s[4:7], s53 offen offset:0 sc1
    s_waitcnt lgkmcnt(8)
    v_mfma_f32_16x16x32_bf16 v[120:123], v[184:187], a[16:19], v[120:123]
    ds_read_b64_tr_b16 v[176:177], v251 offset:29344
    v_mfma_f32_16x16x32_bf16 v[120:123], v[188:191], a[24:27], v[120:123]
    ds_read_b64_tr_b16 v[178:179], v251 offset:32928
    buffer_load_dwordx4 v245, s[20:23], s51 offen offset:1024 lds
    v_mfma_f32_16x16x32_bf16 v[124:127], v[184:187], a[20:23], v[124:127]
    ds_read_b64_tr_b16 v[180:181], v251 offset:43936
    v_mfma_f32_16x16x32_bf16 v[124:127], v[188:191], a[28:31], v[124:127]
    ds_read_b64_tr_b16 v[182:183], v251 offset:47520
    s_add_u32 s54, s54, 4096
    buffer_load_dwordx4 a[100:103], v2, s[4:7], s54 offen offset:0 sc1
    s_waitcnt lgkmcnt(8)
    v_mfma_f32_16x16x32_bf16 v[128:131], v[192:195], a[16:19], v[128:131]
    ds_read_b64_tr_b16 v[184:185], v251 offset:36640
    v_mfma_f32_16x16x32_bf16 v[128:131], v[196:199], a[24:27], v[128:131]
    ds_read_b64_tr_b16 v[186:187], v251 offset:40224
    v_mfma_f32_16x16x32_bf16 v[132:135], v[192:195], a[20:23], v[132:135]
    ds_read_b64_tr_b16 v[188:189], v251 offset:51232
    v_mfma_f32_16x16x32_bf16 v[132:135], v[196:199], a[28:31], v[132:135]
    ds_read_b64_tr_b16 v[190:191], v251 offset:54816
    buffer_load_dwordx4 v246, s[20:23], s51 offen offset:2048 lds
    s_waitcnt lgkmcnt(8)
    v_mfma_f32_16x16x32_bf16 v[136:139], v[200:203], a[16:19], v[136:139]
    ds_read_b64_tr_b16 v[192:193], v220 offset:29376
    v_mfma_f32_16x16x32_bf16 v[136:139], v[204:207], a[24:27], v[136:139]
    ds_read_b64_tr_b16 v[194:195], v220 offset:32960
    buffer_load_dwordx4 a[104:107], v2, s[4:7], s53 offen offset:1024 sc1
    v_mfma_f32_16x16x32_bf16 v[140:143], v[200:203], a[20:23], v[140:143]
    ds_read_b64_tr_b16 v[196:197], v220 offset:43968
    v_mfma_f32_16x16x32_bf16 v[140:143], v[204:207], a[28:31], v[140:143]
    ds_read_b64_tr_b16 v[198:199], v220 offset:47552
    s_waitcnt lgkmcnt(8)
    v_mfma_f32_16x16x32_bf16 v[144:147], v[176:179], a[16:19], v[144:147]
    ds_read_b64_tr_b16 v[200:201], v220 offset:36672
    v_mfma_f32_16x16x32_bf16 v[144:147], v[180:183], a[24:27], v[144:147]
    ds_read_b64_tr_b16 v[202:203], v220 offset:40256
    buffer_load_dwordx4 a[108:111], v2, s[4:7], s54 offen offset:1024 sc1
    v_mfma_f32_16x16x32_bf16 v[148:151], v[176:179], a[20:23], v[148:151]
    ds_read_b64_tr_b16 v[204:205], v220 offset:51264
    v_mfma_f32_16x16x32_bf16 v[148:151], v[180:183], a[28:31], v[148:151]
    ds_read_b64_tr_b16 v[206:207], v220 offset:54848
    s_waitcnt lgkmcnt(8)
    v_mfma_f32_16x16x32_bf16 v[152:155], v[184:187], a[16:19], v[152:155]
    ds_read_b64_tr_b16 v[176:177], v252 offset:0
    v_mfma_f32_16x16x32_bf16 v[152:155], v[188:191], a[24:27], v[152:155]
    ds_read_b64_tr_b16 v[178:179], v252 offset:3584
    buffer_load_dwordx4 a[112:115], v2, s[4:7], s53 offen offset:2048 sc1
    v_mfma_f32_16x16x32_bf16 v[156:159], v[184:187], a[20:23], v[156:159]
    ds_read_b64_tr_b16 v[180:181], v252 offset:14592
    v_mfma_f32_16x16x32_bf16 v[156:159], v[188:191], a[28:31], v[156:159]
    ds_read_b64_tr_b16 v[182:183], v252 offset:18176
    s_waitcnt lgkmcnt(8)
    v_mfma_f32_16x16x32_bf16 v[160:163], v[192:195], a[16:19], v[160:163]
    ds_read_b64_tr_b16 v[184:185], v252 offset:7296
    v_mfma_f32_16x16x32_bf16 v[160:163], v[196:199], a[24:27], v[160:163]
    ds_read_b64_tr_b16 v[186:187], v252 offset:10880
    v_mfma_f32_16x16x32_bf16 v[164:167], v[192:195], a[20:23], v[164:167]
    ds_read_b64_tr_b16 v[188:189], v252 offset:21888
    v_mfma_f32_16x16x32_bf16 v[164:167], v[196:199], a[28:31], v[164:167]
    ds_read_b64_tr_b16 v[190:191], v252 offset:25472
    buffer_load_dwordx4 a[116:119], v2, s[4:7], s54 offen offset:2048 sc1
    s_waitcnt lgkmcnt(8)
    v_mfma_f32_16x16x32_bf16 v[168:171], v[200:203], a[16:19], v[168:171]
    ds_read_b64_tr_b16 v[192:193], v252 offset:32
    v_mfma_f32_16x16x32_bf16 v[168:171], v[204:207], a[24:27], v[168:171]
    ds_read_b64_tr_b16 v[194:195], v252 offset:3616
    v_mfma_f32_16x16x32_bf16 v[172:175], v[200:203], a[20:23], v[172:175]
    ds_read_b64_tr_b16 v[196:197], v252 offset:14624
    v_mfma_f32_16x16x32_bf16 v[172:175], v[204:207], a[28:31], v[172:175]
    ds_read_b64_tr_b16 v[198:199], v252 offset:18208
    buffer_load_dwordx4 a[120:123], v2, s[4:7], s53 offen offset:3072 sc1
    s_waitcnt vmcnt(26) lgkmcnt(8)
    v_mfma_f32_16x16x32_bf16 v[64:67], v[176:179], a[32:35], v[64:67]
    ds_read_b64_tr_b16 v[200:201], v252 offset:7328
    v_mfma_f32_16x16x32_bf16 v[64:67], v[180:183], a[40:43], v[64:67]
    ds_read_b64_tr_b16 v[202:203], v252 offset:10912
    v_mfma_f32_16x16x32_bf16 v[68:71], v[176:179], a[36:39], v[68:71]
    ds_read_b64_tr_b16 v[204:205], v252 offset:21920
    v_mfma_f32_16x16x32_bf16 v[68:71], v[180:183], a[44:47], v[68:71]
    ds_read_b64_tr_b16 v[206:207], v252 offset:25504
    buffer_load_dwordx4 a[124:127], v2, s[4:7], s54 offen offset:3072 sc1
    s_waitcnt lgkmcnt(8)
    v_mfma_f32_16x16x32_bf16 v[72:75], v[184:187], a[32:35], v[72:75]
    ds_read_b64_tr_b16 v[176:177], v252 offset:64
    v_mfma_f32_16x16x32_bf16 v[72:75], v[188:191], a[40:43], v[72:75]
    ds_read_b64_tr_b16 v[178:179], v252 offset:3648
    v_mfma_f32_16x16x32_bf16 v[76:79], v[184:187], a[36:39], v[76:79]
    ds_read_b64_tr_b16 v[180:181], v252 offset:14656
    v_mfma_f32_16x16x32_bf16 v[76:79], v[188:191], a[44:47], v[76:79]
    ds_read_b64_tr_b16 v[182:183], v252 offset:18240
    s_waitcnt lgkmcnt(8)
    v_mfma_f32_16x16x32_bf16 v[80:83], v[192:195], a[32:35], v[80:83]
    ds_read_b64_tr_b16 v[184:185], v252 offset:7360
    v_mfma_f32_16x16x32_bf16 v[80:83], v[196:199], a[40:43], v[80:83]
    ds_read_b64_tr_b16 v[186:187], v252 offset:10944
    v_mfma_f32_16x16x32_bf16 v[84:87], v[192:195], a[36:39], v[84:87]
    ds_read_b64_tr_b16 v[188:189], v252 offset:21952
    v_mfma_f32_16x16x32_bf16 v[84:87], v[196:199], a[44:47], v[84:87]
    ds_read_b64_tr_b16 v[190:191], v252 offset:25536
    s_waitcnt lgkmcnt(8)
    v_mfma_f32_16x16x32_bf16 v[88:91], v[200:203], a[32:35], v[88:91]
    ds_read_b64_tr_b16 v[192:193], v252 offset:96
    v_mfma_f32_16x16x32_bf16 v[88:91], v[204:207], a[40:43], v[88:91]
    ds_read_b64_tr_b16 v[194:195], v252 offset:3680
    v_mfma_f32_16x16x32_bf16 v[92:95], v[200:203], a[36:39], v[92:95]
    ds_read_b64_tr_b16 v[196:197], v252 offset:14688
    v_mfma_f32_16x16x32_bf16 v[92:95], v[204:207], a[44:47], v[92:95]
    ds_read_b64_tr_b16 v[198:199], v252 offset:18272
    s_waitcnt lgkmcnt(8)
    v_mfma_f32_16x16x32_bf16 v[96:99], v[176:179], a[32:35], v[96:99]
    ds_read_b64_tr_b16 v[200:201], v252 offset:7392
    v_mfma_f32_16x16x32_bf16 v[96:99], v[180:183], a[40:43], v[96:99]
    ds_read_b64_tr_b16 v[202:203], v252 offset:10976
    v_mfma_f32_16x16x32_bf16 v[100:103], v[176:179], a[36:39], v[100:103]
    ds_read_b64_tr_b16 v[204:205], v252 offset:21984
    v_mfma_f32_16x16x32_bf16 v[100:103], v[180:183], a[44:47], v[100:103]
    ds_read_b64_tr_b16 v[206:207], v252 offset:25568
    s_waitcnt lgkmcnt(8)
    v_mfma_f32_16x16x32_bf16 v[104:107], v[184:187], a[32:35], v[104:107]
    ds_read_b64_tr_b16 v[176:177], v252 offset:128
    v_mfma_f32_16x16x32_bf16 v[104:107], v[188:191], a[40:43], v[104:107]
    ds_read_b64_tr_b16 v[178:179], v252 offset:3712
    v_mfma_f32_16x16x32_bf16 v[108:111], v[184:187], a[36:39], v[108:111]
    ds_read_b64_tr_b16 v[180:181], v252 offset:14720
    v_mfma_f32_16x16x32_bf16 v[108:111], v[188:191], a[44:47], v[108:111]
    ds_read_b64_tr_b16 v[182:183], v252 offset:18304
    s_waitcnt lgkmcnt(8)
    v_mfma_f32_16x16x32_bf16 v[112:115], v[192:195], a[32:35], v[112:115]
    ds_read_b64_tr_b16 v[184:185], v252 offset:7424
    v_mfma_f32_16x16x32_bf16 v[112:115], v[196:199], a[40:43], v[112:115]
    ds_read_b64_tr_b16 v[186:187], v252 offset:11008
    v_mfma_f32_16x16x32_bf16 v[116:119], v[192:195], a[36:39], v[116:119]
    ds_read_b64_tr_b16 v[188:189], v252 offset:22016
    v_mfma_f32_16x16x32_bf16 v[116:119], v[196:199], a[44:47], v[116:119]
    ds_read_b64_tr_b16 v[190:191], v252 offset:25600
    s_waitcnt lgkmcnt(8)
    v_mfma_f32_16x16x32_bf16 v[120:123], v[200:203], a[32:35], v[120:123]
    ds_read_b64_tr_b16 v[192:193], v252 offset:160
    v_mfma_f32_16x16x32_bf16 v[120:123], v[204:207], a[40:43], v[120:123]
    ds_read_b64_tr_b16 v[194:195], v252 offset:3744
    v_mfma_f32_16x16x32_bf16 v[124:127], v[200:203], a[36:39], v[124:127]
    ds_read_b64_tr_b16 v[196:197], v252 offset:14752
    v_mfma_f32_16x16x32_bf16 v[124:127], v[204:207], a[44:47], v[124:127]
    ds_read_b64_tr_b16 v[198:199], v252 offset:18336
    s_waitcnt lgkmcnt(8)
    v_mfma_f32_16x16x32_bf16 v[128:131], v[176:179], a[32:35], v[128:131]
    ds_read_b64_tr_b16 v[200:201], v252 offset:7456
    v_mfma_f32_16x16x32_bf16 v[128:131], v[180:183], a[40:43], v[128:131]
    ds_read_b64_tr_b16 v[202:203], v252 offset:11040
    buffer_load_dword v255, v8, s[28:31], s55 offen
    v_mfma_f32_16x16x32_bf16 v[132:135], v[176:179], a[36:39], v[132:135]
    ds_read_b64_tr_b16 v[204:205], v252 offset:22048
    v_mfma_f32_16x16x32_bf16 v[132:135], v[180:183], a[44:47], v[132:135]
    ds_read_b64_tr_b16 v[206:207], v252 offset:25632
    s_waitcnt lgkmcnt(8)
    v_mfma_f32_16x16x32_bf16 v[136:139], v[184:187], a[32:35], v[136:139]
    ds_read_b64_tr_b16 v[176:177], v221 offset:192
    v_mfma_f32_16x16x32_bf16 v[136:139], v[188:191], a[40:43], v[136:139]
    ds_read_b64_tr_b16 v[178:179], v221 offset:3776
    v_mfma_f32_16x16x32_bf16 v[140:143], v[184:187], a[36:39], v[140:143]
    ds_read_b64_tr_b16 v[180:181], v221 offset:14784
    v_mfma_f32_16x16x32_bf16 v[140:143], v[188:191], a[44:47], v[140:143]
    ds_read_b64_tr_b16 v[182:183], v221 offset:18368
    s_barrier
    s_waitcnt lgkmcnt(8)
    v_mfma_f32_16x16x32_bf16 v[144:147], v[192:195], a[32:35], v[144:147]
    ds_read_b64_tr_b16 v[184:185], v221 offset:7488
    v_mfma_f32_16x16x32_bf16 v[144:147], v[196:199], a[40:43], v[144:147]
    ds_read_b64_tr_b16 v[186:187], v221 offset:11072
    v_mfma_f32_16x16x32_bf16 v[148:151], v[192:195], a[36:39], v[148:151]
    ds_read_b64_tr_b16 v[188:189], v221 offset:22080
    v_mfma_f32_16x16x32_bf16 v[148:151], v[196:199], a[44:47], v[148:151]
    ds_read_b64_tr_b16 v[190:191], v221 offset:25664
    s_waitcnt lgkmcnt(8)
    v_mfma_f32_16x16x32_bf16 v[152:155], v[200:203], a[32:35], v[152:155]
    ds_read_b64_tr_b16 v[192:193], v252 offset:29184
    v_mfma_f32_16x16x32_bf16 v[152:155], v[204:207], a[40:43], v[152:155]
    ds_read_b64_tr_b16 v[194:195], v252 offset:32768
    s_add_u32 m0, s66, 0
    s_add_u32 s51, s67, 1146880
    v_mfma_f32_16x16x32_bf16 v[156:159], v[200:203], a[36:39], v[156:159]
    ds_read_b64_tr_b16 v[196:197], v252 offset:43776
    v_mfma_f32_16x16x32_bf16 v[156:159], v[204:207], a[44:47], v[156:159]
    ds_read_b64_tr_b16 v[198:199], v252 offset:47360
    s_waitcnt lgkmcnt(8)
    v_mfma_f32_16x16x32_bf16 v[160:163], v[176:179], a[32:35], v[160:163]
    ds_read_b64_tr_b16 v[200:201], v252 offset:36480
    v_mfma_f32_16x16x32_bf16 v[160:163], v[180:183], a[40:43], v[160:163]
    ds_read_b64_tr_b16 v[202:203], v252 offset:40064
    v_mfma_f32_16x16x32_bf16 v[164:167], v[176:179], a[36:39], v[164:167]
    ds_read_b64_tr_b16 v[204:205], v252 offset:51072
    v_mfma_f32_16x16x32_bf16 v[164:167], v[180:183], a[44:47], v[164:167]
    ds_read_b64_tr_b16 v[206:207], v252 offset:54656
    buffer_load_dwordx4 v240, s[20:23], s51 offen offset:0 lds
    s_waitcnt lgkmcnt(8)
    v_mfma_f32_16x16x32_bf16 v[168:171], v[184:187], a[32:35], v[168:171]
    ds_read_b64_tr_b16 v[176:177], v252 offset:29216
    v_mfma_f32_16x16x32_bf16 v[168:171], v[188:191], a[40:43], v[168:171]
    ds_read_b64_tr_b16 v[178:179], v252 offset:32800
    v_mfma_f32_16x16x32_bf16 v[172:175], v[184:187], a[36:39], v[172:175]
    ds_read_b64_tr_b16 v[180:181], v252 offset:43808
    v_mfma_f32_16x16x32_bf16 v[172:175], v[188:191], a[44:47], v[172:175]
    ds_read_b64_tr_b16 v[182:183], v252 offset:47392
    s_waitcnt vmcnt(25) lgkmcnt(8)
    v_mfma_f32_16x16x32_bf16 v[64:67], v[192:195], a[48:51], v[64:67]
    ds_read_b64_tr_b16 v[184:185], v252 offset:36512
    v_mfma_f32_16x16x32_bf16 v[64:67], v[196:199], a[56:59], v[64:67]
    ds_read_b64_tr_b16 v[186:187], v252 offset:40096
    buffer_load_dwordx4 v241, s[20:23], s51 offen offset:1024 lds
    v_mfma_f32_16x16x32_bf16 v[68:71], v[192:195], a[52:55], v[68:71]
    ds_read_b64_tr_b16 v[188:189], v252 offset:51104
    v_mfma_f32_16x16x32_bf16 v[68:71], v[196:199], a[60:63], v[68:71]
    ds_read_b64_tr_b16 v[190:191], v252 offset:54688
    s_waitcnt lgkmcnt(8)
    v_mfma_f32_16x16x32_bf16 v[72:75], v[200:203], a[48:51], v[72:75]
    ds_read_b64_tr_b16 v[192:193], v252 offset:29248
    v_mfma_f32_16x16x32_bf16 v[72:75], v[204:207], a[56:59], v[72:75]
    ds_read_b64_tr_b16 v[194:195], v252 offset:32832
    v_mfma_f32_16x16x32_bf16 v[76:79], v[200:203], a[52:55], v[76:79]
    ds_read_b64_tr_b16 v[196:197], v252 offset:43840
    v_mfma_f32_16x16x32_bf16 v[76:79], v[204:207], a[60:63], v[76:79]
    ds_read_b64_tr_b16 v[198:199], v252 offset:47424
    buffer_load_dwordx4 v242, s[20:23], s51 offen offset:2048 lds
    s_waitcnt lgkmcnt(8)
    v_mfma_f32_16x16x32_bf16 v[80:83], v[176:179], a[48:51], v[80:83]
    ds_read_b64_tr_b16 v[200:201], v252 offset:36544
    v_mfma_f32_16x16x32_bf16 v[80:83], v[180:183], a[56:59], v[80:83]
    ds_read_b64_tr_b16 v[202:203], v252 offset:40128
    v_mfma_f32_16x16x32_bf16 v[84:87], v[176:179], a[52:55], v[84:87]
    ds_read_b64_tr_b16 v[204:205], v252 offset:51136
    v_mfma_f32_16x16x32_bf16 v[84:87], v[180:183], a[60:63], v[84:87]
    ds_read_b64_tr_b16 v[206:207], v252 offset:54720
    s_waitcnt lgkmcnt(8)
    v_mfma_f32_16x16x32_bf16 v[88:91], v[184:187], a[48:51], v[88:91]
    ds_read_b64_tr_b16 v[176:177], v252 offset:29280
    v_mfma_f32_16x16x32_bf16 v[88:91], v[188:191], a[56:59], v[88:91]
    ds_read_b64_tr_b16 v[178:179], v252 offset:32864
    buffer_load_dwordx4 v243, s[20:23], s51 offen offset:3072 lds
    v_mfma_f32_16x16x32_bf16 v[92:95], v[184:187], a[52:55], v[92:95]
    ds_read_b64_tr_b16 v[180:181], v252 offset:43872
    v_mfma_f32_16x16x32_bf16 v[92:95], v[188:191], a[60:63], v[92:95]
    ds_read_b64_tr_b16 v[182:183], v252 offset:47456
    s_waitcnt lgkmcnt(8)
    v_mfma_f32_16x16x32_bf16 v[96:99], v[192:195], a[48:51], v[96:99]
    ds_read_b64_tr_b16 v[184:185], v252 offset:36576
    v_mfma_f32_16x16x32_bf16 v[96:99], v[196:199], a[56:59], v[96:99]
    ds_read_b64_tr_b16 v[186:187], v252 offset:40160
    v_mfma_f32_16x16x32_bf16 v[100:103], v[192:195], a[52:55], v[100:103]
    ds_read_b64_tr_b16 v[188:189], v252 offset:51168
    v_mfma_f32_16x16x32_bf16 v[100:103], v[196:199], a[60:63], v[100:103]
    ds_read_b64_tr_b16 v[190:191], v252 offset:54752
    s_add_u32 m0, s66, 4096
    s_nop 0
    s_waitcnt lgkmcnt(8)
    v_mfma_f32_16x16x32_bf16 v[104:107], v[200:203], a[48:51], v[104:107]
    ds_read_b64_tr_b16 v[192:193], v252 offset:29312
    v_mfma_f32_16x16x32_bf16 v[104:107], v[204:207], a[56:59], v[104:107]
    ds_read_b64_tr_b16 v[194:195], v252 offset:32896
    v_mfma_f32_16x16x32_bf16 v[108:111], v[200:203], a[52:55], v[108:111]
    ds_read_b64_tr_b16 v[196:197], v252 offset:43904
    v_mfma_f32_16x16x32_bf16 v[108:111], v[204:207], a[60:63], v[108:111]
    ds_read_b64_tr_b16 v[198:199], v252 offset:47488
    s_waitcnt lgkmcnt(8)
    v_mfma_f32_16x16x32_bf16 v[112:115], v[176:179], a[48:51], v[112:115]
    ds_read_b64_tr_b16 v[200:201], v252 offset:36608
    v_mfma_f32_16x16x32_bf16 v[112:115], v[180:183], a[56:59], v[112:115]
    ds_read_b64_tr_b16 v[202:203], v252 offset:40192
    buffer_load_dwordx4 v244, s[20:23], s51 offen offset:0 lds
    v_mfma_f32_16x16x32_bf16 v[116:119], v[176:179], a[52:55], v[116:119]
    ds_read_b64_tr_b16 v[204:205], v252 offset:51200
    v_mfma_f32_16x16x32_bf16 v[116:119], v[180:183], a[60:63], v[116:119]
    ds_read_b64_tr_b16 v[206:207], v252 offset:54784
    s_waitcnt lgkmcnt(8)
    v_mfma_f32_16x16x32_bf16 v[120:123], v[184:187], a[48:51], v[120:123]
    ds_read_b64_tr_b16 v[176:177], v252 offset:29344
    v_mfma_f32_16x16x32_bf16 v[120:123], v[188:191], a[56:59], v[120:123]
    ds_read_b64_tr_b16 v[178:179], v252 offset:32928
    v_mfma_f32_16x16x32_bf16 v[124:127], v[184:187], a[52:55], v[124:127]
    ds_read_b64_tr_b16 v[180:181], v252 offset:43936
    v_mfma_f32_16x16x32_bf16 v[124:127], v[188:191], a[60:63], v[124:127]
    ds_read_b64_tr_b16 v[182:183], v252 offset:47520
    buffer_load_dwordx4 v245, s[20:23], s51 offen offset:1024 lds
    s_waitcnt lgkmcnt(8)
    v_mfma_f32_16x16x32_bf16 v[128:131], v[192:195], a[48:51], v[128:131]
    ds_read_b64_tr_b16 v[184:185], v252 offset:36640
    v_mfma_f32_16x16x32_bf16 v[128:131], v[196:199], a[56:59], v[128:131]
    ds_read_b64_tr_b16 v[186:187], v252 offset:40224
    v_mfma_f32_16x16x32_bf16 v[132:135], v[192:195], a[52:55], v[132:135]
    ds_read_b64_tr_b16 v[188:189], v252 offset:51232
    v_mfma_f32_16x16x32_bf16 v[132:135], v[196:199], a[60:63], v[132:135]
    ds_read_b64_tr_b16 v[190:191], v252 offset:54816
    s_waitcnt lgkmcnt(8)
    v_mfma_f32_16x16x32_bf16 v[136:139], v[200:203], a[48:51], v[136:139]
    ds_read_b64_tr_b16 v[192:193], v221 offset:29376
    v_mfma_f32_16x16x32_bf16 v[136:139], v[204:207], a[56:59], v[136:139]
    ds_read_b64_tr_b16 v[194:195], v221 offset:32960
    buffer_load_dwordx4 v246, s[20:23], s51 offen offset:2048 lds
    v_mfma_f32_16x16x32_bf16 v[140:143], v[200:203], a[52:55], v[140:143]
    ds_read_b64_tr_b16 v[196:197], v221 offset:43968
    v_mfma_f32_16x16x32_bf16 v[140:143], v[204:207], a[60:63], v[140:143]
    ds_read_b64_tr_b16 v[198:199], v221 offset:47552
    s_waitcnt vmcnt(14)
    s_barrier
    s_waitcnt lgkmcnt(8)
    v_mfma_f32_16x16x32_bf16 v[144:147], v[176:179], a[48:51], v[144:147]
    ds_read_b64_tr_b16 v[200:201], v221 offset:36672
    v_mfma_f32_16x16x32_bf16 v[144:147], v[180:183], a[56:59], v[144:147]
    ds_read_b64_tr_b16 v[202:203], v221 offset:40256
    v_mfma_f32_16x16x32_bf16 v[148:151], v[176:179], a[52:55], v[148:151]
    ds_read_b64_tr_b16 v[204:205], v221 offset:51264
    v_mfma_f32_16x16x32_bf16 v[148:151], v[180:183], a[60:63], v[148:151]
    ds_read_b64_tr_b16 v[206:207], v221 offset:54848
    s_waitcnt lgkmcnt(8)
    v_mfma_f32_16x16x32_bf16 v[152:155], v[184:187], a[48:51], v[152:155]
    ds_read_b64_tr_b16 v[176:177], v253 offset:0
    v_mfma_f32_16x16x32_bf16 v[152:155], v[188:191], a[56:59], v[152:155]
    ds_read_b64_tr_b16 v[178:179], v253 offset:3584
    s_add_u32 m0, s66, 29184
    s_add_u32 s51, s67, 1376256
    v_mfma_f32_16x16x32_bf16 v[156:159], v[184:187], a[52:55], v[156:159]
    ds_read_b64_tr_b16 v[180:181], v253 offset:14592
    v_mfma_f32_16x16x32_bf16 v[156:159], v[188:191], a[60:63], v[156:159]
    ds_read_b64_tr_b16 v[182:183], v253 offset:18176
    s_waitcnt lgkmcnt(8)
    v_mfma_f32_16x16x32_bf16 v[160:163], v[192:195], a[48:51], v[160:163]
    ds_read_b64_tr_b16 v[184:185], v253 offset:7296
    v_mfma_f32_16x16x32_bf16 v[160:163], v[196:199], a[56:59], v[160:163]
    ds_read_b64_tr_b16 v[186:187], v253 offset:10880
    v_mfma_f32_16x16x32_bf16 v[164:167], v[192:195], a[52:55], v[164:167]
    ds_read_b64_tr_b16 v[188:189], v253 offset:21888
    v_mfma_f32_16x16x32_bf16 v[164:167], v[196:199], a[60:63], v[164:167]
    ds_read_b64_tr_b16 v[190:191], v253 offset:25472
    buffer_load_dwordx4 v240, s[20:23], s51 offen offset:0 lds
    s_waitcnt lgkmcnt(8)
    v_mfma_f32_16x16x32_bf16 v[168:171], v[200:203], a[48:51], v[168:171]
    ds_read_b64_tr_b16 v[192:193], v253 offset:32
    v_mfma_f32_16x16x32_bf16 v[168:171], v[204:207], a[56:59], v[168:171]
    ds_read_b64_tr_b16 v[194:195], v253 offset:3616
    v_mfma_f32_16x16x32_bf16 v[172:175], v[200:203], a[52:55], v[172:175]
    ds_read_b64_tr_b16 v[196:197], v253 offset:14624
    v_mfma_f32_16x16x32_bf16 v[172:175], v[204:207], a[60:63], v[172:175]
    ds_read_b64_tr_b16 v[198:199], v253 offset:18208
    s_waitcnt lgkmcnt(8)
    v_mfma_f32_16x16x32_bf16 v[64:67], v[176:179], a[64:67], v[64:67]
    ds_read_b64_tr_b16 v[200:201], v253 offset:7328
    v_mfma_f32_16x16x32_bf16 v[64:67], v[180:183], a[72:75], v[64:67]
    ds_read_b64_tr_b16 v[202:203], v253 offset:10912
    buffer_load_dwordx4 v241, s[20:23], s51 offen offset:1024 lds
    v_mfma_f32_16x16x32_bf16 v[68:71], v[176:179], a[68:71], v[68:71]
    ds_read_b64_tr_b16 v[204:205], v253 offset:21920
    v_mfma_f32_16x16x32_bf16 v[68:71], v[180:183], a[76:79], v[68:71]
    ds_read_b64_tr_b16 v[206:207], v253 offset:25504
    s_waitcnt lgkmcnt(8)
    v_mfma_f32_16x16x32_bf16 v[72:75], v[184:187], a[64:67], v[72:75]
    ds_read_b64_tr_b16 v[176:177], v253 offset:64
    v_mfma_f32_16x16x32_bf16 v[72:75], v[188:191], a[72:75], v[72:75]
    ds_read_b64_tr_b16 v[178:179], v253 offset:3648
    v_mfma_f32_16x16x32_bf16 v[76:79], v[184:187], a[68:71], v[76:79]
    ds_read_b64_tr_b16 v[180:181], v253 offset:14656
    v_mfma_f32_16x16x32_bf16 v[76:79], v[188:191], a[76:79], v[76:79]
    ds_read_b64_tr_b16 v[182:183], v253 offset:18240
    buffer_load_dwordx4 v242, s[20:23], s51 offen offset:2048 lds
    s_waitcnt lgkmcnt(8)
    v_mfma_f32_16x16x32_bf16 v[80:83], v[192:195], a[64:67], v[80:83]
    ds_read_b64_tr_b16 v[184:185], v253 offset:7360
    v_mfma_f32_16x16x32_bf16 v[80:83], v[196:199], a[72:75], v[80:83]
    ds_read_b64_tr_b16 v[186:187], v253 offset:10944
    v_mfma_f32_16x16x32_bf16 v[84:87], v[192:195], a[68:71], v[84:87]
    ds_read_b64_tr_b16 v[188:189], v253 offset:21952
    v_mfma_f32_16x16x32_bf16 v[84:87], v[196:199], a[76:79], v[84:87]
    ds_read_b64_tr_b16 v[190:191], v253 offset:25536
    s_waitcnt lgkmcnt(8)
    v_mfma_f32_16x16x32_bf16 v[88:91], v[200:203], a[64:67], v[88:91]
    ds_read_b64_tr_b16 v[192:193], v253 offset:96
    v_mfma_f32_16x16x32_bf16 v[88:91], v[204:207], a[72:75], v[88:91]
    ds_read_b64_tr_b16 v[194:195], v253 offset:3680
    buffer_load_dwordx4 v243, s[20:23], s51 offen offset:3072 lds
    v_mfma_f32_16x16x32_bf16 v[92:95], v[200:203], a[68:71], v[92:95]
    ds_read_b64_tr_b16 v[196:197], v253 offset:14688
    v_mfma_f32_16x16x32_bf16 v[92:95], v[204:207], a[76:79], v[92:95]
    ds_read_b64_tr_b16 v[198:199], v253 offset:18272
    s_waitcnt lgkmcnt(8)
    v_mfma_f32_16x16x32_bf16 v[96:99], v[176:179], a[64:67], v[96:99]
    ds_read_b64_tr_b16 v[200:201], v253 offset:7392
    s_mul_i32 s56, s26, 7
    v_mfma_f32_16x16x32_bf16 v[96:99], v[180:183], a[72:75], v[96:99]
    ds_read_b64_tr_b16 v[202:203], v253 offset:10976
    v_mfma_f32_16x16x32_bf16 v[100:103], v[176:179], a[68:71], v[100:103]
    ds_read_b64_tr_b16 v[204:205], v253 offset:21984
    v_mfma_f32_16x16x32_bf16 v[100:103], v[180:183], a[76:79], v[100:103]
    ds_read_b64_tr_b16 v[206:207], v253 offset:25568
    s_add_u32 m0, s66, 33280
    s_nop 0
    s_waitcnt lgkmcnt(8)
    v_mfma_f32_16x16x32_bf16 v[104:107], v[184:187], a[64:67], v[104:107]
    ds_read_b64_tr_b16 v[176:177], v253 offset:128
    s_add_u32 s56, s56, 1
    v_mfma_f32_16x16x32_bf16 v[104:107], v[188:191], a[72:75], v[104:107]
    ds_read_b64_tr_b16 v[178:179], v253 offset:3712
    v_mfma_f32_16x16x32_bf16 v[108:111], v[184:187], a[68:71], v[108:111]
    ds_read_b64_tr_b16 v[180:181], v253 offset:14720
    v_mfma_f32_16x16x32_bf16 v[108:111], v[188:191], a[76:79], v[108:111]
    ds_read_b64_tr_b16 v[182:183], v253 offset:18304
    s_waitcnt lgkmcnt(8)
    v_mfma_f32_16x16x32_bf16 v[112:115], v[192:195], a[64:67], v[112:115]
    ds_read_b64_tr_b16 v[184:185], v253 offset:7424
    s_lshr_b32 s57, s56, 1
    v_mfma_f32_16x16x32_bf16 v[112:115], v[196:199], a[72:75], v[112:115]
    ds_read_b64_tr_b16 v[186:187], v253 offset:11008
    buffer_load_dwordx4 v244, s[20:23], s51 offen offset:0 lds
    v_mfma_f32_16x16x32_bf16 v[116:119], v[192:195], a[68:71], v[116:119]
    ds_read_b64_tr_b16 v[188:189], v253 offset:22016
    v_mfma_f32_16x16x32_bf16 v[116:119], v[196:199], a[76:79], v[116:119]
    ds_read_b64_tr_b16 v[190:191], v253 offset:25600
    s_waitcnt lgkmcnt(8)
    v_mfma_f32_16x16x32_bf16 v[120:123], v[200:203], a[64:67], v[120:123]
    ds_read_b64_tr_b16 v[192:193], v253 offset:160
    s_mul_i32 s52, s64, 114688
    v_mfma_f32_16x16x32_bf16 v[120:123], v[204:207], a[72:75], v[120:123]
    ds_read_b64_tr_b16 v[194:195], v253 offset:3744
    v_mfma_f32_16x16x32_bf16 v[124:127], v[200:203], a[68:71], v[124:127]
    ds_read_b64_tr_b16 v[196:197], v253 offset:14752
    v_mfma_f32_16x16x32_bf16 v[124:127], v[204:207], a[76:79], v[124:127]
    ds_read_b64_tr_b16 v[198:199], v253 offset:18336
    buffer_load_dwordx4 v245, s[20:23], s51 offen offset:1024 lds
    s_waitcnt lgkmcnt(8)
    v_mfma_f32_16x16x32_bf16 v[128:131], v[176:179], a[64:67], v[128:131]
    ds_read_b64_tr_b16 v[200:201], v253 offset:7456
    s_lshl_b32 s3, s57, 10
    v_mfma_f32_16x16x32_bf16 v[128:131], v[180:183], a[72:75], v[128:131]
    ds_read_b64_tr_b16 v[202:203], v253 offset:11040
    v_mfma_f32_16x16x32_bf16 v[132:135], v[176:179], a[68:71], v[132:135]
    ds_read_b64_tr_b16 v[204:205], v253 offset:22048
    v_mfma_f32_16x16x32_bf16 v[132:135], v[180:183], a[76:79], v[132:135]
    ds_read_b64_tr_b16 v[206:207], v253 offset:25632
    s_waitcnt lgkmcnt(8)
    v_mfma_f32_16x16x32_bf16 v[136:139], v[184:187], a[64:67], v[136:139]
    ds_read_b64_tr_b16 v[176:177], v222 offset:192
    s_add_u32 s52, s52, s3
    v_mfma_f32_16x16x32_bf16 v[136:139], v[188:191], a[72:75], v[136:139]
    ds_read_b64_tr_b16 v[178:179], v222 offset:3776
    buffer_load_dwordx4 v246, s[20:23], s51 offen offset:2048 lds
    v_mfma_f32_16x16x32_bf16 v[140:143], v[184:187], a[68:71], v[140:143]
    ds_read_b64_tr_b16 v[180:181], v222 offset:14784
    v_mfma_f32_16x16x32_bf16 v[140:143], v[188:191], a[76:79], v[140:143]
    ds_read_b64_tr_b16 v[182:183], v222 offset:18368
    s_waitcnt vmcnt(7)
    s_barrier
    s_waitcnt lgkmcnt(8)
    v_mfma_f32_16x16x32_bf16 v[144:147], v[192:195], a[64:67], v[144:147]
    ds_read_b64_tr_b16 v[184:185], v222 offset:7488
    s_add_u32 s52, s52, 13631488
    v_mfma_f32_16x16x32_bf16 v[144:147], v[196:199], a[72:75], v[144:147]
    ds_read_b64_tr_b16 v[186:187], v222 offset:11072
    v_mfma_f32_16x16x32_bf16 v[148:151], v[192:195], a[68:71], v[148:151]
    ds_read_b64_tr_b16 v[188:189], v222 offset:22080
    v_mfma_f32_16x16x32_bf16 v[148:151], v[196:199], a[76:79], v[148:151]
    ds_read_b64_tr_b16 v[190:191], v222 offset:25664
    s_waitcnt lgkmcnt(8)
    v_mfma_f32_16x16x32_bf16 v[152:155], v[200:203], a[64:67], v[152:155]
    ds_read_b64_tr_b16 v[192:193], v251 offset:0
    s_add_u32 s53, s52, 57344
    v_mfma_f32_16x16x32_bf16 v[152:155], v[204:207], a[72:75], v[152:155]
    ds_read_b64_tr_b16 v[194:195], v251 offset:3584
    s_add_u32 m0, s66, 58368
    s_add_u32 s51, s67, 1605632
    v_mfma_f32_16x16x32_bf16 v[156:159], v[200:203], a[68:71], v[156:159]
    ds_read_b64_tr_b16 v[196:197], v251 offset:14592
    v_mfma_f32_16x16x32_bf16 v[156:159], v[204:207], a[76:79], v[156:159]
    ds_read_b64_tr_b16 v[198:199], v251 offset:18176
    s_waitcnt lgkmcnt(8)
    v_mfma_f32_16x16x32_bf16 v[160:163], v[176:179], a[64:67], v[160:163]
    ds_read_b64_tr_b16 v[200:201], v251 offset:7296
    s_bitcmp1_b32 s45, 0
    s_cselect_b32 s57, -4, 0
    v_mfma_f32_16x16x32_bf16 v[160:163], v[180:183], a[72:75], v[160:163]
    ds_read_b64_tr_b16 v[202:203], v251 offset:10880
    buffer_load_dwordx4 v240, s[20:23], s51 offen offset:0 lds
    v_mfma_f32_16x16x32_bf16 v[164:167], v[176:179], a[68:71], v[164:167]
    ds_read_b64_tr_b16 v[204:205], v251 offset:21888
    v_mfma_f32_16x16x32_bf16 v[164:167], v[180:183], a[76:79], v[164:167]
    ds_read_b64_tr_b16 v[206:207], v251 offset:25472
    s_waitcnt lgkmcnt(8)
    v_mfma_f32_16x16x32_bf16 v[168:171], v[184:187], a[64:67], v[168:171]
    ds_read_b64_tr_b16 v[176:177], v251 offset:32
    s_mul_i32 s57, s57, 1022
    v_mfma_f32_16x16x32_bf16 v[168:171], v[188:191], a[72:75], v[168:171]
    ds_read_b64_tr_b16 v[178:179], v251 offset:3616
    v_mfma_f32_16x16x32_bf16 v[172:175], v[184:187], a[68:71], v[172:175]
    ds_read_b64_tr_b16 v[180:181], v251 offset:14624
    v_mfma_f32_16x16x32_bf16 v[172:175], v[188:191], a[76:79], v[172:175]
    ds_read_b64_tr_b16 v[182:183], v251 offset:18208
    buffer_load_dwordx4 v241, s[20:23], s51 offen offset:1024 lds
    s_waitcnt lgkmcnt(8)
    v_mfma_f32_16x16x32_bf16 v[64:67], v[192:195], a[80:83], v[64:67]
    ds_read_b64_tr_b16 v[184:185], v251 offset:7328
    s_add_u32 s57, s57, 3072
    v_mfma_f32_16x16x32_bf16 v[64:67], v[196:199], a[88:91], v[64:67]
    ds_read_b64_tr_b16 v[186:187], v251 offset:10912
    v_mfma_f32_16x16x32_bf16 v[68:71], v[192:195], a[84:87], v[68:71]
    ds_read_b64_tr_b16 v[188:189], v251 offset:21920
    v_mfma_f32_16x16x32_bf16 v[68:71], v[196:199], a[92:95], v[68:71]
    ds_read_b64_tr_b16 v[190:191], v251 offset:25504
    s_waitcnt lgkmcnt(8)
    v_mfma_f32_16x16x32_bf16 v[72:75], v[200:203], a[80:83], v[72:75]
    ds_read_b64_tr_b16 v[192:193], v251 offset:64
    s_add_u32 s72, s52, s57
    v_mfma_f32_16x16x32_bf16 v[72:75], v[204:207], a[88:91], v[72:75]
    ds_read_b64_tr_b16 v[194:195], v251 offset:3648
    buffer_load_dwordx4 v242, s[20:23], s51 offen offset:2048 lds
    v_mfma_f32_16x16x32_bf16 v[76:79], v[200:203], a[84:87], v[76:79]
    ds_read_b64_tr_b16 v[196:197], v251 offset:14656
    v_mfma_f32_16x16x32_bf16 v[76:79], v[204:207], a[92:95], v[76:79]
    ds_read_b64_tr_b16 v[198:199], v251 offset:18240
    s_waitcnt lgkmcnt(8)
    v_mfma_f32_16x16x32_bf16 v[80:83], v[176:179], a[80:83], v[80:83]
    ds_read_b64_tr_b16 v[200:201], v251 offset:7360
    s_add_u32 s73, s72, 57344
    v_mfma_f32_16x16x32_bf16 v[80:83], v[180:183], a[88:91], v[80:83]
    ds_read_b64_tr_b16 v[202:203], v251 offset:10944
    buffer_load_dwordx4 v243, s[20:23], s51 offen offset:3072 lds
    v_mfma_f32_16x16x32_bf16 v[84:87], v[176:179], a[84:87], v[84:87]
    ds_read_b64_tr_b16 v[204:205], v251 offset:21952
    v_mfma_f32_16x16x32_bf16 v[84:87], v[180:183], a[92:95], v[84:87]
    ds_read_b64_tr_b16 v[206:207], v251 offset:25536
    s_waitcnt lgkmcnt(8)
    v_mfma_f32_16x16x32_bf16 v[88:91], v[184:187], a[80:83], v[88:91]
    ds_read_b64_tr_b16 v[176:177], v251 offset:96
    s_lshl_b32 s56, s64, 7
    v_mfma_f32_16x16x32_bf16 v[88:91], v[188:191], a[88:91], v[88:91]
    ds_read_b64_tr_b16 v[178:179], v251 offset:3680
    v_mfma_f32_16x16x32_bf16 v[92:95], v[184:187], a[84:87], v[92:95]
    ds_read_b64_tr_b16 v[180:181], v251 offset:14688
    v_mfma_f32_16x16x32_bf16 v[92:95], v[188:191], a[92:95], v[92:95]
    ds_read_b64_tr_b16 v[182:183], v251 offset:18272
    s_add_u32 m0, s66, 62464
    s_nop 0
    s_waitcnt lgkmcnt(8)
    v_mfma_f32_16x16x32_bf16 v[96:99], v[192:195], a[80:83], v[96:99]
    ds_read_b64_tr_b16 v[184:185], v251 offset:7392
    s_lshl_b32 s3, s26, 2
    v_mfma_f32_16x16x32_bf16 v[96:99], v[196:199], a[88:91], v[96:99]
    ds_read_b64_tr_b16 v[186:187], v251 offset:10976
    v_mfma_f32_16x16x32_bf16 v[100:103], v[192:195], a[84:87], v[100:103]
    ds_read_b64_tr_b16 v[188:189], v251 offset:21984
    v_mfma_f32_16x16x32_bf16 v[100:103], v[196:199], a[92:95], v[100:103]
    ds_read_b64_tr_b16 v[190:191], v251 offset:25568
    s_waitcnt lgkmcnt(8)
    v_mfma_f32_16x16x32_bf16 v[104:107], v[200:203], a[80:83], v[104:107]
    ds_read_b64_tr_b16 v[192:193], v251 offset:128
    s_add_u32 s56, s56, s3
    v_mfma_f32_16x16x32_bf16 v[104:107], v[204:207], a[88:91], v[104:107]
    ds_read_b64_tr_b16 v[194:195], v251 offset:3712
    buffer_load_dwordx4 v244, s[20:23], s51 offen offset:0 lds
    v_mfma_f32_16x16x32_bf16 v[108:111], v[200:203], a[84:87], v[108:111]
    ds_read_b64_tr_b16 v[196:197], v251 offset:14720
    v_mfma_f32_16x16x32_bf16 v[108:111], v[204:207], a[92:95], v[108:111]
    ds_read_b64_tr_b16 v[198:199], v251 offset:18304
    s_waitcnt lgkmcnt(8)
    v_mfma_f32_16x16x32_bf16 v[112:115], v[176:179], a[80:83], v[112:115]
    ds_read_b64_tr_b16 v[200:201], v251 offset:7424
    s_add_u32 s56, s56, 57344
    v_mfma_f32_16x16x32_bf16 v[112:115], v[180:183], a[88:91], v[112:115]
    ds_read_b64_tr_b16 v[202:203], v251 offset:11008
    buffer_load_dwordx4 v245, s[20:23], s51 offen offset:1024 lds
    v_mfma_f32_16x16x32_bf16 v[116:119], v[176:179], a[84:87], v[116:119]
    ds_read_b64_tr_b16 v[204:205], v251 offset:22016
    v_mfma_f32_16x16x32_bf16 v[116:119], v[180:183], a[92:95], v[116:119]
    ds_read_b64_tr_b16 v[206:207], v251 offset:25600
    s_waitcnt lgkmcnt(8)
    v_mfma_f32_16x16x32_bf16 v[120:123], v[184:187], a[80:83], v[120:123]
    ds_read_b64_tr_b16 v[176:177], v251 offset:160
    s_and_b32 s59, s62, 0x7e
    v_mfma_f32_16x16x32_bf16 v[120:123], v[188:191], a[88:91], v[120:123]
    ds_read_b64_tr_b16 v[178:179], v251 offset:3744
    v_mfma_f32_16x16x32_bf16 v[124:127], v[184:187], a[84:87], v[124:127]
    ds_read_b64_tr_b16 v[180:181], v251 offset:14752
    v_mfma_f32_16x16x32_bf16 v[124:127], v[188:191], a[92:95], v[124:127]
    ds_read_b64_tr_b16 v[182:183], v251 offset:18336
    buffer_load_dwordx4 v246, s[20:23], s51 offen offset:2048 lds
    s_waitcnt lgkmcnt(8)
    v_mfma_f32_16x16x32_bf16 v[128:131], v[192:195], a[80:83], v[128:131]
    ds_read_b64_tr_b16 v[184:185], v251 offset:7456
    s_lshl_b32 s59, s59, 7
    v_mfma_f32_16x16x32_bf16 v[128:131], v[196:199], a[88:91], v[128:131]
    ds_read_b64_tr_b16 v[186:187], v251 offset:11040
    v_mfma_f32_16x16x32_bf16 v[132:135], v[192:195], a[84:87], v[132:135]
    ds_read_b64_tr_b16 v[188:189], v251 offset:22048
    v_mfma_f32_16x16x32_bf16 v[132:135], v[196:199], a[92:95], v[132:135]
    ds_read_b64_tr_b16 v[190:191], v251 offset:25632
    s_waitcnt lgkmcnt(8)
    v_mfma_f32_16x16x32_bf16 v[136:139], v[200:203], a[80:83], v[136:139]
    ds_read_b64_tr_b16 v[192:193], v220 offset:192
    s_lshl_b32 s3, s46, 4
    v_mfma_f32_16x16x32_bf16 v[136:139], v[204:207], a[88:91], v[136:139]
    ds_read_b64_tr_b16 v[194:195], v220 offset:3776
    s_add_u32 m0, s74, 87552
    s_add_u32 s51, s75, 229376
    v_mfma_f32_16x16x32_bf16 v[140:143], v[200:203], a[84:87], v[140:143]
    ds_read_b64_tr_b16 v[196:197], v220 offset:14784
    v_mfma_f32_16x16x32_bf16 v[140:143], v[204:207], a[92:95], v[140:143]
    ds_read_b64_tr_b16 v[198:199], v220 offset:18368
    buffer_load_dwordx4 v247, s[28:31], s51 offen offset:0 lds
    s_waitcnt vmcnt(8)
    s_barrier
    s_waitcnt lgkmcnt(8)
    v_mfma_f32_16x16x32_bf16 v[144:147], v[176:179], a[80:83], v[144:147]
    ds_read_b64_tr_b16 v[200:201], v220 offset:7488
    s_add_u32 s59, s59, s3
    v_mfma_f32_16x16x32_bf16 v[144:147], v[180:183], a[88:91], v[144:147]
    ds_read_b64_tr_b16 v[202:203], v220 offset:11072
    v_mfma_f32_16x16x32_bf16 v[148:151], v[176:179], a[84:87], v[148:151]
    ds_read_b64_tr_b16 v[204:205], v220 offset:22080
    v_mfma_f32_16x16x32_bf16 v[148:151], v[180:183], a[92:95], v[148:151]
    ds_read_b64_tr_b16 v[206:207], v220 offset:25664
    buffer_load_dwordx4 v248, s[28:31], s51 offen offset:1024 lds
    s_waitcnt lgkmcnt(8)
    v_mfma_f32_16x16x32_bf16 v[152:155], v[184:187], a[80:83], v[152:155]
    ds_read_b64_tr_b16 v[176:177], v251 offset:29184
    s_add_u32 s59, s59, 57344
    v_mfma_f32_16x16x32_bf16 v[152:155], v[188:191], a[88:91], v[152:155]
    ds_read_b64_tr_b16 v[178:179], v251 offset:32768
    v_mfma_f32_16x16x32_bf16 v[156:159], v[184:187], a[84:87], v[156:159]
    ds_read_b64_tr_b16 v[180:181], v251 offset:43776
    v_mfma_f32_16x16x32_bf16 v[156:159], v[188:191], a[92:95], v[156:159]
    ds_read_b64_tr_b16 v[182:183], v251 offset:47360
    s_add_u32 m0, s74, 89600
    s_add_u32 s51, s75, 245760
    s_waitcnt lgkmcnt(8)
    v_mfma_f32_16x16x32_bf16 v[160:163], v[192:195], a[80:83], v[160:163]
    ds_read_b64_tr_b16 v[184:185], v251 offset:36480
    v_and_b32 v7, 1, v1
    v_mfma_f32_16x16x32_bf16 v[160:163], v[196:199], a[88:91], v[160:163]
    ds_read_b64_tr_b16 v[186:187], v251 offset:40064
    buffer_load_dwordx4 v247, s[28:31], s51 offen offset:0 lds
    v_mfma_f32_16x16x32_bf16 v[164:167], v[192:195], a[84:87], v[164:167]
    ds_read_b64_tr_b16 v[188:189], v251 offset:51072
    v_mfma_f32_16x16x32_bf16 v[164:167], v[196:199], a[92:95], v[164:167]
    ds_read_b64_tr_b16 v[190:191], v251 offset:54656
    s_waitcnt lgkmcnt(8)
    v_mfma_f32_16x16x32_bf16 v[168:171], v[200:203], a[80:83], v[168:171]
    ds_read_b64_tr_b16 v[192:193], v251 offset:29216
    v_lshlrev_b32 v7, 7, v7
    v_mfma_f32_16x16x32_bf16 v[168:171], v[204:207], a[88:91], v[168:171]
    ds_read_b64_tr_b16 v[194:195], v251 offset:32800
    buffer_load_dwordx4 v248, s[28:31], s51 offen offset:1024 lds
    v_mfma_f32_16x16x32_bf16 v[172:175], v[200:203], a[84:87], v[172:175]
    ds_read_b64_tr_b16 v[196:197], v251 offset:43808
    v_mfma_f32_16x16x32_bf16 v[172:175], v[204:207], a[92:95], v[172:175]
    ds_read_b64_tr_b16 v[198:199], v251 offset:47392
    s_waitcnt lgkmcnt(8)
    v_mfma_f32_16x16x32_bf16 v[64:67], v[176:179], a[96:99], v[64:67]
    ds_read_b64_tr_b16 v[200:201], v251 offset:36512
    v_bfe_u32 v6, v1, 1, 2
    v_mfma_f32_16x16x32_bf16 v[64:67], v[180:183], a[104:107], v[64:67]
    ds_read_b64_tr_b16 v[202:203], v251 offset:40096
    s_add_u32 m0, s74, 103936
    s_add_u32 s51, s75, 262144
    v_mfma_f32_16x16x32_bf16 v[68:71], v[176:179], a[100:103], v[68:71]
    ds_read_b64_tr_b16 v[204:205], v251 offset:51104
    v_mfma_f32_16x16x32_bf16 v[68:71], v[180:183], a[108:111], v[68:71]
    ds_read_b64_tr_b16 v[206:207], v251 offset:54688
    buffer_load_dwordx4 v247, s[28:31], s51 offen offset:0 lds
    s_waitcnt lgkmcnt(8)
    v_mfma_f32_16x16x32_bf16 v[72:75], v[184:187], a[96:99], v[72:75]
    ds_read_b64_tr_b16 v[176:177], v251 offset:29248
    v_lshl_add_u32 v7, v6, 2, v7
    v_mfma_f32_16x16x32_bf16 v[72:75], v[188:191], a[104:107], v[72:75]
    ds_read_b64_tr_b16 v[178:179], v251 offset:32832
    buffer_load_dwordx4 v248, s[28:31], s51 offen offset:1024 lds
    v_mfma_f32_16x16x32_bf16 v[76:79], v[184:187], a[100:103], v[76:79]
    ds_read_b64_tr_b16 v[180:181], v251 offset:43840
    v_mfma_f32_16x16x32_bf16 v[76:79], v[188:191], a[108:111], v[76:79]
    ds_read_b64_tr_b16 v[182:183], v251 offset:47424
    s_waitcnt lgkmcnt(8)
    v_mfma_f32_16x16x32_bf16 v[80:83], v[192:195], a[96:99], v[80:83]
    ds_read_b64_tr_b16 v[184:185], v251 offset:36544
    v_mov_b32 v16, 0xc0135761
    v_mfma_f32_16x16x32_bf16 v[80:83], v[196:199], a[104:107], v[80:83]
    ds_read_b64_tr_b16 v[186:187], v251 offset:40128
    s_add_u32 m0, s74, 105984
    s_add_u32 s51, s75, 278528
    v_mfma_f32_16x16x32_bf16 v[84:87], v[192:195], a[100:103], v[84:87]
    ds_read_b64_tr_b16 v[188:189], v251 offset:51136
    v_mfma_f32_16x16x32_bf16 v[84:87], v[196:199], a[108:111], v[84:87]
    ds_read_b64_tr_b16 v[190:191], v251 offset:54720
    buffer_load_dwordx4 v247, s[28:31], s51 offen offset:0 lds
    s_waitcnt lgkmcnt(8)
    v_mfma_f32_16x16x32_bf16 v[88:91], v[200:203], a[96:99], v[88:91]
    ds_read_b64_tr_b16 v[192:193], v251 offset:29280
    v_mov_b32 v18, 0xbdd2d3e8
    v_mfma_f32_16x16x32_bf16 v[88:91], v[204:207], a[104:107], v[88:91]
    ds_read_b64_tr_b16 v[194:195], v251 offset:32864
    buffer_load_dwordx4 v248, s[28:31], s51 offen offset:1024 lds
    v_mfma_f32_16x16x32_bf16 v[92:95], v[200:203], a[100:103], v[92:95]
    ds_read_b64_tr_b16 v[196:197], v251 offset:43872
    v_mfma_f32_16x16x32_bf16 v[92:95], v[204:207], a[108:111], v[92:95]
    ds_read_b64_tr_b16 v[198:199], v251 offset:47456
    s_waitcnt lgkmcnt(8)
    v_mfma_f32_16x16x32_bf16 v[96:99], v[176:179], a[96:99], v[96:99]
    ds_read_b64_tr_b16 v[200:201], v251 offset:36576
    v_mov_b32 v20, 1.0
    v_mfma_f32_16x16x32_bf16 v[96:99], v[180:183], a[104:107], v[96:99]
    ds_read_b64_tr_b16 v[202:203], v251 offset:40160
    s_add_u32 m0, s74, 120320
    s_add_u32 s51, s75, 360448
    v_mfma_f32_16x16x32_bf16 v[100:103], v[176:179], a[100:103], v[100:103]
    ds_read_b64_tr_b16 v[204:205], v251 offset:51168
    v_mfma_f32_16x16x32_bf16 v[100:103], v[180:183], a[108:111], v[100:103]
    ds_read_b64_tr_b16 v[206:207], v251 offset:54752
    buffer_load_dwordx4 v247, s[28:31], s51 offen offset:0 lds
    s_waitcnt lgkmcnt(8)
    v_mfma_f32_16x16x32_bf16 v[104:107], v[184:187], a[96:99], v[104:107]
    ds_read_b64_tr_b16 v[176:177], v251 offset:29312
    v_mfma_f32_16x16x32_bf16 v[104:107], v[188:191], a[104:107], v[104:107]
    ds_read_b64_tr_b16 v[178:179], v251 offset:32896
    buffer_load_dwordx4 v248, s[28:31], s51 offen offset:1024 lds
    v_mfma_f32_16x16x32_bf16 v[108:111], v[184:187], a[100:103], v[108:111]
    ds_read_b64_tr_b16 v[180:181], v251 offset:43904
    v_mfma_f32_16x16x32_bf16 v[108:111], v[188:191], a[108:111], v[108:111]
    ds_read_b64_tr_b16 v[182:183], v251 offset:47488
    s_waitcnt lgkmcnt(8)
    v_mfma_f32_16x16x32_bf16 v[112:115], v[192:195], a[96:99], v[112:115]
    ds_read_b64_tr_b16 v[184:185], v251 offset:36608
    v_mfma_f32_16x16x32_bf16 v[112:115], v[196:199], a[104:107], v[112:115]
    ds_read_b64_tr_b16 v[186:187], v251 offset:40192
    s_add_u32 m0, s74, 122368
    s_add_u32 s51, s75, 376832
    v_mfma_f32_16x16x32_bf16 v[116:119], v[192:195], a[100:103], v[116:119]
    ds_read_b64_tr_b16 v[188:189], v251 offset:51200
    v_mfma_f32_16x16x32_bf16 v[116:119], v[196:199], a[108:111], v[116:119]
    ds_read_b64_tr_b16 v[190:191], v251 offset:54784
    buffer_load_dwordx4 v247, s[28:31], s51 offen offset:0 lds
    s_waitcnt lgkmcnt(8)
    v_mfma_f32_16x16x32_bf16 v[120:123], v[200:203], a[96:99], v[120:123]
    ds_read_b64_tr_b16 v[192:193], v251 offset:29344
    v_mfma_f32_16x16x32_bf16 v[120:123], v[204:207], a[104:107], v[120:123]
    ds_read_b64_tr_b16 v[194:195], v251 offset:32928
    buffer_load_dwordx4 v248, s[28:31], s51 offen offset:1024 lds
    v_mfma_f32_16x16x32_bf16 v[124:127], v[200:203], a[100:103], v[124:127]
    ds_read_b64_tr_b16 v[196:197], v251 offset:43936
    v_mfma_f32_16x16x32_bf16 v[124:127], v[204:207], a[108:111], v[124:127]
    ds_read_b64_tr_b16 v[198:199], v251 offset:47520
    s_waitcnt lgkmcnt(8)
    v_mfma_f32_16x16x32_bf16 v[128:131], v[176:179], a[96:99], v[128:131]
    ds_read_b64_tr_b16 v[200:201], v251 offset:36640
    v_mfma_f32_16x16x32_bf16 v[128:131], v[180:183], a[104:107], v[128:131]
    ds_read_b64_tr_b16 v[202:203], v251 offset:40224
    s_add_u32 m0, s74, 136704
    s_add_u32 s51, s75, 393216
    v_mfma_f32_16x16x32_bf16 v[132:135], v[176:179], a[100:103], v[132:135]
    ds_read_b64_tr_b16 v[204:205], v251 offset:51232
    v_mfma_f32_16x16x32_bf16 v[132:135], v[180:183], a[108:111], v[132:135]
    ds_read_b64_tr_b16 v[206:207], v251 offset:54816
    buffer_load_dwordx4 v247, s[28:31], s51 offen offset:0 lds
    s_waitcnt lgkmcnt(8)
    v_mfma_f32_16x16x32_bf16 v[136:139], v[184:187], a[96:99], v[136:139]
    ds_read_b64_tr_b16 v[176:177], v220 offset:29376
    v_mfma_f32_16x16x32_bf16 v[136:139], v[188:191], a[104:107], v[136:139]
    ds_read_b64_tr_b16 v[178:179], v220 offset:32960
    buffer_load_dwordx4 v248, s[28:31], s51 offen offset:1024 lds
    v_mfma_f32_16x16x32_bf16 v[140:143], v[184:187], a[100:103], v[140:143]
    ds_read_b64_tr_b16 v[180:181], v220 offset:43968
    v_mfma_f32_16x16x32_bf16 v[140:143], v[188:191], a[108:111], v[140:143]
    ds_read_b64_tr_b16 v[182:183], v220 offset:47552
    s_waitcnt vmcnt(14)
    s_barrier
    s_waitcnt lgkmcnt(8)
    v_mfma_f32_16x16x32_bf16 v[144:147], v[192:195], a[96:99], v[144:147]
    ds_read_b64_tr_b16 v[184:185], v220 offset:36672
    v_mfma_f32_16x16x32_bf16 v[144:147], v[196:199], a[104:107], v[144:147]
    ds_read_b64_tr_b16 v[186:187], v220 offset:40256
    s_add_u32 m0, s74, 138752
    s_add_u32 s51, s75, 409600
    v_mfma_f32_16x16x32_bf16 v[148:151], v[192:195], a[100:103], v[148:151]
    ds_read_b64_tr_b16 v[188:189], v220 offset:51264
    v_mfma_f32_16x16x32_bf16 v[148:151], v[196:199], a[108:111], v[148:151]
    ds_read_b64_tr_b16 v[190:191], v220 offset:54848
    buffer_load_dwordx4 v247, s[28:31], s51 offen offset:0 lds
    s_waitcnt lgkmcnt(8)
    v_mfma_f32_16x16x32_bf16 v[152:155], v[200:203], a[96:99], v[152:155]
    ds_read_b64_tr_b16 v[192:193], v252 offset:0
    v_mfma_f32_16x16x32_bf16 v[152:155], v[204:207], a[104:107], v[152:155]
    ds_read_b64_tr_b16 v[194:195], v252 offset:3584
    buffer_load_dwordx4 v248, s[28:31], s51 offen offset:1024 lds
    v_mfma_f32_16x16x32_bf16 v[156:159], v[200:203], a[100:103], v[156:159]
    ds_read_b64_tr_b16 v[196:197], v252 offset:14592
    v_mfma_f32_16x16x32_bf16 v[156:159], v[204:207], a[108:111], v[156:159]
    ds_read_b64_tr_b16 v[198:199], v252 offset:18176
    s_waitcnt lgkmcnt(8)
    v_mfma_f32_16x16x32_bf16 v[160:163], v[176:179], a[96:99], v[160:163]
    ds_read_b64_tr_b16 v[200:201], v252 offset:7296
    v_mfma_f32_16x16x32_bf16 v[160:163], v[180:183], a[104:107], v[160:163]
    ds_read_b64_tr_b16 v[202:203], v252 offset:10880
    s_add_u32 m0, s74, 0
    s_add_u32 s51, s75, 65536
    v_mfma_f32_16x16x32_bf16 v[164:167], v[176:179], a[100:103], v[164:167]
    ds_read_b64_tr_b16 v[204:205], v252 offset:21888
    v_mfma_f32_16x16x32_bf16 v[164:167], v[180:183], a[108:111], v[164:167]
    ds_read_b64_tr_b16 v[206:207], v252 offset:25472
    buffer_load_dwordx4 v247, s[28:31], s51 offen offset:0 lds
    s_waitcnt lgkmcnt(8)
    v_mfma_f32_16x16x32_bf16 v[168:171], v[184:187], a[96:99], v[168:171]
    ds_read_b64_tr_b16 v[176:177], v252 offset:32
    v_mfma_f32_16x16x32_bf16 v[168:171], v[188:191], a[104:107], v[168:171]
    ds_read_b64_tr_b16 v[178:179], v252 offset:3616
    buffer_load_dwordx4 v248, s[28:31], s51 offen offset:1024 lds
    v_mfma_f32_16x16x32_bf16 v[172:175], v[184:187], a[100:103], v[172:175]
    ds_read_b64_tr_b16 v[180:181], v252 offset:14624
    v_mfma_f32_16x16x32_bf16 v[172:175], v[188:191], a[108:111], v[172:175]
    ds_read_b64_tr_b16 v[182:183], v252 offset:18208
    s_waitcnt lgkmcnt(8)
    v_mfma_f32_16x16x32_bf16 v[64:67], v[192:195], a[112:115], v[64:67]
    ds_read_b64_tr_b16 v[184:185], v252 offset:7328
    v_mfma_f32_16x16x32_bf16 v[64:67], v[196:199], a[120:123], v[64:67]
    ds_read_b64_tr_b16 v[186:187], v252 offset:10912
    s_add_u32 m0, s74, 2048
    s_add_u32 s51, s75, 81920
    v_mfma_f32_16x16x32_bf16 v[68:71], v[192:195], a[116:119], v[68:71]
    ds_read_b64_tr_b16 v[188:189], v252 offset:21920
    v_mfma_f32_16x16x32_bf16 v[68:71], v[196:199], a[124:127], v[68:71]
    ds_read_b64_tr_b16 v[190:191], v252 offset:25504
    buffer_load_dwordx4 v247, s[28:31], s51 offen offset:0 lds
    s_barrier
    s_waitcnt lgkmcnt(8)
    v_mfma_f32_16x16x32_bf16 v[72:75], v[200:203], a[112:115], v[72:75]
    ds_read_b64_tr_b16 v[192:193], v252 offset:64
    v_mfma_f32_16x16x32_bf16 v[72:75], v[204:207], a[120:123], v[72:75]
    ds_read_b64_tr_b16 v[194:195], v252 offset:3648
    buffer_load_dwordx4 v248, s[28:31], s51 offen offset:1024 lds
    v_mfma_f32_16x16x32_bf16 v[76:79], v[200:203], a[116:119], v[76:79]
    ds_read_b64_tr_b16 v[196:197], v252 offset:14656
    v_mfma_f32_16x16x32_bf16 v[76:79], v[204:207], a[124:127], v[76:79]
    ds_read_b64_tr_b16 v[198:199], v252 offset:18240
    s_waitcnt lgkmcnt(8)
    v_mfma_f32_16x16x32_bf16 v[80:83], v[176:179], a[112:115], v[80:83]
    ds_read_b64_tr_b16 v[200:201], v252 offset:7360
    v_mfma_f32_16x16x32_bf16 v[80:83], v[180:183], a[120:123], v[80:83]
    ds_read_b64_tr_b16 v[202:203], v252 offset:10944
    s_add_u32 m0, s74, 16384
    s_add_u32 s51, s75, 98304
    v_mfma_f32_16x16x32_bf16 v[84:87], v[176:179], a[116:119], v[84:87]
    ds_read_b64_tr_b16 v[204:205], v252 offset:21952
    v_mfma_f32_16x16x32_bf16 v[84:87], v[180:183], a[124:127], v[84:87]
    ds_read_b64_tr_b16 v[206:207], v252 offset:25536
    s_waitcnt lgkmcnt(8)
    v_mfma_f32_16x16x32_bf16 v[88:91], v[184:187], a[112:115], v[88:91]
    ds_read_b64_tr_b16 v[176:177], v252 offset:96
    v_mfma_f32_16x16x32_bf16 v[88:91], v[188:191], a[120:123], v[88:91]
    ds_read_b64_tr_b16 v[178:179], v252 offset:3680
    buffer_load_dwordx4 v247, s[28:31], s51 offen offset:0 lds
    v_mfma_f32_16x16x32_bf16 v[92:95], v[184:187], a[116:119], v[92:95]
    ds_read_b64_tr_b16 v[180:181], v252 offset:14688
    v_mfma_f32_16x16x32_bf16 v[92:95], v[188:191], a[124:127], v[92:95]
    ds_read_b64_tr_b16 v[182:183], v252 offset:18272
    s_waitcnt lgkmcnt(8)
    v_mfma_f32_16x16x32_bf16 v[96:99], v[192:195], a[112:115], v[96:99]
    ds_read_b64_tr_b16 v[184:185], v252 offset:7392
    v_mfma_f32_16x16x32_bf16 v[96:99], v[196:199], a[120:123], v[96:99]
    ds_read_b64_tr_b16 v[186:187], v252 offset:10976
    buffer_load_dwordx4 v248, s[28:31], s51 offen offset:1024 lds
    v_mfma_f32_16x16x32_bf16 v[100:103], v[192:195], a[116:119], v[100:103]
    ds_read_b64_tr_b16 v[188:189], v252 offset:21984
    v_mfma_f32_16x16x32_bf16 v[100:103], v[196:199], a[124:127], v[100:103]
    ds_read_b64_tr_b16 v[190:191], v252 offset:25568
    s_waitcnt lgkmcnt(8)
    v_mfma_f32_16x16x32_bf16 v[104:107], v[200:203], a[112:115], v[104:107]
    ds_read_b64_tr_b16 v[192:193], v252 offset:128
    v_mfma_f32_16x16x32_bf16 v[104:107], v[204:207], a[120:123], v[104:107]
    ds_read_b64_tr_b16 v[194:195], v252 offset:3712
    s_add_u32 m0, s74, 18432
    s_add_u32 s51, s75, 114688
    v_mfma_f32_16x16x32_bf16 v[108:111], v[200:203], a[116:119], v[108:111]
    ds_read_b64_tr_b16 v[196:197], v252 offset:14720
    v_mfma_f32_16x16x32_bf16 v[108:111], v[204:207], a[124:127], v[108:111]
    ds_read_b64_tr_b16 v[198:199], v252 offset:18304
    s_waitcnt lgkmcnt(8)
    v_mfma_f32_16x16x32_bf16 v[112:115], v[176:179], a[112:115], v[112:115]
    ds_read_b64_tr_b16 v[200:201], v252 offset:7424
    v_mfma_f32_16x16x32_bf16 v[112:115], v[180:183], a[120:123], v[112:115]
    ds_read_b64_tr_b16 v[202:203], v252 offset:11008
    buffer_load_dwordx4 v247, s[28:31], s51 offen offset:0 lds
    v_mfma_f32_16x16x32_bf16 v[116:119], v[176:179], a[116:119], v[116:119]
    ds_read_b64_tr_b16 v[204:205], v252 offset:22016
    v_mfma_f32_16x16x32_bf16 v[116:119], v[180:183], a[124:127], v[116:119]
    ds_read_b64_tr_b16 v[206:207], v252 offset:25600
    s_waitcnt lgkmcnt(8)
    v_mfma_f32_16x16x32_bf16 v[120:123], v[184:187], a[112:115], v[120:123]
    ds_read_b64_tr_b16 v[176:177], v252 offset:160
    v_mfma_f32_16x16x32_bf16 v[120:123], v[188:191], a[120:123], v[120:123]
    ds_read_b64_tr_b16 v[178:179], v252 offset:3744
    buffer_load_dwordx4 v248, s[28:31], s51 offen offset:1024 lds
    v_mfma_f32_16x16x32_bf16 v[124:127], v[184:187], a[116:119], v[124:127]
    ds_read_b64_tr_b16 v[180:181], v252 offset:14752
    v_mfma_f32_16x16x32_bf16 v[124:127], v[188:191], a[124:127], v[124:127]
    ds_read_b64_tr_b16 v[182:183], v252 offset:18336
    s_waitcnt lgkmcnt(8)
    v_mfma_f32_16x16x32_bf16 v[128:131], v[192:195], a[112:115], v[128:131]
    ds_read_b64_tr_b16 v[184:185], v252 offset:7456
    v_mfma_f32_16x16x32_bf16 v[128:131], v[196:199], a[120:123], v[128:131]
    ds_read_b64_tr_b16 v[186:187], v252 offset:11040
    s_add_u32 m0, s74, 32768
    s_add_u32 s51, s75, 196608
    v_mfma_f32_16x16x32_bf16 v[132:135], v[192:195], a[116:119], v[132:135]
    ds_read_b64_tr_b16 v[188:189], v252 offset:22048
    v_mfma_f32_16x16x32_bf16 v[132:135], v[196:199], a[124:127], v[132:135]
    ds_read_b64_tr_b16 v[190:191], v252 offset:25632
    s_waitcnt lgkmcnt(8)
    v_mfma_f32_16x16x32_bf16 v[136:139], v[200:203], a[112:115], v[136:139]
    ds_read_b64_tr_b16 v[192:193], v221 offset:192
    v_mfma_f32_16x16x32_bf16 v[136:139], v[204:207], a[120:123], v[136:139]
    ds_read_b64_tr_b16 v[194:195], v221 offset:3776
    buffer_load_dwordx4 v247, s[28:31], s51 offen offset:0 lds
    v_mfma_f32_16x16x32_bf16 v[140:143], v[200:203], a[116:119], v[140:143]
    ds_read_b64_tr_b16 v[196:197], v221 offset:14784
    v_mfma_f32_16x16x32_bf16 v[140:143], v[204:207], a[124:127], v[140:143]
    ds_read_b64_tr_b16 v[198:199], v221 offset:18368
    s_waitcnt lgkmcnt(8)
    v_mfma_f32_16x16x32_bf16 v[144:147], v[176:179], a[112:115], v[144:147]
    ds_read_b64_tr_b16 v[200:201], v221 offset:7488
    v_mfma_f32_16x16x32_bf16 v[144:147], v[180:183], a[120:123], v[144:147]
    ds_read_b64_tr_b16 v[202:203], v221 offset:11072
    buffer_load_dwordx4 v248, s[28:31], s51 offen offset:1024 lds
    v_mfma_f32_16x16x32_bf16 v[148:151], v[176:179], a[116:119], v[148:151]
    ds_read_b64_tr_b16 v[204:205], v221 offset:22080
    v_mfma_f32_16x16x32_bf16 v[148:151], v[180:183], a[124:127], v[148:151]
    ds_read_b64_tr_b16 v[206:207], v221 offset:25664
    s_waitcnt lgkmcnt(8)
    v_mfma_f32_16x16x32_bf16 v[152:155], v[184:187], a[112:115], v[152:155]
    v_mfma_f32_16x16x32_bf16 v[152:155], v[188:191], a[120:123], v[152:155]
    s_add_u32 m0, s74, 34816
    s_add_u32 s51, s75, 212992
    v_mfma_f32_16x16x32_bf16 v[156:159], v[184:187], a[116:119], v[156:159]
    v_mfma_f32_16x16x32_bf16 v[156:159], v[188:191], a[124:127], v[156:159]
    s_waitcnt lgkmcnt(4)
    v_mfma_f32_16x16x32_bf16 v[160:163], v[192:195], a[112:115], v[160:163]
    v_mfma_f32_16x16x32_bf16 v[160:163], v[196:199], a[120:123], v[160:163]
    buffer_load_dwordx4 v247, s[28:31], s51 offen offset:0 lds
    v_mfma_f32_16x16x32_bf16 v[164:167], v[192:195], a[116:119], v[164:167]
    v_mfma_f32_16x16x32_bf16 v[164:167], v[196:199], a[124:127], v[164:167]
    s_waitcnt lgkmcnt(0)
    v_mfma_f32_16x16x32_bf16 v[168:171], v[200:203], a[112:115], v[168:171]
    v_mfma_f32_16x16x32_bf16 v[168:171], v[204:207], a[120:123], v[168:171]
    buffer_load_dwordx4 v248, s[28:31], s51 offen offset:1024 lds
    v_mfma_f32_16x16x32_bf16 v[172:175], v[200:203], a[116:119], v[172:175]
    v_mfma_f32_16x16x32_bf16 v[172:175], v[204:207], a[124:127], v[172:175]
    s_barrier
    s_add_u32 s57, s56, 64
    v_pk_mul_f32 v[24:25], v[64:65], v[64:65]
    v_pk_mul_f32 v[26:27], v[66:67], v[66:67]
    v_pk_mul_f32 v[28:29], v[68:69], v[68:69]
    v_pk_mul_f32 v[30:31], v[70:71], v[70:71]
    v_pk_fma_f32 v[24:25], v[24:25], v[18:19], v[16:17] op_sel_hi:[1,0,0]
    v_pk_fma_f32 v[26:27], v[26:27], v[18:19], v[16:17] op_sel_hi:[1,0,0]
    v_pk_fma_f32 v[28:29], v[28:29], v[18:19], v[16:17] op_sel_hi:[1,0,0]
    v_pk_fma_f32 v[30:31], v[30:31], v[18:19], v[16:17] op_sel_hi:[1,0,0]
    v_pk_mul_f32 v[24:25], v[24:25], v[64:65]
    v_pk_mul_f32 v[26:27], v[26:27], v[66:67]
    v_pk_mul_f32 v[28:29], v[28:29], v[68:69]
    v_pk_mul_f32 v[30:31], v[30:31], v[70:71]
    s_add_u32 m0, s74, 49152
    s_add_u32 s51, s75, 294912
    buffer_load_dwordx4 v247, s[28:31], s51 offen offset:0 lds
    buffer_load_dwordx4 v248, s[28:31], s51 offen offset:1024 lds
    v_exp_f32 v24, v24
    v_exp_f32 v25, v25
    v_exp_f32 v26, v26
    v_exp_f32 v27, v27
    v_exp_f32 v28, v28
    v_exp_f32 v29, v29
    v_exp_f32 v30, v30
    v_exp_f32 v31, v31
    v_pk_mul_f32 v[72:73], v[72:73], v[64:65]
    v_pk_mul_f32 v[74:75], v[74:75], v[66:67]
    v_pk_mul_f32 v[76:77], v[76:77], v[68:69]
    v_pk_mul_f32 v[78:79], v[78:79], v[70:71]
    v_pk_add_f32 v[24:25], v[24:25], v[20:21] op_sel_hi:[1,0]
    v_pk_add_f32 v[26:27], v[26:27], v[20:21] op_sel_hi:[1,0]
    v_pk_add_f32 v[28:29], v[28:29], v[20:21] op_sel_hi:[1,0]
    v_pk_add_f32 v[30:31], v[30:31], v[20:21] op_sel_hi:[1,0]
    s_add_u32 m0, s74, 51200
    s_add_u32 s51, s75, 311296
    buffer_load_dwordx4 v247, s[28:31], s51 offen offset:0 lds
    buffer_load_dwordx4 v248, s[28:31], s51 offen offset:1024 lds
    v_rcp_f32 v24, v24
    v_rcp_f32 v25, v25
    v_rcp_f32 v26, v26
    v_rcp_f32 v27, v27
    v_rcp_f32 v28, v28
    v_rcp_f32 v29, v29
    v_rcp_f32 v30, v30
    v_rcp_f32 v31, v31
    s_nop 0
    v_pk_mul_f32 v[72:73], v[72:73], v[24:25]
    v_pk_mul_f32 v[74:75], v[74:75], v[26:27]
    v_pk_mul_f32 v[76:77], v[76:77], v[28:29]
    v_pk_mul_f32 v[78:79], v[78:79], v[30:31]
    v_cvt_pk_bf16_f32 v176, v72, v73
    v_cvt_pk_bf16_f32 v177, v74, v75
    v_cvt_pk_bf16_f32 v180, v76, v77
    v_cvt_pk_bf16_f32 v181, v78, v79
    v_pk_mul_f32 v[24:25], v[80:81], v[80:81]
    v_pk_mul_f32 v[26:27], v[82:83], v[82:83]
    v_pk_mul_f32 v[28:29], v[84:85], v[84:85]
    v_pk_mul_f32 v[30:31], v[86:87], v[86:87]
    v_pk_fma_f32 v[24:25], v[24:25], v[18:19], v[16:17] op_sel_hi:[1,0,0]
    v_pk_fma_f32 v[26:27], v[26:27], v[18:19], v[16:17] op_sel_hi:[1,0,0]
    v_pk_fma_f32 v[28:29], v[28:29], v[18:19], v[16:17] op_sel_hi:[1,0,0]
    v_pk_fma_f32 v[30:31], v[30:31], v[18:19], v[16:17] op_sel_hi:[1,0,0]
    v_pk_mul_f32 v[24:25], v[24:25], v[80:81]
    v_pk_mul_f32 v[26:27], v[26:27], v[82:83]
    v_pk_mul_f32 v[28:29], v[28:29], v[84:85]
    v_pk_mul_f32 v[30:31], v[30:31], v[86:87]
    s_add_u32 m0, s74, 65536
    s_add_u32 s51, s75, 327680
    buffer_load_dwordx4 v247, s[28:31], s51 offen offset:0 lds
    buffer_load_dwordx4 v248, s[28:31], s51 offen offset:1024 lds
    v_exp_f32 v24, v24
    v_exp_f32 v25, v25
    v_exp_f32 v26, v26
    v_exp_f32 v27, v27
    v_exp_f32 v28, v28
    v_exp_f32 v29, v29
    v_exp_f32 v30, v30
    v_exp_f32 v31, v31
    v_pk_mul_f32 v[88:89], v[88:89], v[80:81]
    v_pk_mul_f32 v[90:91], v[90:91], v[82:83]
    v_pk_mul_f32 v[92:93], v[92:93], v[84:85]
    v_pk_mul_f32 v[94:95], v[94:95], v[86:87]
    v_pk_add_f32 v[24:25], v[24:25], v[20:21] op_sel_hi:[1,0]
    v_pk_add_f32 v[26:27], v[26:27], v[20:21] op_sel_hi:[1,0]
    v_pk_add_f32 v[28:29], v[28:29], v[20:21] op_sel_hi:[1,0]
    v_pk_add_f32 v[30:31], v[30:31], v[20:21] op_sel_hi:[1,0]
    s_add_u32 m0, s74, 67584
    s_add_u32 s51, s75, 344064
    buffer_load_dwordx4 v247, s[28:31], s51 offen offset:0 lds
    buffer_load_dwordx4 v248, s[28:31], s51 offen offset:1024 lds
    v_rcp_f32 v24, v24
    v_rcp_f32 v25, v25
    v_rcp_f32 v26, v26
    v_rcp_f32 v27, v27
    v_rcp_f32 v28, v28
    v_rcp_f32 v29, v29
    v_rcp_f32 v30, v30
    v_rcp_f32 v31, v31
    s_nop 0
    v_pk_mul_f32 v[88:89], v[88:89], v[24:25]
    v_pk_mul_f32 v[90:91], v[90:91], v[26:27]
    v_pk_mul_f32 v[92:93], v[92:93], v[28:29]
    v_pk_mul_f32 v[94:95], v[94:95], v[30:31]
    v_cvt_pk_bf16_f32 v178, v88, v89
    v_cvt_pk_bf16_f32 v179, v90, v91
    v_cvt_pk_bf16_f32 v182, v92, v93
    v_cvt_pk_bf16_f32 v183, v94, v95
    s_cmp_eq_u32 s48, 0
    s_cbranch_scc1 L_slow_46
    buffer_store_dwordx4 v[176:179], v2, s[4:7], s52 offen offset:0
    buffer_store_dwordx4 v[180:183], v2, s[4:7], s53 offen offset:0
L_st_47:
    v_pk_mul_f32 v[24:25], v[96:97], v[96:97]
    v_pk_mul_f32 v[26:27], v[98:99], v[98:99]
    v_pk_mul_f32 v[28:29], v[100:101], v[100:101]
    v_pk_mul_f32 v[30:31], v[102:103], v[102:103]
    v_pk_fma_f32 v[24:25], v[24:25], v[18:19], v[16:17] op_sel_hi:[1,0,0]
    v_pk_fma_f32 v[26:27], v[26:27], v[18:19], v[16:17] op_sel_hi:[1,0,0]
    v_pk_fma_f32 v[28:29], v[28:29], v[18:19], v[16:17] op_sel_hi:[1,0,0]
    v_pk_fma_f32 v[30:31], v[30:31], v[18:19], v[16:17] op_sel_hi:[1,0,0]
    v_pk_mul_f32 v[24:25], v[24:25], v[96:97]
    v_pk_mul_f32 v[26:27], v[26:27], v[98:99]
    v_pk_mul_f32 v[28:29], v[28:29], v[100:101]
    v_pk_mul_f32 v[30:31], v[30:31], v[102:103]
    v_exp_f32 v24, v24
    v_exp_f32 v25, v25
    v_exp_f32 v26, v26
    v_exp_f32 v27, v27
    v_exp_f32 v28, v28
    v_exp_f32 v29, v29
    v_exp_f32 v30, v30
    v_exp_f32 v31, v31
    v_pk_mul_f32 v[104:105], v[104:105], v[96:97]
    v_pk_mul_f32 v[106:107], v[106:107], v[98:99]
    v_pk_mul_f32 v[108:109], v[108:109], v[100:101]
    v_pk_mul_f32 v[110:111], v[110:111], v[102:103]
    v_pk_add_f32 v[24:25], v[24:25], v[20:21] op_sel_hi:[1,0]
    v_pk_add_f32 v[26:27], v[26:27], v[20:21] op_sel_hi:[1,0]
    v_pk_add_f32 v[28:29], v[28:29], v[20:21] op_sel_hi:[1,0]
    v_pk_add_f32 v[30:31], v[30:31], v[20:21] op_sel_hi:[1,0]
    v_rcp_f32 v24, v24
    v_rcp_f32 v25, v25
    v_rcp_f32 v26, v26
    v_rcp_f32 v27, v27
    v_rcp_f32 v28, v28
    v_rcp_f32 v29, v29
    v_rcp_f32 v30, v30
    v_rcp_f32 v31, v31
    s_nop 0
    v_pk_mul_f32 v[104:105], v[104:105], v[24:25]
    v_pk_mul_f32 v[106:107], v[106:107], v[26:27]
    v_pk_mul_f32 v[108:109], v[108:109], v[28:29]
    v_pk_mul_f32 v[110:111], v[110:111], v[30:31]
    v_cvt_pk_bf16_f32 v184, v104, v105
    v_cvt_pk_bf16_f32 v185, v106, v107
    v_cvt_pk_bf16_f32 v188, v108, v109
    v_cvt_pk_bf16_f32 v189, v110, v111
    v_pk_mul_f32 v[24:25], v[112:113], v[112:113]
    v_pk_mul_f32 v[26:27], v[114:115], v[114:115]
    v_pk_mul_f32 v[28:29], v[116:117], v[116:117]
    v_pk_mul_f32 v[30:31], v[118:119], v[118:119]
    v_pk_fma_f32 v[24:25], v[24:25], v[18:19], v[16:17] op_sel_hi:[1,0,0]
    v_pk_fma_f32 v[26:27], v[26:27], v[18:19], v[16:17] op_sel_hi:[1,0,0]
    v_pk_fma_f32 v[28:29], v[28:29], v[18:19], v[16:17] op_sel_hi:[1,0,0]
    v_pk_fma_f32 v[30:31], v[30:31], v[18:19], v[16:17] op_sel_hi:[1,0,0]
    v_pk_mul_f32 v[24:25], v[24:25], v[112:113]
    v_pk_mul_f32 v[26:27], v[26:27], v[114:115]
    v_pk_mul_f32 v[28:29], v[28:29], v[116:117]
    v_pk_mul_f32 v[30:31], v[30:31], v[118:119]
    v_exp_f32 v24, v24
    v_exp_f32 v25, v25
    v_exp_f32 v26, v26
    v_exp_f32 v27, v27
    v_exp_f32 v28, v28
    v_exp_f32 v29, v29
    v_exp_f32 v30, v30
    v_exp_f32 v31, v31
    v_pk_mul_f32 v[120:121], v[120:121], v[112:113]
    v_pk_mul_f32 v[122:123], v[122:123], v[114:115]
    v_pk_mul_f32 v[124:125], v[124:125], v[116:117]
    v_pk_mul_f32 v[126:127], v[126:127], v[118:119]
    v_pk_add_f32 v[24:25], v[24:25], v[20:21] op_sel_hi:[1,0]
    v_pk_add_f32 v[26:27], v[26:27], v[20:21] op_sel_hi:[1,0]
    v_pk_add_f32 v[28:29], v[28:29], v[20:21] op_sel_hi:[1,0]
    v_pk_add_f32 v[30:31], v[30:31], v[20:21] op_sel_hi:[1,0]
    v_rcp_f32 v24, v24
    v_rcp_f32 v25, v25
    v_rcp_f32 v26, v26
    v_rcp_f32 v27, v27
    v_rcp_f32 v28, v28
    v_rcp_f32 v29, v29
    v_rcp_f32 v30, v30
    v_rcp_f32 v31, v31
    s_nop 0
    v_pk_mul_f32 v[120:121], v[120:121], v[24:25]
    v_pk_mul_f32 v[122:123], v[122:123], v[26:27]
    v_pk_mul_f32 v[124:125], v[124:125], v[28:29]
    v_pk_mul_f32 v[126:127], v[126:127], v[30:31]
    v_cvt_pk_bf16_f32 v186, v120, v121
    v_cvt_pk_bf16_f32 v187, v122, v123
    v_cvt_pk_bf16_f32 v190, v124, v125
    v_cvt_pk_bf16_f32 v191, v126, v127
    s_cmp_eq_u32 s48, 0
    s_cbranch_scc1 L_slow_48
    buffer_store_dwordx4 v[184:187], v2, s[4:7], s52 offen offset:1024
    buffer_store_dwordx4 v[188:191], v2, s[4:7], s53 offen offset:1024
L_st_49:
    v_pk_mul_f32 v[24:25], v[128:129], v[128:129]
    v_pk_mul_f32 v[26:27], v[130:131], v[130:131]
    v_pk_mul_f32 v[28:29], v[132:133], v[132:133]
    v_pk_mul_f32 v[30:31], v[134:135], v[134:135]
    v_pk_fma_f32 v[24:25], v[24:25], v[18:19], v[16:17] op_sel_hi:[1,0,0]
    v_pk_fma_f32 v[26:27], v[26:27], v[18:19], v[16:17] op_sel_hi:[1,0,0]
    v_pk_fma_f32 v[28:29], v[28:29], v[18:19], v[16:17] op_sel_hi:[1,0,0]
    v_pk_fma_f32 v[30:31], v[30:31], v[18:19], v[16:17] op_sel_hi:[1,0,0]
    v_pk_mul_f32 v[24:25], v[24:25], v[128:129]
    v_pk_mul_f32 v[26:27], v[26:27], v[130:131]
    v_pk_mul_f32 v[28:29], v[28:29], v[132:133]
    v_pk_mul_f32 v[30:31], v[30:31], v[134:135]
    v_exp_f32 v24, v24
    v_exp_f32 v25, v25
    v_exp_f32 v26, v26
    v_exp_f32 v27, v27
    v_exp_f32 v28, v28
    v_exp_f32 v29, v29
    v_exp_f32 v30, v30
    v_exp_f32 v31, v31
    v_pk_mul_f32 v[136:137], v[136:137], v[128:129]
    v_pk_mul_f32 v[138:139], v[138:139], v[130:131]
    v_pk_mul_f32 v[140:141], v[140:141], v[132:133]
    v_pk_mul_f32 v[142:143], v[142:143], v[134:135]
    v_pk_add_f32 v[24:25], v[24:25], v[20:21] op_sel_hi:[1,0]
    v_pk_add_f32 v[26:27], v[26:27], v[20:21] op_sel_hi:[1,0]
    v_pk_add_f32 v[28:29], v[28:29], v[20:21] op_sel_hi:[1,0]
    v_pk_add_f32 v[30:31], v[30:31], v[20:21] op_sel_hi:[1,0]
    v_rcp_f32 v24, v24
    v_rcp_f32 v25, v25
    v_rcp_f32 v26, v26
    v_rcp_f32 v27, v27
    v_rcp_f32 v28, v28
    v_rcp_f32 v29, v29
    v_rcp_f32 v30, v30
    v_rcp_f32 v31, v31
    s_nop 0
    v_pk_mul_f32 v[136:137], v[136:137], v[24:25]
    v_pk_mul_f32 v[138:139], v[138:139], v[26:27]
    v_pk_mul_f32 v[140:141], v[140:141], v[28:29]
    v_pk_mul_f32 v[142:143], v[142:143], v[30:31]
    v_cvt_pk_bf16_f32 v192, v136, v137
    v_cvt_pk_bf16_f32 v193, v138, v139
    v_cvt_pk_bf16_f32 v196, v140, v141
    v_cvt_pk_bf16_f32 v197, v142, v143
    s_cmp_eq_u32 s48, 0
    s_cbranch_scc1 L_slow_50
    s_waitcnt vmcnt(0)
    buffer_store_dword v5, off, s[4:7], s56
L_st_51:
    v_pk_mul_f32 v[24:25], v[144:145], v[144:145]
    v_pk_mul_f32 v[26:27], v[146:147], v[146:147]
    v_pk_mul_f32 v[28:29], v[148:149], v[148:149]
    v_pk_mul_f32 v[30:31], v[150:151], v[150:151]
    v_pk_fma_f32 v[24:25], v[24:25], v[18:19], v[16:17] op_sel_hi:[1,0,0]
    v_pk_fma_f32 v[26:27], v[26:27], v[18:19], v[16:17] op_sel_hi:[1,0,0]
    v_pk_fma_f32 v[28:29], v[28:29], v[18:19], v[16:17] op_sel_hi:[1,0,0]
    v_pk_fma_f32 v[30:31], v[30:31], v[18:19], v[16:17] op_sel_hi:[1,0,0]
    v_pk_mul_f32 v[24:25], v[24:25], v[144:145]
    v_pk_mul_f32 v[26:27], v[26:27], v[146:147]
    v_pk_mul_f32 v[28:29], v[28:29], v[148:149]
    v_pk_mul_f32 v[30:31], v[30:31], v[150:151]
    v_exp_f32 v24, v24
    v_exp_f32 v25, v25
    v_exp_f32 v26, v26
    v_exp_f32 v27, v27
    v_exp_f32 v28, v28
    v_exp_f32 v29, v29
    v_exp_f32 v30, v30
    v_exp_f32 v31, v31
    v_pk_mul_f32 v[152:153], v[152:153], v[144:145]
    v_pk_mul_f32 v[154:155], v[154:155], v[146:147]
    v_pk_mul_f32 v[156:157], v[156:157], v[148:149]
    v_pk_mul_f32 v[158:159], v[158:159], v[150:151]
    v_pk_add_f32 v[24:25], v[24:25], v[20:21] op_sel_hi:[1,0]
    v_pk_add_f32 v[26:27], v[26:27], v[20:21] op_sel_hi:[1,0]
    v_pk_add_f32 v[28:29], v[28:29], v[20:21] op_sel_hi:[1,0]
    v_pk_add_f32 v[30:31], v[30:31], v[20:21] op_sel_hi:[1,0]
    v_rcp_f32 v24, v24
    v_rcp_f32 v25, v25
    v_rcp_f32 v26, v26
    v_rcp_f32 v27, v27
    v_rcp_f32 v28, v28
    v_rcp_f32 v29, v29
    v_rcp_f32 v30, v30
    v_rcp_f32 v31, v31
    s_nop 0
    v_pk_mul_f32 v[152:153], v[152:153], v[24:25]
    v_pk_mul_f32 v[154:155], v[154:155], v[26:27]
    v_pk_mul_f32 v[156:157], v[156:157], v[28:29]
    v_pk_mul_f32 v[158:159], v[158:159], v[30:31]
    v_cvt_pk_bf16_f32 v194, v152, v153
    v_cvt_pk_bf16_f32 v195, v154, v155
    v_cvt_pk_bf16_f32 v198, v156, v157
    v_cvt_pk_bf16_f32 v199, v158, v159
    s_cmp_eq_u32 s48, 0
    s_cbranch_scc1 L_slow_52
    buffer_store_dwordx4 v[192:195], v2, s[4:7], s52 offen offset:2048
    buffer_store_dwordx4 v[196:199], v2, s[4:7], s53 offen offset:2048
L_st_53:
    buffer_load_dword v9, v7, s[4:7], s59 offen sc1
    v_pk_mul_f32 v[24:25], v[160:161], v[160:161]
    v_pk_mul_f32 v[26:27], v[162:163], v[162:163]
    v_pk_mul_f32 v[28:29], v[164:165], v[164:165]
    v_pk_mul_f32 v[30:31], v[166:167], v[166:167]
    v_pk_fma_f32 v[24:25], v[24:25], v[18:19], v[16:17] op_sel_hi:[1,0,0]
    v_pk_fma_f32 v[26:27], v[26:27], v[18:19], v[16:17] op_sel_hi:[1,0,0]
    v_pk_fma_f32 v[28:29], v[28:29], v[18:19], v[16:17] op_sel_hi:[1,0,0]
    v_pk_fma_f32 v[30:31], v[30:31], v[18:19], v[16:17] op_sel_hi:[1,0,0]
    v_pk_mul_f32 v[24:25], v[24:25], v[160:161]
    v_pk_mul_f32 v[26:27], v[26:27], v[162:163]
    v_pk_mul_f32 v[28:29], v[28:29], v[164:165]
    v_pk_mul_f32 v[30:31], v[30:31], v[166:167]
    v_exp_f32 v24, v24
    v_exp_f32 v25, v25
    v_exp_f32 v26, v26
    v_exp_f32 v27, v27
    v_exp_f32 v28, v28
    v_exp_f32 v29, v29
    v_exp_f32 v30, v30
    v_exp_f32 v31, v31
    v_pk_mul_f32 v[168:169], v[168:169], v[160:161]
    v_pk_mul_f32 v[170:171], v[170:171], v[162:163]
    v_pk_mul_f32 v[172:173], v[172:173], v[164:165]
    v_pk_mul_f32 v[174:175], v[174:175], v[166:167]
    v_pk_add_f32 v[24:25], v[24:25], v[20:21] op_sel_hi:[1,0]
    v_pk_add_f32 v[26:27], v[26:27], v[20:21] op_sel_hi:[1,0]
    v_pk_add_f32 v[28:29], v[28:29], v[20:21] op_sel_hi:[1,0]
    v_pk_add_f32 v[30:31], v[30:31], v[20:21] op_sel_hi:[1,0]
    v_rcp_f32 v24, v24
    v_rcp_f32 v25, v25
    v_rcp_f32 v26, v26
    v_rcp_f32 v27, v27
    v_rcp_f32 v28, v28
    v_rcp_f32 v29, v29
    v_rcp_f32 v30, v30
    v_rcp_f32 v31, v31
    s_nop 0
    v_pk_mul_f32 v[168:169], v[168:169], v[24:25]
    v_pk_mul_f32 v[170:171], v[170:171], v[26:27]
    v_pk_mul_f32 v[172:173], v[172:173], v[28:29]
    v_pk_mul_f32 v[174:175], v[174:175], v[30:31]
    v_cvt_pk_bf16_f32 v200, v168, v169
    v_cvt_pk_bf16_f32 v201, v170, v171
    v_cvt_pk_bf16_f32 v204, v172, v173
    v_cvt_pk_bf16_f32 v205, v174, v175
    s_cmp_eq_u32 s48, 0
    s_cbranch_scc1 L_slow_54
    buffer_store_dwordx2 v[200:201], v2, s[4:7], s72 offen
    buffer_store_dwordx2 v[204:205], v2, s[4:7], s73 offen
L_st_55:
    s_xor_b32 s58, s63, 0
    s_mul_i32 s53, s58, 57344
    s_mul_i32 s3, s46, 14336
    s_add_u32 s53, s53, s3
    s_add_u32 s53, s53, 13631488
    s_xor_b32 s58, s63, 1
    s_mul_i32 s54, s58, 57344
    s_mul_i32 s3, s46, 14336
    s_add_u32 s54, s54, s3
    s_add_u32 s54, s54, 13631488
    s_xor_b32 s58, s63, 2
    s_mul_i32 s55, s58, 57344
    s_mul_i32 s3, s46, 14336
    s_add_u32 s55, s55, s3
    s_add_u32 s55, s55, 13631488
    s_xor_b32 s58, s63, 3
    s_mul_i32 s56, s58, 57344
    s_mul_i32 s3, s46, 14336
    s_add_u32 s56, s56, s3
    s_add_u32 s56, s56, 13631488
    s_mov_b32 s50, 0x80000
    s_waitcnt vmcnt(2)
    v_cmp_ne_u32 vcc, s47, v9
    s_cbranch_vccnz L_retry_56
L_got_57:
    buffer_load_dwordx4 a[0:3], v2, s[4:7], s53 offen offset:0 sc1
    buffer_load_dwordx4 a[16:19], v2, s[4:7], s53 offen offset:1024 sc1
    buffer_load_dwordx4 a[4:7], v2, s[4:7], s54 offen offset:0 sc1
    buffer_load_dwordx4 a[20:23], v2, s[4:7], s54 offen offset:1024 sc1
    buffer_load_dwordx4 a[8:11], v2, s[4:7], s55 offen offset:0 sc1
    buffer_load_dwordx4 a[24:27], v2, s[4:7], s55 offen offset:1024 sc1
    buffer_load_dwordx4 a[12:15], v2, s[4:7], s56 offen offset:0 sc1
    buffer_load_dwordx4 a[28:31], v2, s[4:7], s56 offen offset:1024 sc1
    s_add_u32 s53, s53, 4096
    buffer_load_dwordx4 a[32:35], v2, s[4:7], s53 offen offset:0 sc1
    buffer_load_dwordx4 a[48:51], v2, s[4:7], s53 offen offset:1024 sc1
    ds_read_b128 v[40:43], v250 offset:768
    ds_read_b128 v[44:47], v250 offset:832
    ds_read_b128 v[48:51], v250 offset:896
    ds_read_b128 v[52:55], v250 offset:960
    v_lshlrev_b32 v16, 16, v232
    v_and_b32 v17, 0xffff0000, v232
    v_lshlrev_b32 v18, 16, v233
    v_and_b32 v19, 0xffff0000, v233
    v_lshlrev_b32 v20, 16, v234
    v_and_b32 v21, 0xffff0000, v234
    v_lshlrev_b32 v22, 16, v235
    v_and_b32 v23, 0xffff0000, v235
    v_lshlrev_b32 v24, 16, v236
    v_and_b32 v25, 0xffff0000, v236
    v_lshlrev_b32 v26, 16, v237
    v_and_b32 v27, 0xffff0000, v237
    v_lshlrev_b32 v28, 16, v238
    v_and_b32 v29, 0xffff0000, v238
    v_lshlrev_b32 v30, 16, v239
    v_and_b32 v31, 0xffff0000, v239
    v_add_u32 v242, s74, v2
    v_xor_b32 v243, 8192, v242
    v_xor_b32 v244, 4096, v242
    v_xor_b32 v245, 12288, v242
    v_and_b32 v246, 15, v1
    v_lshlrev_b32 v246, 10, v246
    v_bfe_u32 v6, v1, 4, 1
    v_lshl_add_u32 v246, v6, 5, v246
    v_lshrrev_b32 v6, 5, v1
    v_lshl_add_u32 v246, v6, 4, v246
    s_waitcnt vmcnt(10)
    s_cmp_eq_u32 s48, 0
    s_cbranch_scc1 L_slow_58
    buffer_store_dword v5, off, s[4:7], s57
L_st_59:
    s_waitcnt vmcnt(9)
    v_mfma_f32_16x16x32_bf16 v[64:67], a[192:195], a[0:3], 0
    s_add_u32 s54, s54, 4096
    buffer_load_dwordx4 a[36:39], v2, s[4:7], s54 offen offset:0 sc1
    v_mfma_f32_16x16x32_bf16 v[64:67], a[208:211], a[16:19], v[64:67]
    v_mfma_f32_16x16x32_bf16 v[68:71], a[196:199], a[0:3], 0
    v_mfma_f32_16x16x32_bf16 v[68:71], a[212:215], a[16:19], v[68:71]
    v_mfma_f32_16x16x32_bf16 v[72:75], a[200:203], a[0:3], 0
    buffer_load_dwordx4 a[52:55], v2, s[4:7], s54 offen offset:1024 sc1
    v_mfma_f32_16x16x32_bf16 v[72:75], a[216:219], a[16:19], v[72:75]
    v_mfma_f32_16x16x32_bf16 v[76:79], a[204:207], a[0:3], 0
    v_mfma_f32_16x16x32_bf16 v[76:79], a[220:223], a[16:19], v[76:79]
    s_waitcnt vmcnt(9)
    v_mfma_f32_16x16x32_bf16 v[80:83], a[192:195], a[4:7], 0
    s_add_u32 s55, s55, 4096
    buffer_load_dwordx4 a[40:43], v2, s[4:7], s55 offen offset:0 sc1
    v_mfma_f32_16x16x32_bf16 v[80:83], a[208:211], a[20:23], v[80:83]
    v_mfma_f32_16x16x32_bf16 v[84:87], a[196:199], a[4:7], 0
    v_mfma_f32_16x16x32_bf16 v[84:87], a[212:215], a[20:23], v[84:87]
    v_mfma_f32_16x16x32_bf16 v[88:91], a[200:203], a[4:7], 0
    buffer_load_dwordx4 a[56:59], v2, s[4:7], s55 offen offset:1024 sc1
    v_mfma_f32_16x16x32_bf16 v[88:91], a[216:219], a[20:23], v[88:91]
    v_mfma_f32_16x16x32_bf16 v[92:95], a[204:207], a[4:7], 0
    v_mfma_f32_16x16x32_bf16 v[92:95], a[220:223], a[20:23], v[92:95]
    s_waitcnt vmcnt(9)
    v_mfma_f32_16x16x32_bf16 v[96:99], a[192:195], a[8:11], 0
    s_add_u32 s56, s56, 4096
    buffer_load_dwordx4 a[44:47], v2, s[4:7], s56 offen offset:0 sc1
    v_mfma_f32_16x16x32_bf16 v[96:99], a[208:211], a[24:27], v[96:99]
    v_mfma_f32_16x16x32_bf16 v[100:103], a[196:199], a[8:11], 0
    v_mfma_f32_16x16x32_bf16 v[100:103], a[212:215], a[24:27], v[100:103]
    v_mfma_f32_16x16x32_bf16 v[104:107], a[200:203], a[8:11], 0
    buffer_load_dwordx4 a[60:63], v2, s[4:7], s56 offen offset:1024 sc1
    v_mfma_f32_16x16x32_bf16 v[104:107], a[216:219], a[24:27], v[104:107]
    v_mfma_f32_16x16x32_bf16 v[108:111], a[204:207], a[8:11], 0
    v_mfma_f32_16x16x32_bf16 v[108:111], a[220:223], a[24:27], v[108:111]
    s_waitcnt vmcnt(9)
    v_mfma_f32_16x16x32_bf16 v[112:115], a[192:195], a[12:15], 0
    buffer_load_dwordx4 a[64:67], v2, s[4:7], s53 offen offset:3072 sc1
    v_mfma_f32_16x16x32_bf16 v[112:115], a[208:211], a[28:31], v[112:115]
    v_mfma_f32_16x16x32_bf16 v[116:119], a[196:199], a[12:15], 0
    v_mfma_f32_16x16x32_bf16 v[116:119], a[212:215], a[28:31], v[116:119]
    v_mfma_f32_16x16x32_bf16 v[120:123], a[200:203], a[12:15], 0
    s_add_u32 s53, s53, 4096
    buffer_load_dwordx4 a[80:83], v2, s[4:7], s53 offen offset:0 sc1
    v_mfma_f32_16x16x32_bf16 v[120:123], a[216:219], a[28:31], v[120:123]
    v_mfma_f32_16x16x32_bf16 v[124:127], a[204:207], a[12:15], 0
    v_mfma_f32_16x16x32_bf16 v[124:127], a[220:223], a[28:31], v[124:127]
    s_waitcnt vmcnt(9)
    v_mfma_f32_16x16x32_bf16 v[64:67], a[224:227], a[32:35], v[64:67]
    buffer_load_dwordx4 a[68:71], v2, s[4:7], s54 offen offset:3072 sc1
    v_mfma_f32_16x16x32_bf16 v[64:67], a[240:243], a[48:51], v[64:67]
    v_mfma_f32_16x16x32_bf16 v[68:71], a[228:231], a[32:35], v[68:71]
    ds_read_b64_tr_b16 v[128:129], v212 offset:22016
    ds_read_b64_tr_b16 v[130:131], v212 offset:24064
    v_mfma_f32_16x16x32_bf16 v[68:71], a[244:247], a[48:51], v[68:71]
    v_mfma_f32_16x16x32_bf16 v[72:75], a[232:235], a[32:35], v[72:75]
    s_add_u32 s54, s54, 4096
    buffer_load_dwordx4 a[84:87], v2, s[4:7], s54 offen offset:0 sc1
    v_mfma_f32_16x16x32_bf16 v[72:75], a[248:251], a[48:51], v[72:75]
    v_mfma_f32_16x16x32_bf16 v[76:79], a[236:239], a[32:35], v[76:79]
    ds_read_b64_tr_b16 v[132:133], v213 offset:22016
    ds_read_b64_tr_b16 v[134:135], v213 offset:24064
    v_mfma_f32_16x16x32_bf16 v[76:79], a[252:255], a[48:51], v[76:79]
    s_waitcnt vmcnt(8)
    v_mfma_f32_16x16x32_bf16 v[80:83], a[224:227], a[36:39], v[80:83]
    buffer_load_dwordx4 a[72:75], v2, s[4:7], s55 offen offset:3072 sc1
    v_mfma_f32_16x16x32_bf16 v[80:83], a[240:243], a[52:55], v[80:83]
    v_mfma_f32_16x16x32_bf16 v[84:87], a[228:231], a[36:39], v[84:87]
    ds_read_b64_tr_b16 v[136:137], v214 offset:22016
    ds_read_b64_tr_b16 v[138:139], v214 offset:24064
    v_mfma_f32_16x16x32_bf16 v[84:87], a[244:247], a[52:55], v[84:87]
    v_mfma_f32_16x16x32_bf16 v[88:91], a[232:235], a[36:39], v[88:91]
    s_add_u32 s55, s55, 4096
    buffer_load_dwordx4 a[88:91], v2, s[4:7], s55 offen offset:0 sc1
    v_mfma_f32_16x16x32_bf16 v[88:91], a[248:251], a[52:55], v[88:91]
    v_mfma_f32_16x16x32_bf16 v[92:95], a[236:239], a[36:39], v[92:95]
    ds_read_b64_tr_b16 v[140:141], v215 offset:22016
    ds_read_b64_tr_b16 v[142:143], v215 offset:24064
    v_mfma_f32_16x16x32_bf16 v[92:95], a[252:255], a[52:55], v[92:95]
    s_waitcnt vmcnt(8)
    v_mfma_f32_16x16x32_bf16 v[96:99], a[224:227], a[40:43], v[96:99]
    buffer_load_dwordx4 a[76:79], v2, s[4:7], s56 offen offset:3072 sc1
    v_mfma_f32_16x16x32_bf16 v[96:99], a[240:243], a[56:59], v[96:99]
    v_mfma_f32_16x16x32_bf16 v[100:103], a[228:231], a[40:43], v[100:103]
    ds_read_b64_tr_b16 v[144:145], v212 offset:38400
    ds_read_b64_tr_b16 v[146:147], v212 offset:40448
    v_mfma_f32_16x16x32_bf16 v[100:103], a[244:247], a[56:59], v[100:103]
    v_mfma_f32_16x16x32_bf16 v[104:107], a[232:235], a[40:43], v[104:107]
    s_add_u32 s56, s56, 4096
    buffer_load_dwordx4 a[92:95], v2, s[4:7], s56 offen offset:0 sc1
    v_mfma_f32_16x16x32_bf16 v[104:107], a[248:251], a[56:59], v[104:107]
    v_mfma_f32_16x16x32_bf16 v[108:111], a[236:239], a[40:43], v[108:111]
    ds_read_b64_tr_b16 v[148:149], v213 offset:38400
    ds_read_b64_tr_b16 v[150:151], v213 offset:40448
    v_mfma_f32_16x16x32_bf16 v[108:111], a[252:255], a[56:59], v[108:111]
    s_waitcnt vmcnt(8)
    v_mfma_f32_16x16x32_bf16 v[112:115], a[224:227], a[44:47], v[112:115]
    buffer_load_dwordx4 a[96:99], v2, s[4:7], s53 offen offset:3072 sc1
    s_add_u32 s57, s59, 64
    buffer_load_dword v8, v7, s[4:7], s57 offen sc1
    v_mfma_f32_16x16x32_bf16 v[112:115], a[240:243], a[60:63], v[112:115]
    v_mfma_f32_16x16x32_bf16 v[116:119], a[228:231], a[44:47], v[116:119]
    ds_read_b64_tr_b16 v[152:153], v214 offset:38400
    ds_read_b64_tr_b16 v[154:155], v214 offset:40448
    v_mfma_f32_16x16x32_bf16 v[116:119], a[244:247], a[60:63], v[116:119]
    v_mfma_f32_16x16x32_bf16 v[120:123], a[232:235], a[44:47], v[120:123]
    s_add_u32 s53, s53, 4096
    buffer_load_dwordx4 a[112:115], v2, s[4:7], s53 offen offset:0 sc1
    v_mfma_f32_16x16x32_bf16 v[120:123], a[248:251], a[60:63], v[120:123]
    v_mfma_f32_16x16x32_bf16 v[124:127], a[236:239], a[44:47], v[124:127]
    ds_read_b64_tr_b16 v[156:157], v215 offset:38400
    ds_read_b64_tr_b16 v[158:159], v215 offset:40448
    v_mfma_f32_16x16x32_bf16 v[124:127], a[252:255], a[60:63], v[124:127]
    s_waitcnt lgkmcnt(0)
    s_waitcnt vmcnt(9)
    v_mfma_f32_16x16x32_bf16 v[64:67], v[128:131], a[64:67], v[64:67]
    buffer_load_dwordx4 a[100:103], v2, s[4:7], s54 offen offset:3072 sc1
    v_mfma_f32_16x16x32_bf16 v[64:67], v[144:147], a[80:83], v[64:67]
    v_mfma_f32_16x16x32_bf16 v[68:71], v[132:135], a[64:67], v[68:71]
    ds_read_b64_tr_b16 v[160:161], v212 offset:54784
    ds_read_b64_tr_b16 v[162:163], v212 offset:56832
    v_mfma_f32_16x16x32_bf16 v[68:71], v[148:151], a[80:83], v[68:71]
    v_mfma_f32_16x16x32_bf16 v[72:75], v[136:139], a[64:67], v[72:75]
    s_add_u32 s54, s54, 4096
    buffer_load_dwordx4 a[116:119], v2, s[4:7], s54 offen offset:0 sc1
    v_mfma_f32_16x16x32_bf16 v[72:75], v[152:155], a[80:83], v[72:75]
    v_mfma_f32_16x16x32_bf16 v[76:79], v[140:143], a[64:67], v[76:79]
    ds_read_b64_tr_b16 v[164:165], v213 offset:54784
    ds_read_b64_tr_b16 v[166:167], v213 offset:56832
    v_mfma_f32_16x16x32_bf16 v[76:79], v[156:159], a[80:83], v[76:79]
    s_waitcnt vmcnt(9)
    v_mfma_f32_16x16x32_bf16 v[80:83], v[128:131], a[68:71], v[80:83]
    buffer_load_dwordx4 a[104:107], v2, s[4:7], s55 offen offset:3072 sc1
    v_mfma_f32_16x16x32_bf16 v[80:83], v[144:147], a[84:87], v[80:83]
    v_mfma_f32_16x16x32_bf16 v[84:87], v[132:135], a[68:71], v[84:87]
    ds_read_b64_tr_b16 v[168:169], v214 offset:54784
    ds_read_b64_tr_b16 v[170:171], v214 offset:56832
    v_mfma_f32_16x16x32_bf16 v[84:87], v[148:151], a[84:87], v[84:87]
    v_mfma_f32_16x16x32_bf16 v[88:91], v[136:139], a[68:71], v[88:91]
    s_add_u32 s55, s55, 4096
    buffer_load_dwordx4 a[120:123], v2, s[4:7], s55 offen offset:0 sc1
    v_mfma_f32_16x16x32_bf16 v[88:91], v[152:155], a[84:87], v[88:91]
    v_mfma_f32_16x16x32_bf16 v[92:95], v[140:143], a[68:71], v[92:95]
    ds_read_b64_tr_b16 v[172:173], v215 offset:54784
    ds_read_b64_tr_b16 v[174:175], v215 offset:56832
    v_mfma_f32_16x16x32_bf16 v[92:95], v[156:159], a[84:87], v[92:95]
    s_waitcnt vmcnt(9)
    v_mfma_f32_16x16x32_bf16 v[96:99], v[128:131], a[72:75], v[96:99]
    buffer_load_dwordx4 a[108:111], v2, s[4:7], s56 offen offset:3072 sc1
    v_mfma_f32_16x16x32_bf16 v[96:99], v[144:147], a[88:91], v[96:99]
    v_mfma_f32_16x16x32_bf16 v[100:103], v[132:135], a[72:75], v[100:103]
    ds_read_b64_tr_b16 v[176:177], v216 offset:5632
    ds_read_b64_tr_b16 v[178:179], v216 offset:7680
    v_mfma_f32_16x16x32_bf16 v[100:103], v[148:151], a[88:91], v[100:103]
    v_mfma_f32_16x16x32_bf16 v[104:107], v[136:139], a[72:75], v[104:107]
    s_add_u32 s56, s56, 4096
    buffer_load_dwordx4 a[124:127], v2, s[4:7], s56 offen offset:0 sc1
    v_mfma_f32_16x16x32_bf16 v[104:107], v[152:155], a[88:91], v[104:107]
    v_mfma_f32_16x16x32_bf16 v[108:111], v[140:143], a[72:75], v[108:111]
    ds_read_b64_tr_b16 v[180:181], v217 offset:5632
    ds_read_b64_tr_b16 v[182:183], v217 offset:7680
    v_mfma_f32_16x16x32_bf16 v[108:111], v[156:159], a[88:91], v[108:111]
    s_waitcnt vmcnt(9)
    v_mfma_f32_16x16x32_bf16 v[112:115], v[128:131], a[76:79], v[112:115]
    s_add_u32 s53, s53, 4294955008
    s_mov_b32 s50, 0x80000
    s_waitcnt vmcnt(7)
    v_cmp_ne_u32 vcc, s47, v8
    s_cbranch_vccnz L_retry_60
L_got_61:
    buffer_load_dwordx4 a[0:3], v2, s[4:7], s53 offen offset:2048 sc1
    v_mfma_f32_16x16x32_bf16 v[112:115], v[144:147], a[92:95], v[112:115]
    v_mfma_f32_16x16x32_bf16 v[116:119], v[132:135], a[76:79], v[116:119]
    ds_read_b64_tr_b16 v[184:185], v218 offset:5632
    ds_read_b64_tr_b16 v[186:187], v218 offset:7680
    v_mfma_f32_16x16x32_bf16 v[116:119], v[148:151], a[92:95], v[116:119]
    v_mfma_f32_16x16x32_bf16 v[120:123], v[136:139], a[76:79], v[120:123]
    buffer_load_dwordx4 a[16:19], v2, s[4:7], s53 offen offset:3072 sc1
    v_mfma_f32_16x16x32_bf16 v[120:123], v[152:155], a[92:95], v[120:123]
    v_mfma_f32_16x16x32_bf16 v[124:127], v[140:143], a[76:79], v[124:127]
    ds_read_b64_tr_b16 v[188:189], v219 offset:5632
    ds_read_b64_tr_b16 v[190:191], v219 offset:7680
    v_mfma_f32_16x16x32_bf16 v[124:127], v[156:159], a[92:95], v[124:127]
    s_waitcnt lgkmcnt(0)
    s_waitcnt vmcnt(8)
    v_mfma_f32_16x16x32_bf16 v[64:67], v[160:163], a[96:99], v[64:67]
    s_add_u32 s54, s54, 4294955008
    buffer_load_dwordx4 a[4:7], v2, s[4:7], s54 offen offset:2048 sc1
    v_mfma_f32_16x16x32_bf16 v[64:67], v[176:179], a[112:115], v[64:67]
    s_add_u32 m0, s74, 87552
    s_add_u32 s51, s75, 425984
    v_mfma_f32_16x16x32_bf16 v[68:71], v[164:167], a[96:99], v[68:71]
    ds_read_b64_tr_b16 v[128:129], v208 offset:0
    ds_read_b64_tr_b16 v[130:131], v208 offset:2048
    v_mfma_f32_16x16x32_bf16 v[68:71], v[180:183], a[112:115], v[68:71]
    buffer_load_dwordx4 v247, s[28:31], s51 offen offset:0 lds
    v_mfma_f32_16x16x32_bf16 v[72:75], v[168:171], a[96:99], v[72:75]
    buffer_load_dwordx4 a[20:23], v2, s[4:7], s54 offen offset:3072 sc1
    v_mfma_f32_16x16x32_bf16 v[72:75], v[184:187], a[112:115], v[72:75]
    buffer_load_dwordx4 v248, s[28:31], s51 offen offset:1024 lds
    v_mfma_f32_16x16x32_bf16 v[76:79], v[172:175], a[96:99], v[76:79]
    ds_read_b64_tr_b16 v[132:133], v209 offset:0
    ds_read_b64_tr_b16 v[134:135], v209 offset:2048
    v_mfma_f32_16x16x32_bf16 v[76:79], v[188:191], a[112:115], v[76:79]
    s_waitcnt vmcnt(10)
    v_mfma_f32_16x16x32_bf16 v[80:83], v[160:163], a[100:103], v[80:83]
    s_add_u32 s55, s55, 4294955008
    buffer_load_dwordx4 a[8:11], v2, s[4:7], s55 offen offset:2048 sc1
    v_mfma_f32_16x16x32_bf16 v[80:83], v[176:179], a[116:119], v[80:83]
    s_add_u32 m0, s74, 89600
    s_add_u32 s51, s75, 442368
    v_mfma_f32_16x16x32_bf16 v[84:87], v[164:167], a[100:103], v[84:87]
    ds_read_b64_tr_b16 v[136:137], v210 offset:0
    ds_read_b64_tr_b16 v[138:139], v210 offset:2048
    v_mfma_f32_16x16x32_bf16 v[84:87], v[180:183], a[116:119], v[84:87]
    buffer_load_dwordx4 v247, s[28:31], s51 offen offset:0 lds
    v_mfma_f32_16x16x32_bf16 v[88:91], v[168:171], a[100:103], v[88:91]
    buffer_load_dwordx4 a[24:27], v2, s[4:7], s55 offen offset:3072 sc1
    v_mfma_f32_16x16x32_bf16 v[88:91], v[184:187], a[116:119], v[88:91]
    buffer_load_dwordx4 v248, s[28:31], s51 offen offset:1024 lds
    v_mfma_f32_16x16x32_bf16 v[92:95], v[172:175], a[100:103], v[92:95]
    ds_read_b64_tr_b16 v[140:141], v211 offset:0
    ds_read_b64_tr_b16 v[142:143], v211 offset:2048
    v_mfma_f32_16x16x32_bf16 v[92:95], v[188:191], a[116:119], v[92:95]
    s_waitcnt vmcnt(12)
    v_mfma_f32_16x16x32_bf16 v[96:99], v[160:163], a[104:107], v[96:99]
    s_add_u32 s56, s56, 4294955008
    buffer_load_dwordx4 a[12:15], v2, s[4:7], s56 offen offset:2048 sc1
    v_mfma_f32_16x16x32_bf16 v[96:99], v[176:179], a[120:123], v[96:99]
    v_mfma_f32_16x16x32_bf16 v[100:103], v[164:167], a[104:107], v[100:103]
    ds_read_b64_tr_b16 v[144:145], v208 offset:16384
    ds_read_b64_tr_b16 v[146:147], v208 offset:18432
    v_mfma_f32_16x16x32_bf16 v[100:103], v[180:183], a[120:123], v[100:103]
    v_mfma_f32_16x16x32_bf16 v[104:107], v[168:171], a[104:107], v[104:107]
    buffer_load_dwordx4 a[28:31], v2, s[4:7], s56 offen offset:3072 sc1
    v_mfma_f32_16x16x32_bf16 v[104:107], v[184:187], a[120:123], v[104:107]
    v_mfma_f32_16x16x32_bf16 v[108:111], v[172:175], a[104:107], v[108:111]
    ds_read_b64_tr_b16 v[148:149], v209 offset:16384
    ds_read_b64_tr_b16 v[150:151], v209 offset:18432
    v_mfma_f32_16x16x32_bf16 v[108:111], v[188:191], a[120:123], v[108:111]
    s_waitcnt vmcnt(12)
    v_mfma_f32_16x16x32_bf16 v[112:115], v[160:163], a[108:111], v[112:115]
    s_add_u32 s53, s53, 4096
    buffer_load_dwordx4 a[32:35], v2, s[4:7], s53 offen offset:2048 sc1
    v_mfma_f32_16x16x32_bf16 v[112:115], v[176:179], a[124:127], v[112:115]
    v_mfma_f32_16x16x32_bf16 v[116:119], v[164:167], a[108:111], v[116:119]
    ds_read_b64_tr_b16 v[152:153], v210 offset:16384
    ds_read_b64_tr_b16 v[154:155], v210 offset:18432
    v_mfma_f32_16x16x32_bf16 v[116:119], v[180:183], a[124:127], v[116:119]
    v_mfma_f32_16x16x32_bf16 v[120:123], v[168:171], a[108:111], v[120:123]
    s_add_u32 s53, s53, 4096
    buffer_load_dwordx4 a[48:51], v2, s[4:7], s53 offen offset:1024 sc1
    v_mfma_f32_16x16x32_bf16 v[120:123], v[184:187], a[124:127], v[120:123]
    v_mfma_f32_16x16x32_bf16 v[124:127], v[172:175], a[108:111], v[124:127]
    ds_read_b64_tr_b16 v[156:157], v211 offset:16384
    ds_read_b64_tr_b16 v[158:159], v211 offset:18432
    v_mfma_f32_16x16x32_bf16 v[124:127], v[188:191], a[124:127], v[124:127]
    s_waitcnt lgkmcnt(0)
    s_waitcnt vmcnt(12)
    v_mfma_f32_16x16x32_bf16 v[64:67], v[128:131], a[0:3], v[64:67]
    s_add_u32 s54, s54, 4096
    buffer_load_dwordx4 a[36:39], v2, s[4:7], s54 offen offset:2048 sc1
    v_mfma_f32_16x16x32_bf16 v[64:67], v[144:147], a[16:19], v[64:67]
    v_mfma_f32_16x16x32_bf16 v[68:71], v[132:135], a[0:3], v[68:71]
    ds_read_b64_tr_b16 v[160:161], v208 offset:32768
    ds_read_b64_tr_b16 v[162:163], v208 offset:34816
    v_mfma_f32_16x16x32_bf16 v[68:71], v[148:151], a[16:19], v[68:71]
    v_mfma_f32_16x16x32_bf16 v[72:75], v[136:139], a[0:3], v[72:75]
    s_add_u32 s54, s54, 4096
    buffer_load_dwordx4 a[52:55], v2, s[4:7], s54 offen offset:1024 sc1
    v_mfma_f32_16x16x32_bf16 v[72:75], v[152:155], a[16:19], v[72:75]
    v_mfma_f32_16x16x32_bf16 v[76:79], v[140:143], a[0:3], v[76:79]
    ds_read_b64_tr_b16 v[164:165], v209 offset:32768
    ds_read_b64_tr_b16 v[166:167], v209 offset:34816
    v_mfma_f32_16x16x32_bf16 v[76:79], v[156:159], a[16:19], v[76:79]
    s_waitcnt vmcnt(11)
    v_mfma_f32_16x16x32_bf16 v[80:83], v[128:131], a[4:7], v[80:83]
    s_add_u32 s55, s55, 4096
    buffer_load_dwordx4 a[40:43], v2, s[4:7], s55 offen offset:2048 sc1
    v_mfma_f32_16x16x32_bf16 v[80:83], v[144:147], a[20:23], v[80:83]
    v_mfma_f32_16x16x32_bf16 v[84:87], v[132:135], a[4:7], v[84:87]
    ds_read_b64_tr_b16 v[168:169], v210 offset:32768
    ds_read_b64_tr_b16 v[170:171], v210 offset:34816
    v_mfma_f32_16x16x32_bf16 v[84:87], v[148:151], a[20:23], v[84:87]
    v_mfma_f32_16x16x32_bf16 v[88:91], v[136:139], a[4:7], v[88:91]
    s_add_u32 s55, s55, 4096
    buffer_load_dwordx4 a[56:59], v2, s[4:7], s55 offen offset:1024 sc1
    v_mfma_f32_16x16x32_bf16 v[88:91], v[152:155], a[20:23], v[88:91]
    v_mfma_f32_16x16x32_bf16 v[92:95], v[140:143], a[4:7], v[92:95]
    ds_read_b64_tr_b16 v[172:173], v211 offset:32768
    ds_read_b64_tr_b16 v[174:175], v211 offset:34816
    v_mfma_f32_16x16x32_bf16 v[92:95], v[156:159], a[20:23], v[92:95]
    s_waitcnt vmcnt(9)
    v_mfma_f32_16x16x32_bf16 v[96:99], v[128:131], a[8:11], v[96:99]
    s_add_u32 s56, s56, 4096
    buffer_load_dwordx4 a[44:47], v2, s[4:7], s56 offen offset:2048 sc1
    v_mfma_f32_16x16x32_bf16 v[96:99], v[144:147], a[24:27], v[96:99]
    v_mfma_f32_16x16x32_bf16 v[100:103], v[132:135], a[8:11], v[100:103]
    ds_read_b64_tr_b16 v[176:177], v208 offset:49152
    ds_read_b64_tr_b16 v[178:179], v208 offset:51200
    v_mfma_f32_16x16x32_bf16 v[100:103], v[148:151], a[24:27], v[100:103]
    v_mfma_f32_16x16x32_bf16 v[104:107], v[136:139], a[8:11], v[104:107]
    s_add_u32 s56, s56, 4096
    buffer_load_dwordx4 a[60:63], v2, s[4:7], s56 offen offset:1024 sc1
    v_mfma_f32_16x16x32_bf16 v[104:107], v[152:155], a[24:27], v[104:107]
    v_mfma_f32_16x16x32_bf16 v[108:111], v[140:143], a[8:11], v[108:111]
    ds_read_b64_tr_b16 v[180:181], v209 offset:49152
    ds_read_b64_tr_b16 v[182:183], v209 offset:51200
    v_mfma_f32_16x16x32_bf16 v[108:111], v[156:159], a[24:27], v[108:111]
    s_waitcnt vmcnt(8)
    v_mfma_f32_16x16x32_bf16 v[112:115], v[128:131], a[12:15], v[112:115]
    buffer_load_dwordx4 a[68:71], v2, s[4:7], s54 offen offset:2048 sc1
    v_mfma_f32_16x16x32_bf16 v[112:115], v[144:147], a[28:31], v[112:115]
    v_mfma_f32_16x16x32_bf16 v[116:119], v[132:135], a[12:15], v[116:119]
    ds_read_b64_tr_b16 v[184:185], v210 offset:49152
    ds_read_b64_tr_b16 v[186:187], v210 offset:51200
    v_mfma_f32_16x16x32_bf16 v[116:119], v[148:151], a[28:31], v[116:119]
    v_mfma_f32_16x16x32_bf16 v[120:123], v[136:139], a[12:15], v[120:123]
    s_add_u32 s54, s54, 4096
    buffer_load_dwordx4 a[84:87], v2, s[4:7], s54 offen offset:1024 sc1
    v_mfma_f32_16x16x32_bf16 v[120:123], v[152:155], a[28:31], v[120:123]
    v_mfma_f32_16x16x32_bf16 v[124:127], v[140:143], a[12:15], v[124:127]
    ds_read_b64_tr_b16 v[188:189], v211 offset:49152
    ds_read_b64_tr_b16 v[190:191], v211 offset:51200
    v_mfma_f32_16x16x32_bf16 v[124:127], v[156:159], a[28:31], v[124:127]
    s_waitcnt lgkmcnt(0)
    s_waitcnt vmcnt(8)
    v_mfma_f32_16x16x32_bf16 v[64:67], v[160:163], a[32:35], v[64:67]
    buffer_load_dwordx4 a[72:75], v2, s[4:7], s55 offen offset:2048 sc1
    v_mfma_f32_16x16x32_bf16 v[64:67], v[176:179], a[48:51], v[64:67]
    v_mfma_f32_16x16x32_bf16 v[68:71], v[164:167], a[32:35], v[68:71]
    ds_read_b64_tr_b16 v[128:129], v212 offset:0
    ds_read_b64_tr_b16 v[130:131], v212 offset:2048
    v_mfma_f32_16x16x32_bf16 v[68:71], v[180:183], a[48:51], v[68:71]
    v_mfma_f32_16x16x32_bf16 v[72:75], v[168:171], a[32:35], v[72:75]
    s_add_u32 s55, s55, 4096
    buffer_load_dwordx4 a[88:91], v2, s[4:7], s55 offen offset:1024 sc1
    v_mfma_f32_16x16x32_bf16 v[72:75], v[184:187], a[48:51], v[72:75]
    v_mfma_f32_16x16x32_bf16 v[76:79], v[172:175], a[32:35], v[76:79]
    ds_read_b64_tr_b16 v[132:133], v213 offset:0
    ds_read_b64_tr_b16 v[134:135], v213 offset:2048
    v_mfma_f32_16x16x32_bf16 v[76:79], v[188:191], a[48:51], v[76:79]
    s_waitcnt vmcnt(8)
    v_mfma_f32_16x16x32_bf16 v[80:83], v[160:163], a[36:39], v[80:83]
    buffer_load_dwordx4 a[76:79], v2, s[4:7], s56 offen offset:2048 sc1
    v_mfma_f32_16x16x32_bf16 v[80:83], v[176:179], a[52:55], v[80:83]
    v_mfma_f32_16x16x32_bf16 v[84:87], v[164:167], a[36:39], v[84:87]
    ds_read_b64_tr_b16 v[136:137], v214 offset:0
    ds_read_b64_tr_b16 v[138:139], v214 offset:2048
    v_mfma_f32_16x16x32_bf16 v[84:87], v[180:183], a[52:55], v[84:87]
    v_mfma_f32_16x16x32_bf16 v[88:91], v[168:171], a[36:39], v[88:91]
    s_add_u32 s56, s56, 4096
    buffer_load_dwordx4 a[92:95], v2, s[4:7], s56 offen offset:1024 sc1
    v_mfma_f32_16x16x32_bf16 v[88:91], v[184:187], a[52:55], v[88:91]
    v_mfma_f32_16x16x32_bf16 v[92:95], v[172:175], a[36:39], v[92:95]
    ds_read_b64_tr_b16 v[140:141], v215 offset:0
    ds_read_b64_tr_b16 v[142:143], v215 offset:2048
    v_mfma_f32_16x16x32_bf16 v[92:95], v[188:191], a[52:55], v[92:95]
    s_waitcnt vmcnt(8)
    v_mfma_f32_16x16x32_bf16 v[96:99], v[160:163], a[40:43], v[96:99]
    buffer_load_dwordx4 a[64:67], v2, s[4:7], s53 offen offset:2048 sc1
    v_mfma_f32_16x16x32_bf16 v[96:99], v[176:179], a[56:59], v[96:99]
    v_mfma_f32_16x16x32_bf16 v[100:103], v[164:167], a[40:43], v[100:103]
    ds_read_b64_tr_b16 v[144:145], v212 offset:22016
    ds_read_b64_tr_b16 v[146:147], v212 offset:24064
    v_mfma_f32_16x16x32_bf16 v[100:103], v[180:183], a[56:59], v[100:103]
    v_mfma_f32_16x16x32_bf16 v[104:107], v[168:171], a[40:43], v[104:107]
    s_add_u32 s53, s53, 4096
    buffer_load_dwordx4 a[80:83], v2, s[4:7], s53 offen offset:1024 sc1
    v_mfma_f32_16x16x32_bf16 v[104:107], v[184:187], a[56:59], v[104:107]
    v_mfma_f32_16x16x32_bf16 v[108:111], v[172:175], a[40:43], v[108:111]
    ds_read_b64_tr_b16 v[148:149], v213 offset:22016
    ds_read_b64_tr_b16 v[150:151], v213 offset:24064
    v_mfma_f32_16x16x32_bf16 v[108:111], v[188:191], a[56:59], v[108:111]
    s_waitcnt vmcnt(8)
    v_mfma_f32_16x16x32_bf16 v[112:115], v[160:163], a[44:47], v[112:115]
    v_mfma_f32_16x16x32_bf16 v[112:115], v[176:179], a[60:63], v[112:115]
    v_mfma_f32_16x16x32_bf16 v[116:119], v[164:167], a[44:47], v[116:119]
    ds_read_b64_tr_b16 v[152:153], v214 offset:22016
    ds_read_b64_tr_b16 v[154:155], v214 offset:24064
    v_mfma_f32_16x16x32_bf16 v[116:119], v[180:183], a[60:63], v[116:119]
    v_mfma_f32_16x16x32_bf16 v[120:123], v[168:171], a[44:47], v[120:123]
    v_mfma_f32_16x16x32_bf16 v[120:123], v[184:187], a[60:63], v[120:123]
    v_mfma_f32_16x16x32_bf16 v[124:127], v[172:175], a[44:47], v[124:127]
    ds_read_b64_tr_b16 v[156:157], v215 offset:22016
    ds_read_b64_tr_b16 v[158:159], v215 offset:24064
    v_mfma_f32_16x16x32_bf16 v[124:127], v[188:191], a[60:63], v[124:127]
    s_waitcnt lgkmcnt(0)
    s_waitcnt vmcnt(6)
    v_mfma_f32_16x16x32_bf16 v[80:83], v[128:131], a[68:71], v[80:83]
    v_mfma_f32_16x16x32_bf16 v[80:83], v[144:147], a[84:87], v[80:83]
    v_mfma_f32_16x16x32_bf16 v[84:87], v[132:135], a[68:71], v[84:87]
    v_mfma_f32_16x16x32_bf16 v[84:87], v[148:151], a[84:87], v[84:87]
    v_mfma_f32_16x16x32_bf16 v[88:91], v[136:139], a[68:71], v[88:91]
    v_mfma_f32_16x16x32_bf16 v[88:91], v[152:155], a[84:87], v[88:91]
    v_mfma_f32_16x16x32_bf16 v[92:95], v[140:143], a[68:71], v[92:95]
    v_mfma_f32_16x16x32_bf16 v[92:95], v[156:159], a[84:87], v[92:95]
    s_waitcnt vmcnt(4)
    v_mfma_f32_16x16x32_bf16 v[96:99], v[128:131], a[72:75], v[96:99]
    v_mfma_f32_16x16x32_bf16 v[96:99], v[144:147], a[88:91], v[96:99]
    ds_write_b128 v242, v[80:83] offset:0
    v_mfma_f32_16x16x32_bf16 v[100:103], v[132:135], a[72:75], v[100:103]
    v_mfma_f32_16x16x32_bf16 v[100:103], v[148:151], a[88:91], v[100:103]
    ds_write_b128 v242, v[84:87] offset:1024
    v_mfma_f32_16x16x32_bf16 v[104:107], v[136:139], a[72:75], v[104:107]
    v_mfma_f32_16x16x32_bf16 v[104:107], v[152:155], a[88:91], v[104:107]
    ds_write_b128 v242, v[88:91] offset:2048
    v_mfma_f32_16x16x32_bf16 v[108:111], v[140:143], a[72:75], v[108:111]
    v_mfma_f32_16x16x32_bf16 v[108:111], v[156:159], a[88:91], v[108:111]
    ds_write_b128 v242, v[92:95] offset:3072
    s_waitcnt vmcnt(2)
    v_mfma_f32_16x16x32_bf16 v[112:115], v[128:131], a[76:79], v[112:115]
    v_mfma_f32_16x16x32_bf16 v[112:115], v[144:147], a[92:95], v[112:115]
    ds_write_b128 v242, v[96:99] offset:16384
    v_mfma_f32_16x16x32_bf16 v[116:119], v[132:135], a[76:79], v[116:119]
    v_mfma_f32_16x16x32_bf16 v[116:119], v[148:151], a[92:95], v[116:119]
    ds_write_b128 v242, v[100:103] offset:17408
    v_mfma_f32_16x16x32_bf16 v[120:123], v[136:139], a[76:79], v[120:123]
    v_mfma_f32_16x16x32_bf16 v[120:123], v[152:155], a[92:95], v[120:123]
    ds_write_b128 v242, v[104:107] offset:18432
    v_mfma_f32_16x16x32_bf16 v[124:127], v[140:143], a[76:79], v[124:127]
    v_mfma_f32_16x16x32_bf16 v[124:127], v[156:159], a[92:95], v[124:127]
    ds_write_b128 v242, v[108:111] offset:19456
    s_waitcnt vmcnt(0)
    v_mfma_f32_16x16x32_bf16 v[64:67], v[128:131], a[64:67], v[64:67]
    v_mfma_f32_16x16x32_bf16 v[64:67], v[144:147], a[80:83], v[64:67]
    ds_write_b128 v242, v[112:115] offset:32768
    v_mfma_f32_16x16x32_bf16 v[68:71], v[132:135], a[64:67], v[68:71]
    v_mfma_f32_16x16x32_bf16 v[68:71], v[148:151], a[80:83], v[68:71]
    ds_write_b128 v242, v[116:119] offset:33792
    v_mfma_f32_16x16x32_bf16 v[72:75], v[136:139], a[64:67], v[72:75]
    v_mfma_f32_16x16x32_bf16 v[72:75], v[152:155], a[80:83], v[72:75]
    ds_write_b128 v242, v[120:123] offset:34816
    v_mfma_f32_16x16x32_bf16 v[76:79], v[140:143], a[64:67], v[76:79]
    v_mfma_f32_16x16x32_bf16 v[76:79], v[156:159], a[80:83], v[76:79]
    ds_write_b128 v242, v[124:127] offset:35840
    s_waitcnt lgkmcnt(0)
    s_barrier
    ds_read_b128 v[80:83], v243 offset:0
    ds_read_b128 v[84:87], v243 offset:1024
    ds_read_b128 v[88:91], v243 offset:2048
    ds_read_b128 v[92:95], v243 offset:3072
    ds_read_b128 v[96:99], v244 offset:16384
    ds_read_b128 v[100:103], v244 offset:17408
    ds_read_b128 v[104:107], v244 offset:18432
    ds_read_b128 v[108:111], v244 offset:19456
    ds_read_b128 v[112:115], v245 offset:32768
    ds_read_b128 v[116:119], v245 offset:33792
    ds_read_b128 v[120:123], v245 offset:34816
    ds_read_b128 v[124:127], v245 offset:35840
    s_waitcnt lgkmcnt(11)
    v_pk_add_f32 v[64:65], v[64:65], v[80:81]
    v_pk_add_f32 v[66:67], v[66:67], v[82:83]
    s_waitcnt lgkmcnt(10)
    v_pk_add_f32 v[68:69], v[68:69], v[84:85]
    v_pk_add_f32 v[70:71], v[70:71], v[86:87]
    s_waitcnt lgkmcnt(9)
    v_pk_add_f32 v[72:73], v[72:73], v[88:89]
    v_pk_add_f32 v[74:75], v[74:75], v[90:91]
    s_waitcnt lgkmcnt(8)
    v_pk_add_f32 v[76:77], v[76:77], v[92:93]
    v_pk_add_f32 v[78:79], v[78:79], v[94:95]
    s_waitcnt lgkmcnt(7)
    v_pk_add_f32 v[64:65], v[64:65], v[96:97]
    v_pk_add_f32 v[66:67], v[66:67], v[98:99]
    s_waitcnt lgkmcnt(6)
    v_pk_add_f32 v[68:69], v[68:69], v[100:101]
    v_pk_add_f32 v[70:71], v[70:71], v[102:103]
    s_waitcnt lgkmcnt(5)
    v_pk_add_f32 v[72:73], v[72:73], v[104:105]
    v_pk_add_f32 v[74:75], v[74:75], v[106:107]
    s_waitcnt lgkmcnt(4)
    v_pk_add_f32 v[76:77], v[76:77], v[108:109]
    v_pk_add_f32 v[78:79], v[78:79], v[110:111]
    s_waitcnt lgkmcnt(3)
    v_pk_add_f32 v[64:65], v[64:65], v[112:113]
    v_pk_add_f32 v[66:67], v[66:67], v[114:115]
    s_waitcnt lgkmcnt(2)
    v_pk_add_f32 v[68:69], v[68:69], v[116:117]
    v_pk_add_f32 v[70:71], v[70:71], v[118:119]
    s_waitcnt lgkmcnt(1)
    v_pk_add_f32 v[72:73], v[72:73], v[120:121]
    v_pk_add_f32 v[74:75], v[74:75], v[122:123]
    s_waitcnt lgkmcnt(0)
    v_pk_add_f32 v[76:77], v[76:77], v[124:125]
    v_pk_add_f32 v[78:79], v[78:79], v[126:127]
    v_pk_fma_f32 v[64:65], v[64:65], v[40:41], v[16:17]
    v_pk_fma_f32 v[66:67], v[66:67], v[42:43], v[18:19]
    v_pk_fma_f32 v[68:69], v[68:69], v[44:45], v[20:21]
    v_pk_fma_f32 v[70:71], v[70:71], v[46:47], v[22:23]
    v_pk_fma_f32 v[72:73], v[72:73], v[48:49], v[24:25]
    v_pk_fma_f32 v[74:75], v[74:75], v[50:51], v[26:27]
    v_pk_fma_f32 v[76:77], v[76:77], v[52:53], v[28:29]
    v_pk_fma_f32 v[78:79], v[78:79], v[54:55], v[30:31]
    v_cvt_pk_bf16_f32 v32, v64, v65
    v_cvt_pk_bf16_f32 v33, v66, v67
    v_cvt_pk_bf16_f32 v34, v68, v69
    v_cvt_pk_bf16_f32 v35, v70, v71
    v_cvt_pk_bf16_f32 v36, v72, v73
    v_cvt_pk_bf16_f32 v37, v74, v75
    v_cvt_pk_bf16_f32 v38, v76, v77
    v_cvt_pk_bf16_f32 v39, v78, v79
    s_nop 0
    v_permlane16_swap_b32 v32, v34
    v_permlane16_swap_b32 v33, v35
    v_permlane16_swap_b32 v36, v38
    v_permlane16_swap_b32 v37, v39
    buffer_store_dwordx4 v[32:35], v246, s[40:43], s65 offen offset:0
    buffer_store_dwordx4 v[36:39], v246, s[40:43], s65 offen offset:64
    s_add_u32 s3, s2, s46
    s_cmp_lg_u32 s3, 0
    s_cbranch_scc1 L_noep_62
    buffer_store_dword v5, off, s[4:7], 0 offset:0 sc1
L_noep_62:
L_end:
    s_endpgm
L_tail:
L_maretry_6:
    buffer_store_dwordx2 v[112:113], v123, s[4:7], 0 offen sc1
    s_add_u32 s57, s53, 32768
    s_mov_b32 s50, 0x80000
L_maslp_7:
    buffer_load_dwordx4 v[64:67], v125, s[4:7], s53 offen offset:0 sc1
    buffer_load_dwordx4 v[80:83], v125, s[4:7], s57 offen offset:0 sc1
    buffer_load_dwordx4 v[68:71], v125, s[4:7], s53 offen offset:16 sc1
    buffer_load_dwordx4 v[84:87], v125, s[4:7], s57 offen offset:16 sc1
    buffer_load_dwordx4 v[72:75], v125, s[4:7], s53 offen offset:2048 sc1
    buffer_load_dwordx4 v[88:91], v125, s[4:7], s57 offen offset:2048 sc1
    buffer_load_dwordx4 v[76:79], v125, s[4:7], s53 offen offset:2064 sc1
    buffer_load_dwordx4 v[92:95], v125, s[4:7], s57 offen offset:2064 sc1
    s_waitcnt vmcnt(0)
    s_mov_b64 s[68:69], 0
    s_mov_b64 s[70:71], 0
    v_cmp_ne_u32 vcc, v126, v65
    v_cmp_ne_u32 s[72:73], v5, v81
    s_or_b64 s[70:71], s[70:71], vcc
    v_cndmask_b32 v64, v64, v80, vcc
    s_and_b64 s[72:73], s[72:73], vcc
    s_or_b64 s[68:69], s[68:69], s[72:73]
    v_cmp_ne_u32 vcc, v126, v67
    v_cmp_ne_u32 s[72:73], v5, v83
    s_or_b64 s[70:71], s[70:71], vcc
    v_cndmask_b32 v66, v66, v82, vcc
    s_and_b64 s[72:73], s[72:73], vcc
    s_or_b64 s[68:69], s[68:69], s[72:73]
    v_cmp_ne_u32 vcc, v126, v69
    v_cmp_ne_u32 s[72:73], v5, v85
    s_or_b64 s[70:71], s[70:71], vcc
    v_cndmask_b32 v68, v68, v84, vcc
    s_and_b64 s[72:73], s[72:73], vcc
    s_or_b64 s[68:69], s[68:69], s[72:73]
    v_cmp_ne_u32 vcc, v126, v71
    v_cmp_ne_u32 s[72:73], v5, v87
    s_or_b64 s[70:71], s[70:71], vcc
    v_cndmask_b32 v70, v70, v86, vcc
    s_and_b64 s[72:73], s[72:73], vcc
    s_or_b64 s[68:69], s[68:69], s[72:73]
    v_cmp_ne_u32 vcc, v126, v73
    v_cmp_ne_u32 s[72:73], v5, v89
    s_or_b64 s[70:71], s[70:71], vcc
    v_cndmask_b32 v72, v72, v88, vcc
    s_and_b64 s[72:73], s[72:73], vcc
    s_or_b64 s[68:69], s[68:69], s[72:73]
    v_cmp_ne_u32 vcc, v126, v75
    v_cmp_ne_u32 s[72:73], v5, v91
    s_or_b64 s[70:71], s[70:71], vcc
    v_cndmask_b32 v74, v74, v90, vcc
    s_and_b64 s[72:73], s[72:73], vcc
    s_or_b64 s[68:69], s[68:69], s[72:73]
    v_cmp_ne_u32 vcc, v126, v77
    v_cmp_ne_u32 s[72:73], v5, v93
    s_or_b64 s[70:71], s[70:71], vcc
    v_cndmask_b32 v76, v76, v92, vcc
    s_and_b64 s[72:73], s[72:73], vcc
    s_or_b64 s[68:69], s[68:69], s[72:73]
    v_cmp_ne_u32 vcc, v126, v79
    v_cmp_ne_u32 s[72:73], v5, v95
    s_or_b64 s[70:71], s[70:71], vcc
    v_cndmask_b32 v78, v78, v94, vcc
    s_and_b64 s[72:73], s[72:73], vcc
    s_or_b64 s[68:69], s[68:69], s[72:73]
    s_cmp_eq_u64 s[70:71], 0
    s_cselect_b32 s48, 1, 0
    s_cmp_eq_u64 s[68:69], 0
    s_cbranch_scc1 L_madone_8
    s_sub_u32 s50, s50, 1
    s_cbranch_scc0 L_maslp_7
    s_branch L_madone_8
L_slow_9:
    s_waitcnt lgkmcnt(3)
    buffer_store_dwordx4 v[16:19], v124, s[4:7], s54 offen offset:0 sc1
    s_waitcnt lgkmcnt(2)
    buffer_store_dwordx4 v[20:23], v124, s[4:7], s54 offen offset:512 sc1
    s_waitcnt lgkmcnt(1)
    buffer_store_dwordx4 v[24:27], v124, s[4:7], s54 offen offset:1024 sc1
    s_waitcnt lgkmcnt(0)
    buffer_store_dwordx4 v[28:31], v124, s[4:7], s54 offen offset:1536 sc1
    s_waitcnt vmcnt(0)
    buffer_store_dword v5, off, s[4:7], s55 sc1
    s_branch L_st_10
L_h1late_12:
    buffer_store_dwordx2 v[112:113], v123, s[4:7], 0 offen sc1
    s_mov_b32 s50, 0x80000
L_retry_14:
    buffer_load_dword v6, v7, s[4:7], s52 offen sc1
    s_sub_u32 s50, s50, 1
    s_waitcnt vmcnt(0)
    v_cmp_ne_u32 vcc, s47, v6
    s_cbranch_scc1 L_got_15
    s_cbranch_vccnz L_retry_14
L_got_15:
    s_branch L_h1got_13
L_notone_16:
    s_mov_b32 s48, 0
    buffer_store_dwordx2 v[112:113], v123, s[4:7], 0 offen sc1
    s_branch L_one_17
L_slow_18:
    buffer_store_dword v5, off, s[4:7], s92 sc1
    s_branch L_st_19
L_retry_20:
    s_sub_u32 s50, s50, 1
    s_cbranch_scc1 L_got_21
    buffer_load_dword v9, v238, s[4:7], s85 offen sc1
    s_waitcnt vmcnt(0)
    v_cmp_ne_u32 vcc, s47, v9
    s_cbranch_vccnz L_retry_20
    s_branch L_got_21
L_retry_22:
    s_sub_u32 s50, s50, 1
    s_cbranch_scc1 L_got_23
    buffer_load_dword v9, v253, s[4:7], s84 offen sc1
    s_waitcnt vmcnt(0)
    v_cmp_ne_u32 vcc, s47, v9
    s_cbranch_vccnz L_retry_22
    s_branch L_got_23
L_retry_24:
    s_sub_u32 s50, s50, 1
    s_cbranch_scc1 L_got_25
    buffer_load_dword v9, v254, s[4:7], s84 offen sc1
    s_waitcnt vmcnt(0)
    v_cmp_ne_u32 vcc, s47, v9
    s_cbranch_vccnz L_retry_24
    s_branch L_got_25
L_slow_28:
    buffer_store_dwordx4 v[64:67], v8, s[4:7], s53 offen sc1
    buffer_store_dwordx4 v[68:71], v8, s[4:7], s54 offen sc1
    s_branch L_st_29
L_slow_30:
    s_waitcnt vmcnt(0)
    buffer_store_dword v5, off, s[4:7], s75 sc1
    s_branch L_st_31
L_retry_32:
    s_sub_u32 s50, s50, 1
    s_cbranch_scc1 L_got_33
    s_add_u32 s59, s74, 0
    buffer_load_dwordx2 v[16:17], v7, s[4:7], s59 offen sc1
    s_add_u32 s59, s74, 16384
    buffer_load_dwordx2 v[18:19], v7, s[4:7], s59 offen sc1
    s_add_u32 s59, s74, 32768
    buffer_load_dwordx2 v[20:21], v7, s[4:7], s59 offen sc1
    s_add_u32 s59, s74, 49152
    buffer_load_dwordx2 v[22:23], v7, s[4:7], s59 offen sc1
    s_waitcnt vmcnt(0)
    v_xor_b32 v17, v5, v17
    v_xor_b32 v19, v5, v19
    v_xor_b32 v21, v5, v21
    v_xor_b32 v23, v5, v23
    v_or3_b32 v17, v17, v19, v21
    v_or_b32 v23, v23, v17
    v_cmp_ne_u32 vcc, 0, v23
    s_cbranch_vccnz L_retry_32
    s_branch L_got_33
L_slow_36:
    buffer_store_dwordx2 v[32:33], v7, s[4:7], s56 offen sc1
    s_branch L_st_37
L_slow_40:
    buffer_store_dwordx4 v[40:43], v2, s[4:7], s57 offen sc1
    buffer_store_dwordx4 v[44:47], v2, s[4:7], s57 offen offset:1024 sc1
    s_branch L_st_41
L_slow_42:
    s_waitcnt vmcnt(0)
    buffer_store_dword v5, off, s[4:7], s58 sc1
    s_branch L_st_43
L_slow_46:
    buffer_store_dwordx4 v[176:179], v2, s[4:7], s52 offen offset:0 sc1
    buffer_store_dwordx4 v[180:183], v2, s[4:7], s53 offen offset:0 sc1
    s_branch L_st_47
L_slow_48:
    buffer_store_dwordx4 v[184:187], v2, s[4:7], s52 offen offset:1024 sc1
    buffer_store_dwordx4 v[188:191], v2, s[4:7], s53 offen offset:1024 sc1
    s_branch L_st_49
L_slow_50:
    s_waitcnt vmcnt(0)
    buffer_store_dword v5, off, s[4:7], s56 sc1
    s_branch L_st_51
L_slow_52:
    buffer_store_dwordx4 v[192:195], v2, s[4:7], s52 offen offset:2048 sc1
    buffer_store_dwordx4 v[196:199], v2, s[4:7], s53 offen offset:2048 sc1
    s_branch L_st_53
L_slow_54:
    buffer_store_dwordx2 v[200:201], v2, s[4:7], s72 offen sc1
    buffer_store_dwordx2 v[204:205], v2, s[4:7], s73 offen sc1
    s_branch L_st_55
L_retry_56:
    s_sub_u32 s50, s50, 1
    s_cbranch_scc1 L_got_57
    buffer_load_dword v9, v7, s[4:7], s59 offen sc1
    s_waitcnt vmcnt(0)
    v_cmp_ne_u32 vcc, s47, v9
    s_cbranch_vccnz L_retry_56
    s_branch L_got_57
L_slow_58:
    buffer_store_dword v5, off, s[4:7], s57 sc1
    s_branch L_st_59
L_retry_60:
    s_sub_u32 s50, s50, 1
    s_cbranch_scc1 L_got_61
    buffer_load_dword v8, v7, s[4:7], s57 offen sc1
    s_waitcnt vmcnt(0)
    v_cmp_ne_u32 vcc, s47, v8
    s_cbranch_vccnz L_retry_60
    s_branch L_got_61
L_tail_end:
L_fallback:
    s_waitcnt vmcnt(0) lgkmcnt(0)
    v_mov_b32 v48, 0xff800000
    s_mov_b32 s3, s65
    s_mov_b32 s50, 64
L_fb1_63:
    buffer_load_dwordx4 v[128:131], v2, s[4:7], s3 offen sc1
    s_waitcnt vmcnt(0)
    v_mfma_f32_32x32x16_bf16 v[16:31], v[128:131], a[136:139], 0
    s_nop 11
    v_max3_f32 v48, v16, v17, v48
    v_max3_f32 v48, v18, v19, v48
    v_max3_f32 v48, v20, v21, v48
    v_max3_f32 v48, v22, v23, v48
    v_max3_f32 v48, v24, v25, v48
    v_max3_f32 v48, v26, v27, v48
    v_max3_f32 v48, v28, v29, v48
    v_max3_f32 v48, v30, v31, v48
    s_add_u32 s3, s3, 2048
    s_sub_u32 s50, s50, 1
    s_cmp_lg_u32 s50, 0
    s_cbranch_scc1 L_fb1_63
    v_mov_b32 v49, v48
    s_nop 1
    v_permlane32_swap_b32 v48, v49
    v_max_f32 v48, v48, v49
    v_sub_f32 v32, 0, v48
    v_sub_f32 v33, 0, v48
    v_sub_f32 v34, 0, v48
    v_sub_f32 v35, 0, v48
    v_sub_f32 v36, 0, v48
    v_sub_f32 v37, 0, v48
    v_sub_f32 v38, 0, v48
    v_sub_f32 v39, 0, v48
    v_sub_f32 v40, 0, v48
    v_sub_f32 v41, 0, v48
    v_sub_f32 v42, 0, v48
    v_sub_f32 v43, 0, v48
    v_sub_f32 v44, 0, v48
    v_sub_f32 v45, 0, v48
    v_sub_f32 v46, 0, v48
    v_sub_f32 v47, 0, v48
    v_mov_b32 v192, 0
    v_mov_b32 v193, 0
    v_mov_b32 v194, 0
    v_mov_b32 v195, 0
    v_mov_b32 v196, 0
    v_mov_b32 v197, 0
    v_mov_b32 v198, 0
    v_mov_b32 v199, 0
    v_mov_b32 v200, 0
    v_mov_b32 v201, 0
    v_mov_b32 v202, 0
    v_mov_b32 v203, 0
    v_mov_b32 v204, 0
    v_mov_b32 v205, 0
    v_mov_b32 v206, 0
    v_mov_b32 v207, 0
    s_mov_b32 s3, s65
    s_mov_b32 s50, 64
L_fb2_64:
    buffer_load_dwordx4 v[128:131], v2, s[4:7], s3 offen sc1
    s_mov_b64 exec, s[60:61]
    buffer_load_dwordx4 v[132:135], v12, s[4:7], s3 offen offset:1024 sc1
    buffer_load_dwordx4 v[136:139], v12, s[4:7], s3 offen offset:1536 sc1
    s_mov_b64 exec, -1
    s_waitcnt vmcnt(0)
    v_mfma_f32_32x32x16_bf16 v[16:31], v[128:131], a[136:139], v[32:47]
    s_nop 11
    v_exp_f32 v16, v16
    v_exp_f32 v17, v17
    v_exp_f32 v18, v18
    v_exp_f32 v19, v19
    v_exp_f32 v20, v20
    v_exp_f32 v21, v21
    v_exp_f32 v22, v22
    v_exp_f32 v23, v23
    v_exp_f32 v24, v24
    v_exp_f32 v25, v25
    v_exp_f32 v26, v26
    v_exp_f32 v27, v27
    v_exp_f32 v28, v28
    v_exp_f32 v29, v29
    v_exp_f32 v30, v30
    v_exp_f32 v31, v31
    s_nop 1
    v_smfmac_f32_32x32x32_bf16 v[192:207], v[132:135], v[16:23], v3
    v_smfmac_f32_32x32x32_bf16 v[192:207], v[136:139], v[24:31], v3
    s_add_u32 s3, s3, 2048
    s_sub_u32 s50, s50, 1
    s_cmp_lg_u32 s50, 0
    s_cbranch_scc1 L_fb2_64
    s_nop 11
    v_mov_b32 v48, 0xff800000
    s_mov_b32 s3, s65
    s_mov_b32 s50, 64
L_fb1_65:
    buffer_load_dwordx4 v[128:131], v2, s[4:7], s3 offen sc1
    s_waitcnt vmcnt(0)
    v_mfma_f32_32x32x16_bf16 v[16:31], v[128:131], a[140:143], 0
    s_nop 11
    v_max3_f32 v48, v16, v17, v48
    v_max3_f32 v48, v18, v19, v48
    v_max3_f32 v48, v20, v21, v48
    v_max3_f32 v48, v22, v23, v48
    v_max3_f32 v48, v24, v25, v48
    v_max3_f32 v48, v26, v27, v48
    v_max3_f32 v48, v28, v29, v48
    v_max3_f32 v48, v30, v31, v48
    s_add_u32 s3, s3, 2048
    s_sub_u32 s50, s50, 1
    s_cmp_lg_u32 s50, 0
    s_cbranch_scc1 L_fb1_65
    v_mov_b32 v49, v48
    s_nop 1
    v_permlane32_swap_b32 v48, v49
    v_max_f32 v48, v48, v49
    v_sub_f32 v32, 0, v48
    v_sub_f32 v33, 0, v48
    v_sub_f32 v34, 0, v48
    v_sub_f32 v35, 0, v48
    v_sub_f32 v36, 0, v48
    v_sub_f32 v37, 0, v48
    v_sub_f32 v38, 0, v48
    v_sub_f32 v39, 0, v48
    v_sub_f32 v40, 0, v48
    v_sub_f32 v41, 0, v48
    v_sub_f32 v42, 0, v48
    v_sub_f32 v43, 0, v48
    v_sub_f32 v44, 0, v48
    v_sub_f32 v45, 0, v48
    v_sub_f32 v46, 0, v48
    v_sub_f32 v47, 0, v48
    v_mov_b32 v208, 0
    v_mov_b32 v209, 0
    v_mov_b32 v210, 0
    v_mov_b32 v211, 0
    v_mov_b32 v212, 0
    v_mov_b32 v213, 0
    v_mov_b32 v214, 0
    v_mov_b32 v215, 0
    v_mov_b32 v216, 0
    v_mov_b32 v217, 0
    v_mov_b32 v218, 0
    v_mov_b32 v219, 0
    v_mov_b32 v220, 0
    v_mov_b32 v221, 0
    v_mov_b32 v222, 0
    v_mov_b32 v223, 0
    s_mov_b32 s3, s65
    s_mov_b32 s50, 64
L_fb2_66:
    buffer_load_dwordx4 v[128:131], v2, s[4:7], s3 offen sc1
    s_mov_b64 exec, s[60:61]
    buffer_load_dwordx4 v[132:135], v12, s[4:7], s3 offen offset:1024 sc1
    buffer_load_dwordx4 v[136:139], v12, s[4:7], s3 offen offset:1536 sc1
    s_mov_b64 exec, -1
    s_waitcnt vmcnt(0)
    v_mfma_f32_32x32x16_bf16 v[16:31], v[128:131], a[140:143], v[32:47]
    s_nop 11
    v_exp_f32 v16, v16
    v_exp_f32 v17, v17
    v_exp_f32 v18, v18
    v_exp_f32 v19, v19
    v_exp_f32 v20, v20
    v_exp_f32 v21, v21
    v_exp_f32 v22, v22
    v_exp_f32 v23, v23
    v_exp_f32 v24, v24
    v_exp_f32 v25, v25
    v_exp_f32 v26, v26
    v_exp_f32 v27, v27
    v_exp_f32 v28, v28
    v_exp_f32 v29, v29
    v_exp_f32 v30, v30
    v_exp_f32 v31, v31
    s_nop 1
    v_smfmac_f32_32x32x32_bf16 v[208:223], v[132:135], v[16:23], v3
    v_smfmac_f32_32x32x32_bf16 v[208:223], v[136:139], v[24:31], v3
    s_add_u32 s3, s3, 2048
    s_sub_u32 s50, s50, 1
    s_cmp_lg_u32 s50, 0
    s_cbranch_scc1 L_fb2_66
    s_nop 11
    s_branch L_norm
.section .rodata,"a"
.p2align 6
.amdhsa_kernel adaLN_cond__softmax_full_mha__glu_gated_geglu__prompt_kernel
  .amdhsa_next_free_vgpr 512
  .amdhsa_next_free_sgpr 102
  .amdhsa_accum_offset 256
  .amdhsa_group_segment_fixed_size 0
  .amdhsa_kernarg_size 96
  .amdhsa_user_sgpr_count 2
  .amdhsa_user_sgpr_kernarg_segment_ptr 1
  .amdhsa_system_sgpr_workgroup_id_x 1
  .amdhsa_float_denorm_mode_32 3
.end_amdhsa_kernel
```
